```python
import torch

def _softmax(x, axis=-1):
    return torch.softmax(x, dim=axis)
def _gelu(x):
    return torch.nn.functional.gelu(x, approximate="tanh")
def _silu(x):
    return torch.nn.functional.silu(x)
def _sigmoid(x):
    return torch.sigmoid(x)
def _layernorm(x, axis=-1, eps=1e-5):
    m = x.mean(dim=axis, keepdim=True)
    v = x.var(dim=axis, keepdim=True, unbiased=False)
    return (x - m) / torch.sqrt(v + eps)
def _scatter_add(tgt, idx, src, axis=0):
    return tgt.clone().index_add_(axis, idx, src)
def _segment_sum(src, seg, n):
    out = torch.zeros((n,) + src.shape[1:], dtype=src.dtype)
    return out.index_add_(0, seg, src)
def _pad(x, pw):
    flat = tuple(v for pair in reversed(pw) for v in pair)
    return torch.nn.functional.pad(x, flat)

kernel_name = 'recurrent_scan__mha_block_cached__glu_gated_glu__prompt'

def setup_inputs():

    _w = (lambda a: (lambda t: t.to(torch.bfloat16) if t.is_floating_point() else t)(torch.as_tensor(a)))
    def _A_setup():
        B, Sq, D = 1, 2048, 448
        H, Sk, Dh = 16, 2048, 256
        return {
            "x": _w((lambda *s: torch.randn(*s, dtype=torch.bfloat16) * 0.05)(B, Sq, D)),
            "k_cache": _w((lambda *s: torch.randn(*s, dtype=torch.bfloat16) * 1.6)(B, H, Sk, Dh)),
            "v_cache": _w((lambda *s: torch.randn(*s, dtype=torch.bfloat16) * 0.2)(B, H, Sk, Dh)),
            "wq": _w((lambda *s: torch.randn(*s, dtype=torch.bfloat16) * 1.6)(D, H * Dh) * (D ** -0.5)),
            "wo": _w((lambda *s: torch.randn(*s, dtype=torch.bfloat16) * 0.2)(H * Dh, D) * ((H * Dh) ** -0.5)),
        }
    _A_in = _A_setup()

    def _B_setup():
        B, S, D, F = 1, 2048, 448, 1792
        return {
            "x": _w((lambda *s: torch.randn(*s, dtype=torch.bfloat16) * 0.05)(B, S, D)),
            "w_gate": _w((lambda *s: torch.randn(*s, dtype=torch.bfloat16) * 0.2)(D, F)),
            "w_up": _w((lambda *s: torch.randn(*s, dtype=torch.bfloat16) * 0.1)(D, F)),
            "w_down": _w((lambda *s: torch.randn(*s, dtype=torch.bfloat16) * 0.1)(F, D)),
        }
    _B_in = _B_setup()

    return {
        "A_x": _A_in["x"],
        "A_k_cache": _A_in["k_cache"],
        "A_v_cache": _A_in["v_cache"],
        "A_wq": _A_in["wq"],
        "A_wo": _A_in["wo"],
        "B_x": _B_in["x"],
        "B_w_gate": _B_in["w_gate"],
        "B_w_up": _B_in["w_up"],
        "B_w_down": _B_in["w_down"],
    }

def reference(A_x, A_k_cache, A_v_cache, A_wq, A_wo, B_x, B_w_gate, B_w_up, B_w_down):
    def _A_ref(x, k_cache, v_cache, wq, wo):
        B, Sq, D = x.shape
        H, Dh = 16, 256
        q = (lambda x, *d: x.permute(*d))((x @ wq).reshape(B, Sq, H, Dh), 0, 2, 1, 3)
        scores = torch.einsum("bhqd,bhkd->bhqk", q, k_cache) * (Dh ** -0.5)
        p = _softmax(scores, axis=-1)
        o = torch.einsum("bhqk,bhkd->bhqd", p, v_cache)
        return (lambda x, *d: x.permute(*d))(o, 0, 2, 1, 3).reshape(B, Sq, H * Dh) @ wo

    def _B_ref(x, w_gate, w_up, w_down):
        g = torch.einsum("bsd,df->bsf", x, w_gate)
        u = torch.einsum("bsd,df->bsf", x, w_up)
        h = _sigmoid(g) * u
        return torch.einsum("bsf,fd->bsd", h, w_down)

    x = A_x
    xn = _layernorm(x, axis=-1)
    s = _A_ref(xn, A_k_cache, A_v_cache, A_wq, A_wo)
    g = _silu(_B_ref(xn, B_w_gate, B_w_up, B_w_down))
    return x + s * g
```

```asm
; @launch grid=(256,1,1) block=(512,1,1) lds=163840
.amdgcn_target "amdgcn-amd-amdhsa--gfx950"
.text
.globl recurrent_scan__mha_block_cached__glu_gated_glu__prompt_kernel
.type recurrent_scan__mha_block_cached__glu_gated_glu__prompt_kernel,@function
.p2align 8
recurrent_scan__mha_block_cached__glu_gated_glu__prompt_kernel:
s_cmp_ge_u32 s2, 256
s_cbranch_scc1 L_end
s_mov_b32 s79, 0
L_restart:
s_load_dwordx16 s[48:63], s[0:1], 0
s_load_dwordx8 s[64:71], s[0:1], 64
s_getpc_b64 s[96:97]
s_lshr_b32 s7, s2, 3
s_lshl_b32 s7, s7, 12
v_lshl_add_u32 v189, v0, 3, s7
v_min_u32 v189, 65864, v189
global_load_dword v251, v189, s[96:97]
v_lshrrev_b32 v1, 6, v0
v_and_b32 v255, 63, v0
v_readfirstlane_b32 s5, v1
s_and_b32 s3, s2, 7
s_lshl_b32 s3, s3, 1
s_bfe_u32 s7, s2, 0x10003
s_add_u32 s3, s3, s7
s_lshr_b32 s91, s2, 4
s_mov_b32 s4, s91
s_and_b32 s6, s5, 3
s_mov_b32 s11, 0x20000
s_mov_b32 s10, 1835008
v_lshrrev_b32 v186, 3, v255
v_and_b32 v185, 7, v255
v_lshlrev_b32 v184, 4, v185
s_movk_i32 s7, 896
v_mad_u32_u24 v184, v186, s7, v184
s_add_u32 s84, s5, s2
s_and_b32 s84, s84, 7
s_and_b32 s75, s2, 1
s_lshl_b32 s7, s4, 3
s_add_u32 s7, s7, s84
s_mul_i32 s80, s7, 14336
v_lshrrev_b32 v250, 4, v0
v_lshlrev_b32 v250, 13, v250
v_and_b32 v2, 15, v0
v_lshl_add_u32 v250, v2, 5, v250
s_mul_i32 s90, s91, 229376
s_mov_b32 s15, 0x20000
s_mov_b32 s19, 0x20000
s_mov_b32 s23, 0x20000
s_mov_b32 s27, 0x20000
s_mov_b32 s31, 0x20000
s_mov_b32 s35, 0x20000
s_mov_b32 s39, 0x20000
s_mov_b32 s43, 0x20000
s_mov_b32 s47, 0x20000
s_mul_i32 s7, s75, 7168
s_add_u32 s81, s80, 7168
s_add_u32 s80, s80, s7
s_sub_u32 s81, s81, s7
s_waitcnt lgkmcnt(0)
s_mov_b32 s8, s48
s_mov_b32 s9, s49
buffer_load_dwordx4 v[128:131], v184, s[8:11], s80 offen offset:0
buffer_load_dwordx4 v[132:135], v184, s[8:11], s80 offen offset:128
buffer_load_dwordx4 v[136:139], v184, s[8:11], s80 offen offset:256
buffer_load_dwordx4 v[140:143], v184, s[8:11], s80 offen offset:384
buffer_load_dwordx4 v[144:147], v184, s[8:11], s80 offen offset:512
buffer_load_dwordx4 v[148:151], v184, s[8:11], s80 offen offset:640
buffer_load_dwordx4 v[152:155], v184, s[8:11], s80 offen offset:768
s_mul_i32 s7, s3, 512
s_add_u32 s20, s54, s7
s_addc_u32 s21, s55, 0
s_sub_u32 s22, 3670016, s7
s_mul_i32 s7, s3, 1048576
s_add_u32 s12, s50, s7
s_addc_u32 s13, s51, 0
s_mov_b32 s14, 1048576
s_mul_i32 s7, s3, 1048576
s_add_u32 s16, s52, s7
s_addc_u32 s17, s53, 0
s_mov_b32 s18, 1048576
s_mul_i32 s7, s3, 229376
s_add_u32 s24, s56, s7
s_addc_u32 s25, s57, 0
s_mov_b32 s26, 229376
s_and_b32 s98, s2, 6
s_bfe_u32 s7, s2, 0x10003
s_add_u32 s98, s98, s7
s_mul_i32 s98, s98, 7
s_and_b32 s99, s2, 1
s_lshl_b32 s7, s99, 2
s_add_u32 s98, s98, s7
s_mul_i32 s7, s98, 64
s_add_u32 s28, s60, s7
s_addc_u32 s29, s61, 0
s_sub_u32 s30, 1605632, s7
s_mul_i32 s7, s98, 64
s_add_u32 s32, s62, s7
s_addc_u32 s33, s63, 0
s_sub_u32 s34, 1605632, s7
s_mul_i32 s7, s98, 28672
s_add_u32 s36, s64, s7
s_addc_u32 s37, s65, 0
s_mov_b32 s38, 114688
s_mul_i32 s7, s99, 28672
s_sub_u32 s38, s38, s7
s_mul_i32 s7, s4, 1835008
s_lshl_b32 s82, s6, 16
s_add_u32 s7, s7, s82
s_lshl_b32 s82, s3, 10
s_add_u32 s7, s7, s82
s_lshr_b32 s82, s5, 2
s_mul_i32 s82, s82, 33554432
s_add_u32 s7, s7, s82
s_add_u32 s40, s70, s7
s_addc_u32 s41, s71, 0
s_mov_b32 s42, 1835008
s_lshl_b32 s7, s4, 2
s_add_u32 s7, s7, s6
s_lshl_b32 s7, s7, 8
s_add_u32 s7, s7, s3
s_lshl_b32 s7, s7, 2
s_lshr_b32 s82, s5, 2
s_lshl_b32 s82, s82, 16
s_add_u32 s7, s7, s82
s_add_u32 s7, s7, 67108864
s_add_u32 s100, s70, s7
s_addc_u32 s101, s71, 0
s_cmp_lt_u32 s6, 2
s_cselect_b32 s44, s12, s16
s_cselect_b32 s45, s13, s17
s_mov_b32 s46, 1048576
s_lshl_b32 s89, s91, 12
s_and_b32 s7, s6, 1
s_lshl_b32 s7, s7, 11
s_add_u32 s89, s89, s7
s_mov_b32 s72, 0x3db8aa3b
s_mov_b32 s74, 0xffff0000
v_lshrrev_b32 v112, 4, v255
v_bfe_u32 v114, v255, 2, 2
v_and_b32 v115, 3, v255
v_lshrrev_b32 v116, 1, v114
v_lshl_add_u32 v116, v112, 1, v116
v_lshlrev_b32 v224, 3, v115
s_movk_i32 s7, 1056
v_mad_u32_u24 v224, v116, s7, v224
v_and_b32_e64 v116, 1, v114
v_lshl_add_u32 v224, v116, 7, v224
v_bfe_u32 v117, v255, 2, 1
v_lshl_add_u32 v116, v115, 1, v117
v_xor_b32 v116, v116, v186
v_lshlrev_b32 v187, 4, v116
v_lshl_add_u32 v187, v115, 8, v187
v_xor_b32_e64 v117, 1, v117
v_lshl_add_u32 v187, v117, 13, v187
s_lshl_b32 s7, s84, 3
s_add_u32 s7, s7, s75
s_lshl_b32 s7, s7, 7
v_add_u32 v187, s7, v187
v_add_u32 v188, 0x10000, v187
v_lshlrev_b32 v116, 1, v112
v_and_b32 v117, 15, v255
v_xor_b32 v116, v116, v117
v_lshlrev_b32 v227, 4, v116
v_lshl_add_u32 v227, v112, 8, v227
s_lshl_b32 s7, s6, 11
v_add_u32 v227, s7, v227
v_add_u32 v228, 0x10000, v227
v_xor_b32 v229, 16, v227
v_xor_b32 v230, 16, v228
v_lshrrev_b32 v185, 2, v255
v_lshlrev_b32 v240, 7, v112
v_and_b32_e64 v116, 7, v255
v_lshl_add_u32 v240, v116, 4, v240
v_bfe_u32 v116, v255, 3, 1
v_lshl_add_u32 v245, v116, 13, v240
v_lshl_add_u32 v240, v116, 9, v240
s_lshl_b32 s7, s6, 16
v_add_u32 v245, s7, v245
s_mul_i32 s77, s6, 2112
s_cmp_ge_u32 s5, 4
s_cbranch_scc1 L_hs
s_mov_b32 s93, 0
v_lshlrev_b32 v252, 5, v255
v_mul_u32_u24 v253, 84, v115
s_movk_i32 s7, 3584
v_mad_u32_u24 v253, v185, s7, v253
v_bfe_u32 v116, v255, 1, 3
v_lshlrev_b32 v117, 2, v116
s_mov_b32 s7, 0xec975320
v_bfe_u32 v117, s7, v117, 4
v_lshlrev_b32_e64 v248, 10, v116
v_lshl_add_u32 v248, v117, 4, v248
v_and_b32_e64 v116, 1, v255
v_lshl_add_u32 v248, v116, 7, v248
v_and_b32_e64 v116, 1, v112
v_lshl_add_u32 v248, v116, 5, v248
v_lshrrev_b32_e64 v116, 1, v112
v_lshl_add_u32 v248, v116, 4, v248
v_add_u32 v249, 67584, v224
v_mov_b32 v116, 135136
v_mov_b32_e64 v117, 0
ds_write_b32 v116, v117
s_branch L_ln
L_hs:
s_mov_b32 s93, 1
s_lshl_b32 s88, s6, 11
v_add_u32_e64 v240, s88, v240
s_lshl_b32 s7, s6, 3
s_lshr_b32 s76, 0xc0703000, s7
s_and_b32 s76, s76, 0xff
s_add_u32 s76, s76, s88
s_lshl_b32 s78, s6, 12
s_movk_i32 s96, -8192
s_movk_i32 s97, -8192
v_and_b32 v116, 1, v112
v_lshlrev_b32 v116, 1, v116
v_xor_b32_e64 v116, v116, v115
v_lshlrev_b32 v242, 4, v116
s_movk_i32 s7, 896
v_mad_u32_u24 v242, v185, s7, v242
v_lshl_add_u32 v117, v112, 3, v114
v_lshlrev_b32 v241, 4, v116
s_movk_i32 s7, 3584
v_mad_u32_u24 v241, v117, s7, v241
s_lshr_b32 s7, s6, 1
s_mul_i32 s7, s7, 114688
v_add_u32 v241, s7, v241
s_bitcmp1_b32 s6, 0
s_cselect_b32 s28, s32, s28
s_cselect_b32 s29, s33, s29
v_lshlrev_b32 v243, 5, v255
v_lshlrev_b32_e64 v249, 4, v255
s_mul_i32 s87, s6, 28672
v_lshlrev_b32_e64 v246, 3, v115
v_lshl_add_u32 v246, v112, 8, v246
v_lshl_add_u32 v246, v114, 6, v246
v_and_b32_e64 v116, 1, v112
v_lshl_add_u32 v246, v116, 5, v246
v_add_u32 v246, 135168, v246
v_xor_b32_e64 v247, 32, v246
v_add_u32 v224, 512, v224
L_ln:
v_add_u32 v225, 50688, v224
v_add_u32 v226, 101376, v224
s_waitcnt vmcnt(6)
buffer_load_dwordx4 v[156:159], v184, s[8:11], s81 offen offset:0
v_lshlrev_b32 v0, 16, v128
v_and_b32 v1, s74, v128
v_mov_b64 v[118:119], v[0:1]
v_pk_mul_f32 v[120:121], v[0:1], v[0:1]
v_lshlrev_b32 v2, 16, v129
v_and_b32 v3, s74, v129
v_pk_add_f32 v[118:119], v[118:119], v[2:3]
v_pk_fma_f32 v[120:121], v[2:3], v[2:3], v[120:121]
v_lshlrev_b32 v4, 16, v130
v_and_b32 v5, s74, v130
v_pk_add_f32 v[118:119], v[118:119], v[4:5]
v_pk_fma_f32 v[120:121], v[4:5], v[4:5], v[120:121]
v_lshlrev_b32 v6, 16, v131
v_and_b32 v7, s74, v131
v_pk_add_f32 v[118:119], v[118:119], v[6:7]
v_pk_fma_f32 v[120:121], v[6:7], v[6:7], v[120:121]
s_waitcnt vmcnt(6)
buffer_load_dwordx4 v[160:163], v184, s[8:11], s81 offen offset:128
v_lshlrev_b32 v8, 16, v132
v_and_b32_e64 v9, s74, v132
v_pk_add_f32 v[118:119], v[118:119], v[8:9]
v_pk_fma_f32 v[120:121], v[8:9], v[8:9], v[120:121]
v_lshlrev_b32 v10, 16, v133
v_and_b32 v11, s74, v133
v_pk_add_f32 v[118:119], v[118:119], v[10:11]
v_pk_fma_f32 v[120:121], v[10:11], v[10:11], v[120:121]
v_lshlrev_b32 v12, 16, v134
v_and_b32 v13, s74, v134
v_pk_add_f32 v[118:119], v[118:119], v[12:13]
v_pk_fma_f32 v[120:121], v[12:13], v[12:13], v[120:121]
v_lshlrev_b32 v14, 16, v135
v_and_b32 v15, s74, v135
v_pk_add_f32 v[118:119], v[118:119], v[14:15]
v_pk_fma_f32 v[120:121], v[14:15], v[14:15], v[120:121]
s_waitcnt vmcnt(6)
buffer_load_dwordx4 v[164:167], v184, s[8:11], s81 offen offset:256
v_lshlrev_b32 v16, 16, v136
v_and_b32_e64 v17, s74, v136
v_pk_add_f32 v[118:119], v[118:119], v[16:17]
v_pk_fma_f32 v[120:121], v[16:17], v[16:17], v[120:121]
v_lshlrev_b32 v18, 16, v137
v_and_b32 v19, s74, v137
v_pk_add_f32 v[118:119], v[118:119], v[18:19]
v_pk_fma_f32 v[120:121], v[18:19], v[18:19], v[120:121]
v_lshlrev_b32 v20, 16, v138
v_and_b32 v21, s74, v138
v_pk_add_f32 v[118:119], v[118:119], v[20:21]
v_pk_fma_f32 v[120:121], v[20:21], v[20:21], v[120:121]
v_lshlrev_b32 v22, 16, v139
v_and_b32 v23, s74, v139
v_pk_add_f32 v[118:119], v[118:119], v[22:23]
v_pk_fma_f32 v[120:121], v[22:23], v[22:23], v[120:121]
s_waitcnt vmcnt(6)
buffer_load_dwordx4 v[168:171], v184, s[8:11], s81 offen offset:384
v_lshlrev_b32 v24, 16, v140
v_and_b32_e64 v25, s74, v140
v_pk_add_f32 v[118:119], v[118:119], v[24:25]
v_pk_fma_f32 v[120:121], v[24:25], v[24:25], v[120:121]
v_lshlrev_b32 v26, 16, v141
v_and_b32 v27, s74, v141
v_pk_add_f32 v[118:119], v[118:119], v[26:27]
v_pk_fma_f32 v[120:121], v[26:27], v[26:27], v[120:121]
v_lshlrev_b32 v28, 16, v142
v_and_b32 v29, s74, v142
v_pk_add_f32 v[118:119], v[118:119], v[28:29]
v_pk_fma_f32 v[120:121], v[28:29], v[28:29], v[120:121]
v_lshlrev_b32 v30, 16, v143
v_and_b32 v31, s74, v143
v_pk_add_f32 v[118:119], v[118:119], v[30:31]
v_pk_fma_f32 v[120:121], v[30:31], v[30:31], v[120:121]
s_waitcnt vmcnt(6)
buffer_load_dwordx4 v[172:175], v184, s[8:11], s81 offen offset:512
v_lshlrev_b32 v32, 16, v144
v_and_b32_e64 v33, s74, v144
v_pk_add_f32 v[118:119], v[118:119], v[32:33]
v_pk_fma_f32 v[120:121], v[32:33], v[32:33], v[120:121]
v_lshlrev_b32 v34, 16, v145
v_and_b32 v35, s74, v145
v_pk_add_f32 v[118:119], v[118:119], v[34:35]
v_pk_fma_f32 v[120:121], v[34:35], v[34:35], v[120:121]
v_lshlrev_b32 v36, 16, v146
v_and_b32 v37, s74, v146
v_pk_add_f32 v[118:119], v[118:119], v[36:37]
v_pk_fma_f32 v[120:121], v[36:37], v[36:37], v[120:121]
v_lshlrev_b32 v38, 16, v147
v_and_b32 v39, s74, v147
v_pk_add_f32 v[118:119], v[118:119], v[38:39]
v_pk_fma_f32 v[120:121], v[38:39], v[38:39], v[120:121]
s_waitcnt vmcnt(6)
buffer_load_dwordx4 v[176:179], v184, s[8:11], s81 offen offset:640
v_lshlrev_b32 v40, 16, v148
v_and_b32_e64 v41, s74, v148
v_pk_add_f32 v[118:119], v[118:119], v[40:41]
v_pk_fma_f32 v[120:121], v[40:41], v[40:41], v[120:121]
v_lshlrev_b32 v42, 16, v149
v_and_b32 v43, s74, v149
v_pk_add_f32 v[118:119], v[118:119], v[42:43]
v_pk_fma_f32 v[120:121], v[42:43], v[42:43], v[120:121]
v_lshlrev_b32 v44, 16, v150
v_and_b32 v45, s74, v150
v_pk_add_f32 v[118:119], v[118:119], v[44:45]
v_pk_fma_f32 v[120:121], v[44:45], v[44:45], v[120:121]
v_lshlrev_b32 v46, 16, v151
v_and_b32 v47, s74, v151
v_pk_add_f32 v[118:119], v[118:119], v[46:47]
v_pk_fma_f32 v[120:121], v[46:47], v[46:47], v[120:121]
s_waitcnt vmcnt(6)
buffer_load_dwordx4 v[180:183], v184, s[8:11], s81 offen offset:768
v_lshlrev_b32 v48, 16, v152
v_and_b32_e64 v49, s74, v152
v_pk_add_f32 v[118:119], v[118:119], v[48:49]
v_pk_fma_f32 v[120:121], v[48:49], v[48:49], v[120:121]
v_lshlrev_b32 v50, 16, v153
v_and_b32 v51, s74, v153
v_pk_add_f32 v[118:119], v[118:119], v[50:51]
v_pk_fma_f32 v[120:121], v[50:51], v[50:51], v[120:121]
v_lshlrev_b32 v52, 16, v154
v_and_b32 v53, s74, v154
v_pk_add_f32 v[118:119], v[118:119], v[52:53]
v_pk_fma_f32 v[120:121], v[52:53], v[52:53], v[120:121]
v_lshlrev_b32 v54, 16, v155
v_and_b32 v55, s74, v155
v_pk_add_f32 v[118:119], v[118:119], v[54:55]
v_pk_fma_f32 v[120:121], v[54:55], v[54:55], v[120:121]
v_add_f32_e64 v118, v118, v119
v_add_f32 v120, v120, v121
s_nop 0
v_add_f32_dpp v118, v118, v118 quad_perm:[1,0,3,2] row_mask:0xf bank_mask:0xf
v_add_f32_dpp v120, v120, v120 quad_perm:[1,0,3,2] row_mask:0xf bank_mask:0xf
s_nop 0
v_add_f32_dpp v118, v118, v118 quad_perm:[2,3,0,1] row_mask:0xf bank_mask:0xf
v_add_f32_dpp v120, v120, v120 quad_perm:[2,3,0,1] row_mask:0xf bank_mask:0xf
s_nop 0
v_add_f32_dpp v118, v118, v118 row_half_mirror row_mask:0xf bank_mask:0xf
v_add_f32_dpp v120, v120, v120 row_half_mirror row_mask:0xf bank_mask:0xf
s_mov_b32 s7, 0x3b124925
v_mul_f32 v118, s7, v118
v_mul_f32 v119, v118, v118
v_fma_f32 v120, v120, s7, -v119
v_max_f32_e64 v120, 0, v120
v_cvt_pk_bf16_f32 v119, v118, v120
v_lshlrev_b32 v118, 16, v119
v_and_b32 v120, s74, v119
v_add_f32 v120, 0x3727c5ac, v120
v_cvt_pk_bf16_f32 v120, v120, v120
v_and_b32_e64 v120, s74, v120
v_sqrt_f32 v120, v120
s_nop 0
v_cvt_pk_bf16_f32 v120, v120, v120
v_and_b32 v120, s74, v120
v_rcp_f32 v120, v120
s_nop 0
v_mul_f32 v118, v118, v120
v_pk_fma_f32 v[0:1], v[0:1], v[120:121], v[118:119] op_sel_hi:[1,0,0] neg_lo:[0,0,1] neg_hi:[0,0,1]
v_pk_fma_f32 v[2:3], v[2:3], v[120:121], v[118:119] op_sel_hi:[1,0,0] neg_lo:[0,0,1] neg_hi:[0,0,1]
v_pk_fma_f32 v[4:5], v[4:5], v[120:121], v[118:119] op_sel_hi:[1,0,0] neg_lo:[0,0,1] neg_hi:[0,0,1]
v_pk_fma_f32 v[6:7], v[6:7], v[120:121], v[118:119] op_sel_hi:[1,0,0] neg_lo:[0,0,1] neg_hi:[0,0,1]
v_cvt_pk_bf16_f32 v128, v0, v1
v_cvt_pk_bf16_f32 v129, v2, v3
v_cvt_pk_bf16_f32 v130, v4, v5
v_cvt_pk_bf16_f32 v131, v6, v7
ds_write_b128 v188, v[128:131] offset:32768
v_pk_fma_f32 v[8:9], v[8:9], v[120:121], v[118:119] op_sel_hi:[1,0,0] neg_lo:[0,0,1] neg_hi:[0,0,1]
v_pk_fma_f32 v[10:11], v[10:11], v[120:121], v[118:119] op_sel_hi:[1,0,0] neg_lo:[0,0,1] neg_hi:[0,0,1]
v_pk_fma_f32 v[12:13], v[12:13], v[120:121], v[118:119] op_sel_hi:[1,0,0] neg_lo:[0,0,1] neg_hi:[0,0,1]
v_pk_fma_f32 v[14:15], v[14:15], v[120:121], v[118:119] op_sel_hi:[1,0,0] neg_lo:[0,0,1] neg_hi:[0,0,1]
v_cvt_pk_bf16_f32 v132, v8, v9
v_cvt_pk_bf16_f32 v133, v10, v11
v_cvt_pk_bf16_f32 v134, v12, v13
v_cvt_pk_bf16_f32 v135, v14, v15
ds_write_b128 v188, v[132:135] offset:16384
v_pk_fma_f32 v[16:17], v[16:17], v[120:121], v[118:119] op_sel_hi:[1,0,0] neg_lo:[0,0,1] neg_hi:[0,0,1]
v_pk_fma_f32 v[18:19], v[18:19], v[120:121], v[118:119] op_sel_hi:[1,0,0] neg_lo:[0,0,1] neg_hi:[0,0,1]
v_pk_fma_f32 v[20:21], v[20:21], v[120:121], v[118:119] op_sel_hi:[1,0,0] neg_lo:[0,0,1] neg_hi:[0,0,1]
v_pk_fma_f32 v[22:23], v[22:23], v[120:121], v[118:119] op_sel_hi:[1,0,0] neg_lo:[0,0,1] neg_hi:[0,0,1]
v_cvt_pk_bf16_f32 v136, v16, v17
v_cvt_pk_bf16_f32 v137, v18, v19
v_cvt_pk_bf16_f32 v138, v20, v21
v_cvt_pk_bf16_f32 v139, v22, v23
ds_write_b128 v188, v[136:139] offset:0
v_pk_fma_f32 v[24:25], v[24:25], v[120:121], v[118:119] op_sel_hi:[1,0,0] neg_lo:[0,0,1] neg_hi:[0,0,1]
v_pk_fma_f32 v[26:27], v[26:27], v[120:121], v[118:119] op_sel_hi:[1,0,0] neg_lo:[0,0,1] neg_hi:[0,0,1]
v_pk_fma_f32 v[28:29], v[28:29], v[120:121], v[118:119] op_sel_hi:[1,0,0] neg_lo:[0,0,1] neg_hi:[0,0,1]
v_pk_fma_f32 v[30:31], v[30:31], v[120:121], v[118:119] op_sel_hi:[1,0,0] neg_lo:[0,0,1] neg_hi:[0,0,1]
v_cvt_pk_bf16_f32 v140, v24, v25
v_cvt_pk_bf16_f32 v141, v26, v27
v_cvt_pk_bf16_f32 v142, v28, v29
v_cvt_pk_bf16_f32 v143, v30, v31
ds_write_b128 v187, v[140:143] offset:49152
v_pk_fma_f32 v[32:33], v[32:33], v[120:121], v[118:119] op_sel_hi:[1,0,0] neg_lo:[0,0,1] neg_hi:[0,0,1]
v_pk_fma_f32 v[34:35], v[34:35], v[120:121], v[118:119] op_sel_hi:[1,0,0] neg_lo:[0,0,1] neg_hi:[0,0,1]
v_pk_fma_f32 v[36:37], v[36:37], v[120:121], v[118:119] op_sel_hi:[1,0,0] neg_lo:[0,0,1] neg_hi:[0,0,1]
v_pk_fma_f32 v[38:39], v[38:39], v[120:121], v[118:119] op_sel_hi:[1,0,0] neg_lo:[0,0,1] neg_hi:[0,0,1]
v_cvt_pk_bf16_f32 v144, v32, v33
v_cvt_pk_bf16_f32 v145, v34, v35
v_cvt_pk_bf16_f32 v146, v36, v37
v_cvt_pk_bf16_f32 v147, v38, v39
ds_write_b128 v187, v[144:147] offset:32768
v_pk_fma_f32 v[40:41], v[40:41], v[120:121], v[118:119] op_sel_hi:[1,0,0] neg_lo:[0,0,1] neg_hi:[0,0,1]
v_pk_fma_f32 v[42:43], v[42:43], v[120:121], v[118:119] op_sel_hi:[1,0,0] neg_lo:[0,0,1] neg_hi:[0,0,1]
v_pk_fma_f32 v[44:45], v[44:45], v[120:121], v[118:119] op_sel_hi:[1,0,0] neg_lo:[0,0,1] neg_hi:[0,0,1]
v_pk_fma_f32 v[46:47], v[46:47], v[120:121], v[118:119] op_sel_hi:[1,0,0] neg_lo:[0,0,1] neg_hi:[0,0,1]
v_cvt_pk_bf16_f32 v148, v40, v41
v_cvt_pk_bf16_f32 v149, v42, v43
v_cvt_pk_bf16_f32 v150, v44, v45
v_cvt_pk_bf16_f32 v151, v46, v47
ds_write_b128 v187, v[148:151] offset:16384
v_pk_fma_f32 v[48:49], v[48:49], v[120:121], v[118:119] op_sel_hi:[1,0,0] neg_lo:[0,0,1] neg_hi:[0,0,1]
v_pk_fma_f32 v[50:51], v[50:51], v[120:121], v[118:119] op_sel_hi:[1,0,0] neg_lo:[0,0,1] neg_hi:[0,0,1]
v_pk_fma_f32 v[52:53], v[52:53], v[120:121], v[118:119] op_sel_hi:[1,0,0] neg_lo:[0,0,1] neg_hi:[0,0,1]
v_pk_fma_f32 v[54:55], v[54:55], v[120:121], v[118:119] op_sel_hi:[1,0,0] neg_lo:[0,0,1] neg_hi:[0,0,1]
v_cvt_pk_bf16_f32 v152, v48, v49
v_cvt_pk_bf16_f32 v153, v50, v51
v_cvt_pk_bf16_f32 v154, v52, v53
v_cvt_pk_bf16_f32 v155, v54, v55
ds_write_b128 v187, v[152:155] offset:0
v_xor_b32 v187, 0x80, v187
v_xor_b32 v188, 0x80, v188
v_mov_b32 v122, 0
v_lshlrev_b32 v123, 7, v255
s_cmp_lg_u32 s79, 0
s_cbranch_scc1 L_norst
s_mov_b64 exec, 0x7f
global_store_dword v123, v122, s[100:101] sc1
s_mov_b64 exec, -1
L_norst:
s_waitcnt vmcnt(6)
v_lshlrev_b32 v56, 16, v156
v_and_b32 v57, s74, v156
v_mov_b64_e64 v[118:119], v[56:57]
v_pk_mul_f32 v[120:121], v[56:57], v[56:57]
buffer_load_dword v251, v250, s[20:23], s90 offen
v_lshlrev_b32 v58, 16, v157
v_and_b32 v59, s74, v157
v_pk_add_f32 v[118:119], v[118:119], v[58:59]
v_pk_fma_f32 v[120:121], v[58:59], v[58:59], v[120:121]
v_lshlrev_b32 v60, 16, v158
v_and_b32 v61, s74, v158
v_pk_add_f32 v[118:119], v[118:119], v[60:61]
v_pk_fma_f32 v[120:121], v[60:61], v[60:61], v[120:121]
v_lshlrev_b32 v62, 16, v159
v_and_b32 v63, s74, v159
v_pk_add_f32 v[118:119], v[118:119], v[62:63]
v_pk_fma_f32 v[120:121], v[62:63], v[62:63], v[120:121]
s_waitcnt vmcnt(6)
v_lshlrev_b32 v64, 16, v160
v_and_b32_e64 v65, s74, v160
v_pk_add_f32 v[118:119], v[118:119], v[64:65]
v_pk_fma_f32 v[120:121], v[64:65], v[64:65], v[120:121]
v_lshlrev_b32 v66, 16, v161
v_and_b32 v67, s74, v161
v_pk_add_f32 v[118:119], v[118:119], v[66:67]
v_pk_fma_f32 v[120:121], v[66:67], v[66:67], v[120:121]
s_lshr_b32 s7, s5, 2
s_lshl_b32 s80, s7, 18
s_mul_i32 s7, s7, 16896
s_add_u32 s7, s7, s77
s_add_u32 m0, s7, 118272
s_nop 0
buffer_load_dwordx4 v245, s[20:23], s80 offen lds
v_lshlrev_b32 v68, 16, v162
v_and_b32 v69, s74, v162
v_pk_add_f32 v[118:119], v[118:119], v[68:69]
v_pk_fma_f32 v[120:121], v[68:69], v[68:69], v[120:121]
v_lshlrev_b32 v70, 16, v163
v_and_b32 v71, s74, v163
v_pk_add_f32 v[118:119], v[118:119], v[70:71]
v_pk_fma_f32 v[120:121], v[70:71], v[70:71], v[120:121]
s_waitcnt vmcnt(6)
v_lshlrev_b32 v72, 16, v164
v_and_b32_e64 v73, s74, v164
v_pk_add_f32 v[118:119], v[118:119], v[72:73]
v_pk_fma_f32 v[120:121], v[72:73], v[72:73], v[120:121]
v_lshlrev_b32 v74, 16, v165
v_and_b32 v75, s74, v165
v_pk_add_f32 v[118:119], v[118:119], v[74:75]
v_pk_fma_f32 v[120:121], v[74:75], v[74:75], v[120:121]
s_addk_i32 m0, 1056
s_addk_i32 s80, 16384
buffer_load_dwordx4 v245, s[20:23], s80 offen lds
v_lshlrev_b32 v76, 16, v166
v_and_b32 v77, s74, v166
v_pk_add_f32 v[118:119], v[118:119], v[76:77]
v_pk_fma_f32 v[120:121], v[76:77], v[76:77], v[120:121]
v_lshlrev_b32 v78, 16, v167
v_and_b32 v79, s74, v167
v_pk_add_f32 v[118:119], v[118:119], v[78:79]
v_pk_fma_f32 v[120:121], v[78:79], v[78:79], v[120:121]
s_waitcnt vmcnt(6)
v_lshlrev_b32 v80, 16, v168
v_and_b32_e64 v81, s74, v168
v_pk_add_f32 v[118:119], v[118:119], v[80:81]
v_pk_fma_f32 v[120:121], v[80:81], v[80:81], v[120:121]
v_lshlrev_b32 v82, 16, v169
v_and_b32 v83, s74, v169
v_pk_add_f32 v[118:119], v[118:119], v[82:83]
v_pk_fma_f32 v[120:121], v[82:83], v[82:83], v[120:121]
s_addk_i32 m0, 7392
s_addk_i32 s80, 16384
buffer_load_dwordx4 v245, s[20:23], s80 offen lds
v_lshlrev_b32 v84, 16, v170
v_and_b32 v85, s74, v170
v_pk_add_f32 v[118:119], v[118:119], v[84:85]
v_pk_fma_f32 v[120:121], v[84:85], v[84:85], v[120:121]
v_lshlrev_b32 v86, 16, v171
v_and_b32 v87, s74, v171
v_pk_add_f32 v[118:119], v[118:119], v[86:87]
v_pk_fma_f32 v[120:121], v[86:87], v[86:87], v[120:121]
s_waitcnt vmcnt(6)
v_lshlrev_b32 v88, 16, v172
v_and_b32_e64 v89, s74, v172
v_pk_add_f32 v[118:119], v[118:119], v[88:89]
v_pk_fma_f32 v[120:121], v[88:89], v[88:89], v[120:121]
v_lshlrev_b32 v90, 16, v173
v_and_b32 v91, s74, v173
v_pk_add_f32 v[118:119], v[118:119], v[90:91]
v_pk_fma_f32 v[120:121], v[90:91], v[90:91], v[120:121]
s_addk_i32 m0, 1056
s_addk_i32 s80, 16384
buffer_load_dwordx4 v245, s[20:23], s80 offen lds
v_lshlrev_b32 v92, 16, v174
v_and_b32 v93, s74, v174
v_pk_add_f32 v[118:119], v[118:119], v[92:93]
v_pk_fma_f32 v[120:121], v[92:93], v[92:93], v[120:121]
v_lshlrev_b32 v94, 16, v175
v_and_b32 v95, s74, v175
v_pk_add_f32 v[118:119], v[118:119], v[94:95]
v_pk_fma_f32 v[120:121], v[94:95], v[94:95], v[120:121]
s_waitcnt vmcnt(6)
v_lshlrev_b32 v96, 16, v176
v_and_b32_e64 v97, s74, v176
v_pk_add_f32 v[118:119], v[118:119], v[96:97]
v_pk_fma_f32 v[120:121], v[96:97], v[96:97], v[120:121]
v_lshlrev_b32 v98, 16, v177
v_and_b32 v99, s74, v177
v_pk_add_f32 v[118:119], v[118:119], v[98:99]
v_pk_fma_f32 v[120:121], v[98:99], v[98:99], v[120:121]
v_lshlrev_b32 v100, 16, v178
v_and_b32 v101, s74, v178
v_pk_add_f32 v[118:119], v[118:119], v[100:101]
v_pk_fma_f32 v[120:121], v[100:101], v[100:101], v[120:121]
v_lshlrev_b32 v102, 16, v179
v_and_b32 v103, s74, v179
v_pk_add_f32 v[118:119], v[118:119], v[102:103]
v_pk_fma_f32 v[120:121], v[102:103], v[102:103], v[120:121]
s_waitcnt vmcnt(5)
v_lshlrev_b32 v104, 16, v180
v_and_b32_e64 v105, s74, v180
v_pk_add_f32 v[118:119], v[118:119], v[104:105]
v_pk_fma_f32 v[120:121], v[104:105], v[104:105], v[120:121]
v_lshlrev_b32 v106, 16, v181
v_and_b32 v107, s74, v181
v_pk_add_f32 v[118:119], v[118:119], v[106:107]
v_pk_fma_f32 v[120:121], v[106:107], v[106:107], v[120:121]
v_lshlrev_b32 v108, 16, v182
v_and_b32 v109, s74, v182
v_pk_add_f32 v[118:119], v[118:119], v[108:109]
v_pk_fma_f32 v[120:121], v[108:109], v[108:109], v[120:121]
v_lshlrev_b32 v110, 16, v183
v_and_b32 v111, s74, v183
v_pk_add_f32 v[118:119], v[118:119], v[110:111]
v_pk_fma_f32 v[120:121], v[110:111], v[110:111], v[120:121]
v_add_f32_e64 v118, v118, v119
v_add_f32 v120, v120, v121
s_nop 0
v_add_f32_dpp v118, v118, v118 quad_perm:[1,0,3,2] row_mask:0xf bank_mask:0xf
v_add_f32_dpp v120, v120, v120 quad_perm:[1,0,3,2] row_mask:0xf bank_mask:0xf
s_nop 0
v_add_f32_dpp v118, v118, v118 quad_perm:[2,3,0,1] row_mask:0xf bank_mask:0xf
v_add_f32_dpp v120, v120, v120 quad_perm:[2,3,0,1] row_mask:0xf bank_mask:0xf
s_nop 0
v_add_f32_dpp v118, v118, v118 row_half_mirror row_mask:0xf bank_mask:0xf
v_add_f32_dpp v120, v120, v120 row_half_mirror row_mask:0xf bank_mask:0xf
s_mov_b32 s7, 0x3b124925
v_mul_f32 v118, s7, v118
v_mul_f32 v119, v118, v118
v_fma_f32 v120, v120, s7, -v119
v_max_f32_e64 v120, 0, v120
v_cvt_pk_bf16_f32 v119, v118, v120
v_lshlrev_b32 v118, 16, v119
v_and_b32 v120, s74, v119
v_add_f32 v120, 0x3727c5ac, v120
v_cvt_pk_bf16_f32 v120, v120, v120
v_and_b32_e64 v120, s74, v120
v_sqrt_f32 v120, v120
s_nop 0
v_cvt_pk_bf16_f32 v120, v120, v120
v_and_b32 v120, s74, v120
v_rcp_f32 v120, v120
s_nop 0
v_mul_f32 v118, v118, v120
v_pk_fma_f32 v[56:57], v[56:57], v[120:121], v[118:119] op_sel_hi:[1,0,0] neg_lo:[0,0,1] neg_hi:[0,0,1]
v_pk_fma_f32 v[58:59], v[58:59], v[120:121], v[118:119] op_sel_hi:[1,0,0] neg_lo:[0,0,1] neg_hi:[0,0,1]
v_pk_fma_f32 v[60:61], v[60:61], v[120:121], v[118:119] op_sel_hi:[1,0,0] neg_lo:[0,0,1] neg_hi:[0,0,1]
v_pk_fma_f32 v[62:63], v[62:63], v[120:121], v[118:119] op_sel_hi:[1,0,0] neg_lo:[0,0,1] neg_hi:[0,0,1]
v_cvt_pk_bf16_f32 v156, v56, v57
v_cvt_pk_bf16_f32 v157, v58, v59
v_cvt_pk_bf16_f32 v158, v60, v61
v_cvt_pk_bf16_f32 v159, v62, v63
ds_write_b128 v188, v[156:159] offset:32768
v_pk_fma_f32 v[64:65], v[64:65], v[120:121], v[118:119] op_sel_hi:[1,0,0] neg_lo:[0,0,1] neg_hi:[0,0,1]
v_pk_fma_f32 v[66:67], v[66:67], v[120:121], v[118:119] op_sel_hi:[1,0,0] neg_lo:[0,0,1] neg_hi:[0,0,1]
v_pk_fma_f32 v[68:69], v[68:69], v[120:121], v[118:119] op_sel_hi:[1,0,0] neg_lo:[0,0,1] neg_hi:[0,0,1]
v_pk_fma_f32 v[70:71], v[70:71], v[120:121], v[118:119] op_sel_hi:[1,0,0] neg_lo:[0,0,1] neg_hi:[0,0,1]
v_cvt_pk_bf16_f32 v160, v64, v65
v_cvt_pk_bf16_f32 v161, v66, v67
v_cvt_pk_bf16_f32 v162, v68, v69
v_cvt_pk_bf16_f32 v163, v70, v71
ds_write_b128 v188, v[160:163] offset:16384
v_pk_fma_f32 v[72:73], v[72:73], v[120:121], v[118:119] op_sel_hi:[1,0,0] neg_lo:[0,0,1] neg_hi:[0,0,1]
v_pk_fma_f32 v[74:75], v[74:75], v[120:121], v[118:119] op_sel_hi:[1,0,0] neg_lo:[0,0,1] neg_hi:[0,0,1]
v_pk_fma_f32 v[76:77], v[76:77], v[120:121], v[118:119] op_sel_hi:[1,0,0] neg_lo:[0,0,1] neg_hi:[0,0,1]
v_pk_fma_f32 v[78:79], v[78:79], v[120:121], v[118:119] op_sel_hi:[1,0,0] neg_lo:[0,0,1] neg_hi:[0,0,1]
v_cvt_pk_bf16_f32 v164, v72, v73
v_cvt_pk_bf16_f32 v165, v74, v75
v_cvt_pk_bf16_f32 v166, v76, v77
v_cvt_pk_bf16_f32 v167, v78, v79
ds_write_b128 v188, v[164:167] offset:0
v_pk_fma_f32 v[80:81], v[80:81], v[120:121], v[118:119] op_sel_hi:[1,0,0] neg_lo:[0,0,1] neg_hi:[0,0,1]
v_pk_fma_f32 v[82:83], v[82:83], v[120:121], v[118:119] op_sel_hi:[1,0,0] neg_lo:[0,0,1] neg_hi:[0,0,1]
v_pk_fma_f32 v[84:85], v[84:85], v[120:121], v[118:119] op_sel_hi:[1,0,0] neg_lo:[0,0,1] neg_hi:[0,0,1]
v_pk_fma_f32 v[86:87], v[86:87], v[120:121], v[118:119] op_sel_hi:[1,0,0] neg_lo:[0,0,1] neg_hi:[0,0,1]
v_cvt_pk_bf16_f32 v168, v80, v81
v_cvt_pk_bf16_f32 v169, v82, v83
v_cvt_pk_bf16_f32 v170, v84, v85
v_cvt_pk_bf16_f32 v171, v86, v87
ds_write_b128 v187, v[168:171] offset:49152
v_pk_fma_f32 v[88:89], v[88:89], v[120:121], v[118:119] op_sel_hi:[1,0,0] neg_lo:[0,0,1] neg_hi:[0,0,1]
v_pk_fma_f32 v[90:91], v[90:91], v[120:121], v[118:119] op_sel_hi:[1,0,0] neg_lo:[0,0,1] neg_hi:[0,0,1]
v_pk_fma_f32 v[92:93], v[92:93], v[120:121], v[118:119] op_sel_hi:[1,0,0] neg_lo:[0,0,1] neg_hi:[0,0,1]
v_pk_fma_f32 v[94:95], v[94:95], v[120:121], v[118:119] op_sel_hi:[1,0,0] neg_lo:[0,0,1] neg_hi:[0,0,1]
v_cvt_pk_bf16_f32 v172, v88, v89
v_cvt_pk_bf16_f32 v173, v90, v91
v_cvt_pk_bf16_f32 v174, v92, v93
v_cvt_pk_bf16_f32 v175, v94, v95
ds_write_b128 v187, v[172:175] offset:32768
v_pk_fma_f32 v[96:97], v[96:97], v[120:121], v[118:119] op_sel_hi:[1,0,0] neg_lo:[0,0,1] neg_hi:[0,0,1]
v_pk_fma_f32 v[98:99], v[98:99], v[120:121], v[118:119] op_sel_hi:[1,0,0] neg_lo:[0,0,1] neg_hi:[0,0,1]
v_pk_fma_f32 v[100:101], v[100:101], v[120:121], v[118:119] op_sel_hi:[1,0,0] neg_lo:[0,0,1] neg_hi:[0,0,1]
v_pk_fma_f32 v[102:103], v[102:103], v[120:121], v[118:119] op_sel_hi:[1,0,0] neg_lo:[0,0,1] neg_hi:[0,0,1]
v_cvt_pk_bf16_f32 v176, v96, v97
v_cvt_pk_bf16_f32 v177, v98, v99
v_cvt_pk_bf16_f32 v178, v100, v101
v_cvt_pk_bf16_f32 v179, v102, v103
ds_write_b128 v187, v[176:179] offset:16384
v_pk_fma_f32 v[104:105], v[104:105], v[120:121], v[118:119] op_sel_hi:[1,0,0] neg_lo:[0,0,1] neg_hi:[0,0,1]
v_pk_fma_f32 v[106:107], v[106:107], v[120:121], v[118:119] op_sel_hi:[1,0,0] neg_lo:[0,0,1] neg_hi:[0,0,1]
v_pk_fma_f32 v[108:109], v[108:109], v[120:121], v[118:119] op_sel_hi:[1,0,0] neg_lo:[0,0,1] neg_hi:[0,0,1]
v_pk_fma_f32 v[110:111], v[110:111], v[120:121], v[118:119] op_sel_hi:[1,0,0] neg_lo:[0,0,1] neg_hi:[0,0,1]
v_cvt_pk_bf16_f32 v180, v104, v105
v_cvt_pk_bf16_f32 v181, v106, v107
v_cvt_pk_bf16_f32 v182, v108, v109
v_cvt_pk_bf16_f32 v183, v110, v111
ds_write_b128 v187, v[180:183] offset:0
s_waitcnt vmcnt(0)
s_waitcnt lgkmcnt(0)
s_barrier
ds_read_b128 v[0:3], v228 offset:40960
ds_read_b128 v[4:7], v228 offset:41984
ds_read_b128 v[8:11], v230 offset:32768
ds_read_b128 v[12:15], v230 offset:33792
ds_read_b128 v[16:19], v228 offset:24576
ds_read_b128 v[20:23], v228 offset:25600
ds_read_b128 v[24:27], v230 offset:16384
ds_read_b128 v[28:31], v230 offset:17408
ds_read_b128 v[32:35], v228 offset:8192
ds_read_b128 v[36:39], v228 offset:9216
ds_read_b128 v[40:43], v230 offset:0
ds_read_b128 v[44:47], v230 offset:1024
ds_read_b128 v[48:51], v227 offset:57344
ds_read_b128 v[52:55], v227 offset:58368
ds_read_b128 v[56:59], v229 offset:49152
ds_read_b128 v[60:63], v229 offset:50176
s_cmp_eq_u32 s93, 1
s_cbranch_scc1 L_helper
ds_read_b64_tr_b16 v[192:193], v226 offset:16896
ds_read_b64_tr_b16 v[194:195], v226 offset:25344
ds_read_b64_tr_b16 v[196:197], v226 offset:16928
ds_read_b64_tr_b16 v[198:199], v226 offset:25376
ds_read_b64_tr_b16 v[200:201], v226 offset:16960
ds_read_b64_tr_b16 v[202:203], v226 offset:25408
ds_read_b64_tr_b16 v[204:205], v226 offset:16992
ds_read_b64_tr_b16 v[206:207], v226 offset:25440
ds_read_b64_tr_b16 v[208:209], v226 offset:17152
ds_read_b64_tr_b16 v[210:211], v226 offset:25600
ds_read_b64_tr_b16 v[212:213], v226 offset:17184
ds_read_b64_tr_b16 v[214:215], v226 offset:25632
s_waitcnt lgkmcnt(12)
s_barrier
s_waitcnt lgkmcnt(10)
v_mfma_f32_16x16x32_bf16 v[128:131], v[192:195], v[0:3], 0
ds_read_b128 v[64:67], v227 offset:40960
ds_read_b128 v[68:71], v227 offset:41984
v_mfma_f32_16x16x32_bf16 v[136:139], v[192:195], v[4:7], 0
ds_read_b64_tr_b16 v[192:193], v226 offset:17216
ds_read_b64_tr_b16 v[194:195], v226 offset:25664
s_waitcnt lgkmcnt(12)
v_mfma_f32_16x16x32_bf16 v[140:143], v[196:199], v[4:7], 0
ds_read_b128 v[72:75], v229 offset:32768
ds_read_b128 v[76:79], v229 offset:33792
v_mfma_f32_16x16x32_bf16 v[132:135], v[196:199], v[0:3], 0
ds_read_b64_tr_b16 v[196:197], v226 offset:17248
ds_read_b64_tr_b16 v[198:199], v226 offset:25696
s_waitcnt lgkmcnt(14)
v_mfma_f32_16x16x32_bf16 v[144:147], v[200:203], v[0:3], 0
ds_read_b128 v[80:83], v227 offset:24576
ds_read_b128 v[84:87], v227 offset:25600
s_waitcnt lgkmcnt(10)
v_mfma_f32_16x16x32_bf16 v[152:155], v[200:203], v[4:7], 0
ds_read_b64_tr_b16 v[200:201], v226 offset:33792
ds_read_b64_tr_b16 v[202:203], v226 offset:42240
v_mfma_f32_16x16x32_bf16 v[156:159], v[204:207], v[4:7], 0
ds_read_b128 v[88:91], v229 offset:16384
ds_read_b128 v[92:95], v229 offset:17408
v_mfma_f32_16x16x32_bf16 v[148:151], v[204:207], v[0:3], 0
ds_read_b64_tr_b16 v[204:205], v226 offset:33824
ds_read_b64_tr_b16 v[206:207], v226 offset:42272
v_mfma_f32_16x16x32_bf16 v[160:163], v[208:211], v[0:3], 0
ds_read_b128 v[96:99], v227 offset:8192
ds_read_b128 v[100:103], v227 offset:9216
v_mfma_f32_16x16x32_bf16 v[168:171], v[208:211], v[4:7], 0
ds_read_b64_tr_b16 v[208:209], v226 offset:33856
ds_read_b64_tr_b16 v[210:211], v226 offset:42304
v_mfma_f32_16x16x32_bf16 v[172:175], v[212:215], v[4:7], 0
ds_read_b128 v[104:107], v229 offset:0
ds_read_b128 v[108:111], v229 offset:1024
s_waitcnt lgkmcnt(10)
v_mfma_f32_16x16x32_bf16 v[164:167], v[212:215], v[0:3], 0
ds_read_b64_tr_b16 v[212:213], v226 offset:33888
ds_read_b64_tr_b16 v[214:215], v226 offset:42336
v_mfma_f32_16x16x32_bf16 v[176:179], v[192:195], v[0:3], 0
v_mfma_f32_16x16x32_bf16 v[184:187], v[192:195], v[4:7], 0
ds_read_b64_tr_b16 v[192:193], v226 offset:34048
ds_read_b64_tr_b16 v[194:195], v226 offset:42496
v_mfma_f32_16x16x32_bf16 v[188:191], v[196:199], v[4:7], 0
v_mfma_f32_16x16x32_bf16 v[180:183], v[196:199], v[0:3], 0
ds_read_b64_tr_b16 v[196:197], v226 offset:34080
ds_read_b64_tr_b16 v[198:199], v226 offset:42528
v_mfma_f32_16x16x32_bf16 v[128:131], v[200:203], v[8:11], v[128:131]
v_mov_b64 v[0:1], 0
s_waitcnt lgkmcnt(4)
v_mfma_f32_16x16x32_bf16 v[136:139], v[200:203], v[12:15], v[136:139]
ds_read_b64_tr_b16 v[200:201], v226 offset:34112
ds_read_b64_tr_b16 v[202:203], v226 offset:42560
v_mfma_f32_16x16x32_bf16 v[140:143], v[204:207], v[12:15], v[140:143]
v_mov_b64_e64 v[2:3], 0
v_mfma_f32_16x16x32_bf16 v[132:135], v[204:207], v[8:11], v[132:135]
ds_read_b64_tr_b16 v[204:205], v226 offset:34144
ds_read_b64_tr_b16 v[206:207], v226 offset:42592
v_mfma_f32_16x16x32_bf16 v[144:147], v[208:211], v[8:11], v[144:147]
v_mov_b64_e64 v[4:5], 0
v_mfma_f32_16x16x32_bf16 v[152:155], v[208:211], v[12:15], v[152:155]
s_barrier
s_or_b32 s7, s79, s6
s_cbranch_scc1 L_noarr
s_lshl_b32 s7, s4, 4
v_mov_b32_e64 v228, s7
v_mov_b32 v229, 1
s_mov_b64 exec, 1
global_atomic_add v228, v229, s[68:69] sc1
s_mov_b64 exec, -1
L_noarr:
ds_read_b64_tr_b16 v[208:209], v225 offset:33792
ds_read_b64_tr_b16 v[210:211], v225 offset:42240
v_mfma_f32_16x16x32_bf16 v[156:159], v[212:215], v[12:15], v[156:159]
v_mov_b64_e64 v[6:7], 0
s_waitcnt lgkmcnt(4)
v_mfma_f32_16x16x32_bf16 v[148:151], v[212:215], v[8:11], v[148:151]
ds_read_b64_tr_b16 v[212:213], v225 offset:33824
ds_read_b64_tr_b16 v[214:215], v225 offset:42272
v_mfma_f32_16x16x32_bf16 v[160:163], v[192:195], v[8:11], v[160:163]
v_mov_b64_e64 v[112:113], 0
v_mfma_f32_16x16x32_bf16 v[168:171], v[192:195], v[12:15], v[168:171]
ds_read_b64_tr_b16 v[192:193], v225 offset:33856
ds_read_b64_tr_b16 v[194:195], v225 offset:42304
v_mfma_f32_16x16x32_bf16 v[172:175], v[196:199], v[12:15], v[172:175]
v_mov_b64_e64 v[114:115], 0
v_mfma_f32_16x16x32_bf16 v[164:167], v[196:199], v[8:11], v[164:167]
ds_read_b64_tr_b16 v[196:197], v225 offset:33888
ds_read_b64_tr_b16 v[198:199], v225 offset:42336
v_mfma_f32_16x16x32_bf16 v[176:179], v[200:203], v[8:11], v[176:179]
s_waitcnt lgkmcnt(4)
s_nop 0
v_mfma_f32_16x16x32_bf16 v[184:187], v[200:203], v[12:15], v[184:187]
ds_read_b64_tr_b16 v[200:201], v225 offset:34048
ds_read_b64_tr_b16 v[202:203], v225 offset:42496
v_mfma_f32_16x16x32_bf16 v[188:191], v[204:207], v[12:15], v[188:191]
v_mfma_f32_16x16x32_bf16 v[180:183], v[204:207], v[8:11], v[180:183]
ds_read_b64_tr_b16 v[204:205], v225 offset:34080
ds_read_b64_tr_b16 v[206:207], v225 offset:42528
v_mfma_f32_16x16x32_bf16 v[128:131], v[208:211], v[16:19], v[128:131]
v_mov_b64_e64 v[8:9], 0
v_mfma_f32_16x16x32_bf16 v[136:139], v[208:211], v[20:23], v[136:139]
ds_read_b64_tr_b16 v[208:209], v225 offset:34112
ds_read_b64_tr_b16 v[210:211], v225 offset:42560
v_mfma_f32_16x16x32_bf16 v[140:143], v[212:215], v[20:23], v[140:143]
v_mov_b64 v[10:11], 0
s_waitcnt lgkmcnt(4)
v_mfma_f32_16x16x32_bf16 v[132:135], v[212:215], v[16:19], v[132:135]
ds_read_b64_tr_b16 v[212:213], v225 offset:34144
ds_read_b64_tr_b16 v[214:215], v225 offset:42592
v_mfma_f32_16x16x32_bf16 v[144:147], v[192:195], v[16:19], v[144:147]
v_mov_b64_e64 v[12:13], 0
v_mfma_f32_16x16x32_bf16 v[152:155], v[192:195], v[20:23], v[152:155]
ds_read_b64_tr_b16 v[192:193], v225 offset:0
ds_read_b64_tr_b16 v[194:195], v225 offset:8448
v_mfma_f32_16x16x32_bf16 v[156:159], v[196:199], v[20:23], v[156:159]
v_mov_b64_e64 v[14:15], 0
v_mfma_f32_16x16x32_bf16 v[148:151], v[196:199], v[16:19], v[148:151]
ds_read_b64_tr_b16 v[196:197], v225 offset:32
ds_read_b64_tr_b16 v[198:199], v225 offset:8480
v_mfma_f32_16x16x32_bf16 v[160:163], v[200:203], v[16:19], v[160:163]
v_mov_b64 v[116:117], 0
s_waitcnt lgkmcnt(4)
v_mfma_f32_16x16x32_bf16 v[168:171], v[200:203], v[20:23], v[168:171]
ds_read_b64_tr_b16 v[200:201], v225 offset:64
ds_read_b64_tr_b16 v[202:203], v225 offset:8512
v_mfma_f32_16x16x32_bf16 v[172:175], v[204:207], v[20:23], v[172:175]
v_mov_b64_e64 v[118:119], 0
v_mfma_f32_16x16x32_bf16 v[164:167], v[204:207], v[16:19], v[164:167]
ds_read_b64_tr_b16 v[204:205], v225 offset:96
ds_read_b64_tr_b16 v[206:207], v225 offset:8544
v_mfma_f32_16x16x32_bf16 v[176:179], v[208:211], v[16:19], v[176:179]
v_mfma_f32_16x16x32_bf16 v[184:187], v[208:211], v[20:23], v[184:187]
ds_read_b64_tr_b16 v[208:209], v225 offset:256
ds_read_b64_tr_b16 v[210:211], v225 offset:8704
v_mfma_f32_16x16x32_bf16 v[188:191], v[212:215], v[20:23], v[188:191]
s_waitcnt lgkmcnt(4)
s_nop 0
v_mfma_f32_16x16x32_bf16 v[180:183], v[212:215], v[16:19], v[180:183]
ds_read_b64_tr_b16 v[212:213], v225 offset:288
ds_read_b64_tr_b16 v[214:215], v225 offset:8736
v_mfma_f32_16x16x32_bf16 v[128:131], v[192:195], v[24:27], v[128:131]
v_mov_b64_e64 v[16:17], 0
v_mfma_f32_16x16x32_bf16 v[136:139], v[192:195], v[28:31], v[136:139]
ds_read_b64_tr_b16 v[192:193], v225 offset:320
ds_read_b64_tr_b16 v[194:195], v225 offset:8768
v_mfma_f32_16x16x32_bf16 v[140:143], v[196:199], v[28:31], v[140:143]
v_mov_b64_e64 v[18:19], 0
v_mfma_f32_16x16x32_bf16 v[132:135], v[196:199], v[24:27], v[132:135]
ds_read_b64_tr_b16 v[196:197], v225 offset:352
ds_read_b64_tr_b16 v[198:199], v225 offset:8800
v_mfma_f32_16x16x32_bf16 v[144:147], v[200:203], v[24:27], v[144:147]
v_mov_b64 v[20:21], 0
s_waitcnt lgkmcnt(4)
v_mfma_f32_16x16x32_bf16 v[152:155], v[200:203], v[28:31], v[152:155]
s_barrier
ds_read_b64_tr_b16 v[200:201], v226 offset:0
ds_read_b64_tr_b16 v[202:203], v226 offset:8448
v_mfma_f32_16x16x32_bf16 v[156:159], v[204:207], v[28:31], v[156:159]
v_mov_b64 v[22:23], 0
v_mfma_f32_16x16x32_bf16 v[148:151], v[204:207], v[24:27], v[148:151]
ds_read_b64_tr_b16 v[204:205], v226 offset:32
ds_read_b64_tr_b16 v[206:207], v226 offset:8480
v_mfma_f32_16x16x32_bf16 v[160:163], v[208:211], v[24:27], v[160:163]
v_mov_b64_e64 v[120:121], 0
v_mfma_f32_16x16x32_bf16 v[168:171], v[208:211], v[28:31], v[168:171]
ds_read_b64_tr_b16 v[208:209], v226 offset:64
ds_read_b64_tr_b16 v[210:211], v226 offset:8512
v_mfma_f32_16x16x32_bf16 v[172:175], v[212:215], v[28:31], v[172:175]
v_mov_b64 v[122:123], 0
s_waitcnt lgkmcnt(4)
v_mfma_f32_16x16x32_bf16 v[164:167], v[212:215], v[24:27], v[164:167]
ds_read_b64_tr_b16 v[212:213], v226 offset:96
ds_read_b64_tr_b16 v[214:215], v226 offset:8544
v_mfma_f32_16x16x32_bf16 v[176:179], v[192:195], v[24:27], v[176:179]
v_mfma_f32_16x16x32_bf16 v[184:187], v[192:195], v[28:31], v[184:187]
ds_read_b64_tr_b16 v[192:193], v226 offset:256
ds_read_b64_tr_b16 v[194:195], v226 offset:8704
v_mfma_f32_16x16x32_bf16 v[188:191], v[196:199], v[28:31], v[188:191]
v_mfma_f32_16x16x32_bf16 v[180:183], v[196:199], v[24:27], v[180:183]
ds_read_b64_tr_b16 v[196:197], v226 offset:288
ds_read_b64_tr_b16 v[198:199], v226 offset:8736
v_mfma_f32_16x16x32_bf16 v[128:131], v[200:203], v[32:35], v[128:131]
v_mov_b64 v[24:25], 0
s_waitcnt lgkmcnt(4)
v_mfma_f32_16x16x32_bf16 v[136:139], v[200:203], v[36:39], v[136:139]
ds_read_b64_tr_b16 v[200:201], v226 offset:320
ds_read_b64_tr_b16 v[202:203], v226 offset:8768
v_mfma_f32_16x16x32_bf16 v[140:143], v[204:207], v[36:39], v[140:143]
v_mov_b64_e64 v[26:27], 0
v_mfma_f32_16x16x32_bf16 v[132:135], v[204:207], v[32:35], v[132:135]
ds_read_b64_tr_b16 v[204:205], v226 offset:352
ds_read_b64_tr_b16 v[206:207], v226 offset:8800
v_mfma_f32_16x16x32_bf16 v[144:147], v[208:211], v[32:35], v[144:147]
v_mov_b64_e64 v[28:29], 0
v_mfma_f32_16x16x32_bf16 v[152:155], v[208:211], v[36:39], v[152:155]
ds_read_b64_tr_b16 v[208:209], v225 offset:16896
ds_read_b64_tr_b16 v[210:211], v225 offset:25344
v_mfma_f32_16x16x32_bf16 v[156:159], v[212:215], v[36:39], v[156:159]
v_mov_b64 v[30:31], 0
s_waitcnt lgkmcnt(4)
v_mfma_f32_16x16x32_bf16 v[148:151], v[212:215], v[32:35], v[148:151]
ds_read_b64_tr_b16 v[212:213], v225 offset:16928
ds_read_b64_tr_b16 v[214:215], v225 offset:25376
v_mfma_f32_16x16x32_bf16 v[160:163], v[192:195], v[32:35], v[160:163]
v_mov_b64_e64 v[124:125], 0
v_mfma_f32_16x16x32_bf16 v[168:171], v[192:195], v[36:39], v[168:171]
ds_read_b64_tr_b16 v[192:193], v225 offset:16960
ds_read_b64_tr_b16 v[194:195], v225 offset:25408
v_mfma_f32_16x16x32_bf16 v[172:175], v[196:199], v[36:39], v[172:175]
v_mov_b64_e64 v[126:127], 0
v_mfma_f32_16x16x32_bf16 v[164:167], v[196:199], v[32:35], v[164:167]
ds_read_b64_tr_b16 v[196:197], v225 offset:16992
ds_read_b64_tr_b16 v[198:199], v225 offset:25440
v_mfma_f32_16x16x32_bf16 v[176:179], v[200:203], v[32:35], v[176:179]
s_waitcnt lgkmcnt(4)
s_nop 0
v_mfma_f32_16x16x32_bf16 v[184:187], v[200:203], v[36:39], v[184:187]
ds_read_b64_tr_b16 v[200:201], v225 offset:17152
ds_read_b64_tr_b16 v[202:203], v225 offset:25600
v_mfma_f32_16x16x32_bf16 v[188:191], v[204:207], v[36:39], v[188:191]
v_mfma_f32_16x16x32_bf16 v[180:183], v[204:207], v[32:35], v[180:183]
ds_read_b64_tr_b16 v[204:205], v225 offset:17184
ds_read_b64_tr_b16 v[206:207], v225 offset:25632
v_mfma_f32_16x16x32_bf16 v[128:131], v[208:211], v[40:43], v[128:131]
v_mov_b64_e64 v[32:33], 0
v_mfma_f32_16x16x32_bf16 v[136:139], v[208:211], v[44:47], v[136:139]
ds_read_b64_tr_b16 v[208:209], v225 offset:17216
ds_read_b64_tr_b16 v[210:211], v225 offset:25664
v_mfma_f32_16x16x32_bf16 v[140:143], v[212:215], v[44:47], v[140:143]
v_mov_b64 v[34:35], 0
s_waitcnt lgkmcnt(4)
v_mfma_f32_16x16x32_bf16 v[132:135], v[212:215], v[40:43], v[132:135]
ds_read_b64_tr_b16 v[212:213], v225 offset:17248
ds_read_b64_tr_b16 v[214:215], v225 offset:25696
v_mfma_f32_16x16x32_bf16 v[144:147], v[192:195], v[40:43], v[144:147]
v_mov_b64_e64 v[36:37], 0
v_mfma_f32_16x16x32_bf16 v[152:155], v[192:195], v[44:47], v[152:155]
s_barrier
ds_read_b64_tr_b16 v[192:193], v224 offset:0
ds_read_b64_tr_b16 v[194:195], v224 offset:8448
v_mfma_f32_16x16x32_bf16 v[156:159], v[196:199], v[44:47], v[156:159]
v_mov_b64 v[38:39], 0
v_mfma_f32_16x16x32_bf16 v[148:151], v[196:199], v[40:43], v[148:151]
ds_read_b64_tr_b16 v[196:197], v224 offset:32
ds_read_b64_tr_b16 v[198:199], v224 offset:8480
v_mfma_f32_16x16x32_bf16 v[160:163], v[200:203], v[40:43], v[160:163]
s_waitcnt lgkmcnt(4)
s_nop 0
v_mfma_f32_16x16x32_bf16 v[168:171], v[200:203], v[44:47], v[168:171]
ds_read_b64_tr_b16 v[200:201], v224 offset:64
ds_read_b64_tr_b16 v[202:203], v224 offset:8512
v_mfma_f32_16x16x32_bf16 v[172:175], v[204:207], v[44:47], v[172:175]
v_mfma_f32_16x16x32_bf16 v[164:167], v[204:207], v[40:43], v[164:167]
ds_read_b64_tr_b16 v[204:205], v224 offset:96
ds_read_b64_tr_b16 v[206:207], v224 offset:8544
v_mfma_f32_16x16x32_bf16 v[176:179], v[208:211], v[40:43], v[176:179]
v_mfma_f32_16x16x32_bf16 v[184:187], v[208:211], v[44:47], v[184:187]
ds_read_b64_tr_b16 v[208:209], v224 offset:256
ds_read_b64_tr_b16 v[210:211], v224 offset:8704
v_mfma_f32_16x16x32_bf16 v[188:191], v[212:215], v[44:47], v[188:191]
s_waitcnt lgkmcnt(4)
s_nop 0
v_mfma_f32_16x16x32_bf16 v[180:183], v[212:215], v[40:43], v[180:183]
ds_read_b64_tr_b16 v[212:213], v224 offset:288
ds_read_b64_tr_b16 v[214:215], v224 offset:8736
v_mfma_f32_16x16x32_bf16 v[128:131], v[192:195], v[48:51], v[128:131]
v_mov_b64_e64 v[40:41], 0
v_mfma_f32_16x16x32_bf16 v[136:139], v[192:195], v[52:55], v[136:139]
ds_read_b64_tr_b16 v[192:193], v224 offset:320
ds_read_b64_tr_b16 v[194:195], v224 offset:8768
v_mfma_f32_16x16x32_bf16 v[140:143], v[196:199], v[52:55], v[140:143]
v_mov_b64_e64 v[42:43], 0
v_mfma_f32_16x16x32_bf16 v[132:135], v[196:199], v[48:51], v[132:135]
ds_read_b64_tr_b16 v[196:197], v224 offset:352
ds_read_b64_tr_b16 v[198:199], v224 offset:8800
v_mfma_f32_16x16x32_bf16 v[144:147], v[200:203], v[48:51], v[144:147]
v_mov_b64 v[44:45], 0
s_waitcnt lgkmcnt(4)
v_mfma_f32_16x16x32_bf16 v[152:155], v[200:203], v[52:55], v[152:155]
ds_read_b64_tr_b16 v[200:201], v224 offset:16896
ds_read_b64_tr_b16 v[202:203], v224 offset:25344
v_mfma_f32_16x16x32_bf16 v[156:159], v[204:207], v[52:55], v[156:159]
v_mov_b64_e64 v[46:47], 0
v_mfma_f32_16x16x32_bf16 v[148:151], v[204:207], v[48:51], v[148:151]
ds_read_b64_tr_b16 v[204:205], v224 offset:16928
ds_read_b64_tr_b16 v[206:207], v224 offset:25376
v_mfma_f32_16x16x32_bf16 v[160:163], v[208:211], v[48:51], v[160:163]
v_mfma_f32_16x16x32_bf16 v[168:171], v[208:211], v[52:55], v[168:171]
ds_read_b64_tr_b16 v[208:209], v224 offset:16960
ds_read_b64_tr_b16 v[210:211], v224 offset:25408
v_mfma_f32_16x16x32_bf16 v[172:175], v[212:215], v[52:55], v[172:175]
s_waitcnt lgkmcnt(4)
s_nop 0
v_mfma_f32_16x16x32_bf16 v[164:167], v[212:215], v[48:51], v[164:167]
ds_read_b64_tr_b16 v[212:213], v224 offset:16992
ds_read_b64_tr_b16 v[214:215], v224 offset:25440
v_mfma_f32_16x16x32_bf16 v[176:179], v[192:195], v[48:51], v[176:179]
v_mfma_f32_16x16x32_bf16 v[184:187], v[192:195], v[52:55], v[184:187]
ds_read_b64_tr_b16 v[192:193], v224 offset:17152
ds_read_b64_tr_b16 v[194:195], v224 offset:25600
v_mfma_f32_16x16x32_bf16 v[188:191], v[196:199], v[52:55], v[188:191]
v_mfma_f32_16x16x32_bf16 v[180:183], v[196:199], v[48:51], v[180:183]
ds_read_b64_tr_b16 v[196:197], v224 offset:17184
ds_read_b64_tr_b16 v[198:199], v224 offset:25632
v_mfma_f32_16x16x32_bf16 v[128:131], v[200:203], v[56:59], v[128:131]
v_mov_b64 v[48:49], 0
s_waitcnt lgkmcnt(4)
v_mfma_f32_16x16x32_bf16 v[136:139], v[200:203], v[60:63], v[136:139]
ds_read_b64_tr_b16 v[200:201], v224 offset:17216
ds_read_b64_tr_b16 v[202:203], v224 offset:25664
v_mfma_f32_16x16x32_bf16 v[140:143], v[204:207], v[60:63], v[140:143]
v_mov_b64_e64 v[50:51], 0
v_mfma_f32_16x16x32_bf16 v[132:135], v[204:207], v[56:59], v[132:135]
ds_read_b64_tr_b16 v[204:205], v224 offset:17248
ds_read_b64_tr_b16 v[206:207], v224 offset:25696
v_mfma_f32_16x16x32_bf16 v[144:147], v[208:211], v[56:59], v[144:147]
v_mov_b64_e64 v[52:53], 0
v_mfma_f32_16x16x32_bf16 v[152:155], v[208:211], v[60:63], v[152:155]
s_barrier
ds_read_b64_tr_b16 v[208:209], v224 offset:33792
ds_read_b64_tr_b16 v[210:211], v224 offset:42240
v_mfma_f32_16x16x32_bf16 v[156:159], v[212:215], v[60:63], v[156:159]
v_mov_b64_e64 v[54:55], 0
s_waitcnt lgkmcnt(4)
v_mfma_f32_16x16x32_bf16 v[148:151], v[212:215], v[56:59], v[148:151]
ds_read_b64_tr_b16 v[212:213], v224 offset:33824
ds_read_b64_tr_b16 v[214:215], v224 offset:42272
v_mfma_f32_16x16x32_bf16 v[160:163], v[192:195], v[56:59], v[160:163]
v_mfma_f32_16x16x32_bf16 v[168:171], v[192:195], v[60:63], v[168:171]
ds_read_b64_tr_b16 v[192:193], v224 offset:33856
ds_read_b64_tr_b16 v[194:195], v224 offset:42304
v_mfma_f32_16x16x32_bf16 v[172:175], v[196:199], v[60:63], v[172:175]
v_mfma_f32_16x16x32_bf16 v[164:167], v[196:199], v[56:59], v[164:167]
ds_read_b64_tr_b16 v[196:197], v224 offset:33888
ds_read_b64_tr_b16 v[198:199], v224 offset:42336
v_mfma_f32_16x16x32_bf16 v[176:179], v[200:203], v[56:59], v[176:179]
s_waitcnt lgkmcnt(4)
s_nop 0
v_mfma_f32_16x16x32_bf16 v[184:187], v[200:203], v[60:63], v[184:187]
ds_read_b64_tr_b16 v[200:201], v224 offset:34048
ds_read_b64_tr_b16 v[202:203], v224 offset:42496
v_mfma_f32_16x16x32_bf16 v[188:191], v[204:207], v[60:63], v[188:191]
v_mfma_f32_16x16x32_bf16 v[180:183], v[204:207], v[56:59], v[180:183]
ds_read_b64_tr_b16 v[204:205], v224 offset:34080
ds_read_b64_tr_b16 v[206:207], v224 offset:42528
v_mfma_f32_16x16x32_bf16 v[128:131], v[208:211], v[64:67], v[128:131]
v_mov_b64_e64 v[56:57], 0
v_mfma_f32_16x16x32_bf16 v[136:139], v[208:211], v[68:71], v[136:139]
ds_read_b64_tr_b16 v[208:209], v224 offset:34112
ds_read_b64_tr_b16 v[210:211], v224 offset:42560
v_mfma_f32_16x16x32_bf16 v[140:143], v[212:215], v[68:71], v[140:143]
v_mov_b64 v[58:59], 0
s_waitcnt lgkmcnt(4)
v_mfma_f32_16x16x32_bf16 v[132:135], v[212:215], v[64:67], v[132:135]
ds_read_b64_tr_b16 v[212:213], v224 offset:34144
ds_read_b64_tr_b16 v[214:215], v224 offset:42592
v_mfma_f32_16x16x32_bf16 v[144:147], v[192:195], v[64:67], v[144:147]
v_mov_b64_e64 v[60:61], 0
v_mfma_f32_16x16x32_bf16 v[152:155], v[192:195], v[68:71], v[152:155]
ds_read_b64_tr_b16 v[192:193], v226 offset:16896
ds_read_b64_tr_b16 v[194:195], v226 offset:25344
v_mfma_f32_16x16x32_bf16 v[156:159], v[196:199], v[68:71], v[156:159]
v_mov_b64_e64 v[62:63], 0
v_mfma_f32_16x16x32_bf16 v[148:151], v[196:199], v[64:67], v[148:151]
ds_read_b64_tr_b16 v[196:197], v226 offset:16928
ds_read_b64_tr_b16 v[198:199], v226 offset:25376
v_mfma_f32_16x16x32_bf16 v[160:163], v[200:203], v[64:67], v[160:163]
s_waitcnt lgkmcnt(4)
s_nop 0
v_mfma_f32_16x16x32_bf16 v[168:171], v[200:203], v[68:71], v[168:171]
ds_read_b64_tr_b16 v[200:201], v226 offset:16960
ds_read_b64_tr_b16 v[202:203], v226 offset:25408
v_mfma_f32_16x16x32_bf16 v[172:175], v[204:207], v[68:71], v[172:175]
v_mfma_f32_16x16x32_bf16 v[164:167], v[204:207], v[64:67], v[164:167]
ds_read_b64_tr_b16 v[204:205], v226 offset:16992
ds_read_b64_tr_b16 v[206:207], v226 offset:25440
v_mfma_f32_16x16x32_bf16 v[176:179], v[208:211], v[64:67], v[176:179]
s_add_u32 s83, s89, 0
buffer_load_dword v251, v252, s[44:47], s83 offen
v_mfma_f32_16x16x32_bf16 v[184:187], v[208:211], v[68:71], v[184:187]
ds_read_b64_tr_b16 v[208:209], v226 offset:17152
ds_read_b64_tr_b16 v[210:211], v226 offset:25600
v_mfma_f32_16x16x32_bf16 v[188:191], v[212:215], v[68:71], v[188:191]
s_waitcnt lgkmcnt(4)
v_mfma_f32_16x16x32_bf16 v[180:183], v[212:215], v[64:67], v[180:183]
ds_read_b64_tr_b16 v[212:213], v226 offset:17184
ds_read_b64_tr_b16 v[214:215], v226 offset:25632
v_mfma_f32_16x16x32_bf16 v[128:131], v[192:195], v[72:75], v[128:131]
v_mov_b64_e64 v[64:65], 0
v_mfma_f32_16x16x32_bf16 v[136:139], v[192:195], v[76:79], v[136:139]
ds_read_b64_tr_b16 v[192:193], v226 offset:17216
ds_read_b64_tr_b16 v[194:195], v226 offset:25664
v_mfma_f32_16x16x32_bf16 v[140:143], v[196:199], v[76:79], v[140:143]
v_mov_b64_e64 v[66:67], 0
v_mfma_f32_16x16x32_bf16 v[132:135], v[196:199], v[72:75], v[132:135]
ds_read_b64_tr_b16 v[196:197], v226 offset:17248
ds_read_b64_tr_b16 v[198:199], v226 offset:25696
v_mfma_f32_16x16x32_bf16 v[144:147], v[200:203], v[72:75], v[144:147]
v_mov_b64 v[68:69], 0
s_waitcnt lgkmcnt(4)
v_mfma_f32_16x16x32_bf16 v[152:155], v[200:203], v[76:79], v[152:155]
s_barrier
ds_read_b64_tr_b16 v[200:201], v226 offset:33792
ds_read_b64_tr_b16 v[202:203], v226 offset:42240
v_mfma_f32_16x16x32_bf16 v[156:159], v[204:207], v[76:79], v[156:159]
v_mov_b64 v[70:71], 0
v_mfma_f32_16x16x32_bf16 v[148:151], v[204:207], v[72:75], v[148:151]
ds_read_b64_tr_b16 v[204:205], v226 offset:33824
ds_read_b64_tr_b16 v[206:207], v226 offset:42272
v_mfma_f32_16x16x32_bf16 v[160:163], v[208:211], v[72:75], v[160:163]
v_mfma_f32_16x16x32_bf16 v[168:171], v[208:211], v[76:79], v[168:171]
ds_read_b64_tr_b16 v[208:209], v226 offset:33856
ds_read_b64_tr_b16 v[210:211], v226 offset:42304
v_mfma_f32_16x16x32_bf16 v[172:175], v[212:215], v[76:79], v[172:175]
s_waitcnt lgkmcnt(4)
s_nop 0
v_mfma_f32_16x16x32_bf16 v[164:167], v[212:215], v[72:75], v[164:167]
ds_read_b64_tr_b16 v[212:213], v226 offset:33888
ds_read_b64_tr_b16 v[214:215], v226 offset:42336
v_mfma_f32_16x16x32_bf16 v[176:179], v[192:195], v[72:75], v[176:179]
s_add_u32 s83, s89, 65536
buffer_load_dword v251, v252, s[44:47], s83 offen
v_mfma_f32_16x16x32_bf16 v[184:187], v[192:195], v[76:79], v[184:187]
ds_read_b64_tr_b16 v[192:193], v226 offset:34048
ds_read_b64_tr_b16 v[194:195], v226 offset:42496
v_mfma_f32_16x16x32_bf16 v[188:191], v[196:199], v[76:79], v[188:191]
v_mfma_f32_16x16x32_bf16 v[180:183], v[196:199], v[72:75], v[180:183]
ds_read_b64_tr_b16 v[196:197], v226 offset:34080
ds_read_b64_tr_b16 v[198:199], v226 offset:42528
v_mfma_f32_16x16x32_bf16 v[128:131], v[200:203], v[80:83], v[128:131]
v_mov_b64 v[72:73], 0
s_waitcnt lgkmcnt(4)
v_mfma_f32_16x16x32_bf16 v[136:139], v[200:203], v[84:87], v[136:139]
ds_read_b64_tr_b16 v[200:201], v226 offset:34112
ds_read_b64_tr_b16 v[202:203], v226 offset:42560
v_mfma_f32_16x16x32_bf16 v[140:143], v[204:207], v[84:87], v[140:143]
v_mov_b64_e64 v[74:75], 0
v_mfma_f32_16x16x32_bf16 v[132:135], v[204:207], v[80:83], v[132:135]
ds_read_b64_tr_b16 v[204:205], v226 offset:34144
ds_read_b64_tr_b16 v[206:207], v226 offset:42592
v_mfma_f32_16x16x32_bf16 v[144:147], v[208:211], v[80:83], v[144:147]
v_mov_b64_e64 v[76:77], 0
v_mfma_f32_16x16x32_bf16 v[152:155], v[208:211], v[84:87], v[152:155]
ds_read_b64_tr_b16 v[208:209], v225 offset:33792
ds_read_b64_tr_b16 v[210:211], v225 offset:42240
v_mfma_f32_16x16x32_bf16 v[156:159], v[212:215], v[84:87], v[156:159]
v_mov_b64 v[78:79], 0
s_waitcnt lgkmcnt(4)
v_mfma_f32_16x16x32_bf16 v[148:151], v[212:215], v[80:83], v[148:151]
ds_read_b64_tr_b16 v[212:213], v225 offset:33824
ds_read_b64_tr_b16 v[214:215], v225 offset:42272
v_mfma_f32_16x16x32_bf16 v[160:163], v[192:195], v[80:83], v[160:163]
v_mfma_f32_16x16x32_bf16 v[168:171], v[192:195], v[84:87], v[168:171]
ds_read_b64_tr_b16 v[192:193], v225 offset:33856
ds_read_b64_tr_b16 v[194:195], v225 offset:42304
v_mfma_f32_16x16x32_bf16 v[172:175], v[196:199], v[84:87], v[172:175]
v_mfma_f32_16x16x32_bf16 v[164:167], v[196:199], v[80:83], v[164:167]
ds_read_b64_tr_b16 v[196:197], v225 offset:33888
ds_read_b64_tr_b16 v[198:199], v225 offset:42336
v_mfma_f32_16x16x32_bf16 v[176:179], v[200:203], v[80:83], v[176:179]
s_add_u32 s83, s89, 131072
buffer_load_dword v251, v252, s[44:47], s83 offen
s_waitcnt lgkmcnt(4)
v_mfma_f32_16x16x32_bf16 v[184:187], v[200:203], v[84:87], v[184:187]
ds_read_b64_tr_b16 v[200:201], v225 offset:34048
ds_read_b64_tr_b16 v[202:203], v225 offset:42496
v_mfma_f32_16x16x32_bf16 v[188:191], v[204:207], v[84:87], v[188:191]
s_nop 0
v_mfma_f32_16x16x32_bf16 v[180:183], v[204:207], v[80:83], v[180:183]
ds_read_b64_tr_b16 v[204:205], v225 offset:34080
ds_read_b64_tr_b16 v[206:207], v225 offset:42528
v_mfma_f32_16x16x32_bf16 v[128:131], v[208:211], v[88:91], v[128:131]
v_mov_b64_e64 v[80:81], 0
v_mfma_f32_16x16x32_bf16 v[136:139], v[208:211], v[92:95], v[136:139]
ds_read_b64_tr_b16 v[208:209], v225 offset:34112
ds_read_b64_tr_b16 v[210:211], v225 offset:42560
v_mfma_f32_16x16x32_bf16 v[140:143], v[212:215], v[92:95], v[140:143]
v_mov_b64 v[82:83], 0
s_waitcnt lgkmcnt(4)
v_mfma_f32_16x16x32_bf16 v[132:135], v[212:215], v[88:91], v[132:135]
ds_read_b64_tr_b16 v[212:213], v225 offset:34144
ds_read_b64_tr_b16 v[214:215], v225 offset:42592
v_mfma_f32_16x16x32_bf16 v[144:147], v[192:195], v[88:91], v[144:147]
v_mov_b64_e64 v[84:85], 0
v_mfma_f32_16x16x32_bf16 v[152:155], v[192:195], v[92:95], v[152:155]
s_barrier
ds_read_b64_tr_b16 v[192:193], v225 offset:0
ds_read_b64_tr_b16 v[194:195], v225 offset:8448
v_mfma_f32_16x16x32_bf16 v[156:159], v[196:199], v[92:95], v[156:159]
v_mov_b64 v[86:87], 0
v_mfma_f32_16x16x32_bf16 v[148:151], v[196:199], v[88:91], v[148:151]
ds_read_b64_tr_b16 v[196:197], v225 offset:32
ds_read_b64_tr_b16 v[198:199], v225 offset:8480
v_mfma_f32_16x16x32_bf16 v[160:163], v[200:203], v[88:91], v[160:163]
s_waitcnt lgkmcnt(4)
s_nop 0
v_mfma_f32_16x16x32_bf16 v[168:171], v[200:203], v[92:95], v[168:171]
ds_read_b64_tr_b16 v[200:201], v225 offset:64
ds_read_b64_tr_b16 v[202:203], v225 offset:8512
v_mfma_f32_16x16x32_bf16 v[172:175], v[204:207], v[92:95], v[172:175]
v_mfma_f32_16x16x32_bf16 v[164:167], v[204:207], v[88:91], v[164:167]
ds_read_b64_tr_b16 v[204:205], v225 offset:96
ds_read_b64_tr_b16 v[206:207], v225 offset:8544
v_mfma_f32_16x16x32_bf16 v[176:179], v[208:211], v[88:91], v[176:179]
s_lshl_b32 s7, s91, 1
s_and_b32 s82, s6, 1
s_add_u32 s7, s7, s82
s_mul_i32 s83, s7, 50176
s_cmp_lt_u32 s6, 2
s_cselect_b32 s44, s28, s32
s_cselect_b32 s45, s29, s33
s_mov_b32 s46, s30
buffer_load_dword v251, v253, s[44:47], s83 offen
v_mfma_f32_16x16x32_bf16 v[184:187], v[208:211], v[92:95], v[184:187]
ds_read_b64_tr_b16 v[208:209], v225 offset:256
ds_read_b64_tr_b16 v[210:211], v225 offset:8704
v_mfma_f32_16x16x32_bf16 v[188:191], v[212:215], v[92:95], v[188:191]
s_waitcnt lgkmcnt(4)
v_mfma_f32_16x16x32_bf16 v[180:183], v[212:215], v[88:91], v[180:183]
ds_read_b64_tr_b16 v[212:213], v225 offset:288
ds_read_b64_tr_b16 v[214:215], v225 offset:8736
v_mfma_f32_16x16x32_bf16 v[128:131], v[192:195], v[96:99], v[128:131]
v_mov_b64_e64 v[88:89], 0
v_mfma_f32_16x16x32_bf16 v[136:139], v[192:195], v[100:103], v[136:139]
ds_read_b64_tr_b16 v[192:193], v225 offset:320
ds_read_b64_tr_b16 v[194:195], v225 offset:8768
v_mfma_f32_16x16x32_bf16 v[140:143], v[196:199], v[100:103], v[140:143]
v_mov_b64_e64 v[90:91], 0
v_mfma_f32_16x16x32_bf16 v[132:135], v[196:199], v[96:99], v[132:135]
ds_read_b64_tr_b16 v[196:197], v225 offset:352
ds_read_b64_tr_b16 v[198:199], v225 offset:8800
v_mfma_f32_16x16x32_bf16 v[144:147], v[200:203], v[96:99], v[144:147]
v_mov_b64 v[92:93], 0
s_waitcnt lgkmcnt(4)
v_mfma_f32_16x16x32_bf16 v[152:155], v[200:203], v[100:103], v[152:155]
ds_read_b64_tr_b16 v[200:201], v226 offset:0
ds_read_b64_tr_b16 v[202:203], v226 offset:8448
v_mfma_f32_16x16x32_bf16 v[156:159], v[204:207], v[100:103], v[156:159]
v_mov_b64_e64 v[94:95], 0
v_mfma_f32_16x16x32_bf16 v[148:151], v[204:207], v[96:99], v[148:151]
ds_read_b64_tr_b16 v[204:205], v226 offset:32
ds_read_b64_tr_b16 v[206:207], v226 offset:8480
v_mfma_f32_16x16x32_bf16 v[160:163], v[208:211], v[96:99], v[160:163]
v_mfma_f32_16x16x32_bf16 v[168:171], v[208:211], v[100:103], v[168:171]
ds_read_b64_tr_b16 v[208:209], v226 offset:64
ds_read_b64_tr_b16 v[210:211], v226 offset:8512
v_mfma_f32_16x16x32_bf16 v[172:175], v[212:215], v[100:103], v[172:175]
s_waitcnt lgkmcnt(4)
s_nop 0
v_mfma_f32_16x16x32_bf16 v[164:167], v[212:215], v[96:99], v[164:167]
ds_read_b64_tr_b16 v[212:213], v226 offset:96
ds_read_b64_tr_b16 v[214:215], v226 offset:8544
v_mfma_f32_16x16x32_bf16 v[176:179], v[192:195], v[96:99], v[176:179]
s_lshr_b32 s7, s3, 2
s_mul_i32 s83, s4, 1835008
s_lshl_b32 s82, s3, 14
s_add_u32 s83, s83, s82
s_lshl_b32 s82, s6, 18
s_add_u32 s83, s83, s82
s_add_u32 s20, s70, s83
s_addc_u32 s21, s71, 0
s_cmp_eq_u32 s6, 3
s_cselect_b32 s22, 0, 1048576
s_add_u32 s22, s22, 33816576
s_mov_b32 s28, s66
s_mov_b32 s29, s67
s_mov_b32 s30, 1835008
s_lshl_b32 s82, s4, 2
s_add_u32 s7, s7, s82
s_lshl_b32 s82, s7, 10
s_add_u32 s82, s82, 67108864
s_add_u32 s32, s70, s82
s_addc_u32 s33, s71, 0
s_mov_b32 s34, 0x10400
s_mov_b32 s84, 0x10000
s_lshl_b32 s7, s7, 1
s_and_b32 s82, s3, 1
s_add_u32 s7, s7, s82
s_mul_i32 s86, s7, 14336
s_lshl_b32 s82, s6, 7
s_add_u32 s86, s86, s82
s_bfe_u32 s82, s3, 0x10001
s_lshl_b32 s82, s82, 6
s_add_u32 s86, s86, s82
v_mfma_f32_16x16x32_bf16 v[184:187], v[192:195], v[100:103], v[184:187]
ds_read_b64_tr_b16 v[192:193], v226 offset:256
ds_read_b64_tr_b16 v[194:195], v226 offset:8704
v_mfma_f32_16x16x32_bf16 v[188:191], v[196:199], v[100:103], v[188:191]
v_mfma_f32_16x16x32_bf16 v[180:183], v[196:199], v[96:99], v[180:183]
ds_read_b64_tr_b16 v[196:197], v226 offset:288
ds_read_b64_tr_b16 v[198:199], v226 offset:8736
v_mfma_f32_16x16x32_bf16 v[128:131], v[200:203], v[104:107], v[128:131]
v_mov_b64 v[96:97], 0
s_waitcnt lgkmcnt(4)
v_mfma_f32_16x16x32_bf16 v[136:139], v[200:203], v[108:111], v[136:139]
ds_read_b64_tr_b16 v[200:201], v226 offset:320
ds_read_b64_tr_b16 v[202:203], v226 offset:8768
v_mfma_f32_16x16x32_bf16 v[140:143], v[204:207], v[108:111], v[140:143]
v_mov_b64_e64 v[98:99], 0
v_mfma_f32_16x16x32_bf16 v[132:135], v[204:207], v[104:107], v[132:135]
ds_read_b64_tr_b16 v[204:205], v226 offset:352
ds_read_b64_tr_b16 v[206:207], v226 offset:8800
v_mfma_f32_16x16x32_bf16 v[144:147], v[208:211], v[104:107], v[144:147]
v_mov_b64_e64 v[100:101], 0
v_mfma_f32_16x16x32_bf16 v[152:155], v[208:211], v[108:111], v[152:155]
v_mov_b64_e64 v[100:101], 0
v_mfma_f32_16x16x32_bf16 v[156:159], v[212:215], v[108:111], v[156:159]
v_mov_b64 v[102:103], 0
s_waitcnt lgkmcnt(2)
v_mfma_f32_16x16x32_bf16 v[148:151], v[212:215], v[104:107], v[148:151]
v_mov_b64_e64 v[102:103], 0
v_mfma_f32_16x16x32_bf16 v[160:163], v[192:195], v[104:107], v[160:163]
v_mfma_f32_16x16x32_bf16 v[168:171], v[192:195], v[108:111], v[168:171]
v_mfma_f32_16x16x32_bf16 v[172:175], v[196:199], v[108:111], v[172:175]
v_mfma_f32_16x16x32_bf16 v[164:167], v[196:199], v[104:107], v[164:167]
v_mfma_f32_16x16x32_bf16 v[176:179], v[200:203], v[104:107], v[176:179]
s_mov_b32 s73, 0xbfb8aa3b
s_lshl_b32 s7, s6, 2
s_lshr_b32 s7, 0x635, s7
s_and_b32 s7, s7, 15
s_mul_i32 s85, s7, 16896
s_lshl_b32 s90, s6, 12
s_add_u32 s90, s90, 151552
s_waitcnt lgkmcnt(0)
v_mfma_f32_16x16x32_bf16 v[184:187], v[200:203], v[108:111], v[184:187]
v_mfma_f32_16x16x32_bf16 v[188:191], v[204:207], v[108:111], v[188:191]
v_mfma_f32_16x16x32_bf16 v[180:183], v[204:207], v[104:107], v[180:183]
s_lshr_b32 s7, s6, 1
s_mul_i32 s7, s7, 16896
s_and_b32 s83, s6, 1
s_lshl_b32 s83, s83, 13
s_add_u32 s7, s7, s83
s_add_u32 s7, s7, 118272
v_lshlrev_b32 v254, 4, v255
v_add_u32 v254, s7, v254
ds_read_b128 v[224:227], v248 offset:0
ds_read_b128 v[228:231], v248 offset:8448
ds_read_b128 v[232:235], v248 offset:64
ds_read_b128 v[236:239], v248 offset:8512
ds_read_b128 v[240:243], v248 offset:256
ds_read_b128 v[244:247], v248 offset:8704
v_mov_b64 v[104:105], 0
v_mov_b64 v[106:107], 0
v_mov_b64 v[108:109], 0
v_mov_b64 v[110:111], 0
v_mul_f32 v128, s72, v128
v_mul_f32 v129, s72, v129
v_mul_f32 v130, s72, v130
v_mul_f32 v131, s72, v131
v_mul_f32 v132, s72, v132
v_mul_f32 v133, s72, v133
v_mul_f32 v134, s72, v134
v_mul_f32 v135, s72, v135
v_cvt_pk_bf16_f32 v128, v128, v129
v_cvt_pk_bf16_f32 v129, v130, v131
v_cvt_pk_bf16_f32 v130, v132, v133
v_cvt_pk_bf16_f32 v131, v134, v135
s_nop 0
v_permlane16_swap_b32 v128, v130
v_permlane16_swap_b32 v129, v131
v_mul_f32 v136, s72, v136
v_mul_f32 v137, s72, v137
v_mul_f32 v138, s72, v138
v_mul_f32 v139, s72, v139
v_mul_f32 v140, s72, v140
v_mul_f32 v141, s72, v141
v_mul_f32 v142, s72, v142
v_mul_f32_e64 v143, s72, v143
v_cvt_pk_bf16_f32 v132, v136, v137
v_cvt_pk_bf16_f32 v134, v140, v141
v_cvt_pk_bf16_f32 v133, v138, v139
v_cvt_pk_bf16_f32 v135, v142, v143
v_permlane16_swap_b32 v132, v134
s_nop 0
v_permlane16_swap_b32 v133, v135
s_waitcnt lgkmcnt(5)
v_mfma_f32_16x16x32_bf16 v[192:195], v[224:227], v[128:131], 0
v_mul_f32 v144, s72, v144
v_mul_f32 v145, s72, v145
v_mul_f32 v146, s72, v146
v_mul_f32 v147, s72, v147
v_mul_f32 v148, s72, v148
v_mul_f32 v149, s72, v149
v_mul_f32 v150, s72, v150
v_mul_f32 v151, s72, v151
v_cvt_pk_bf16_f32 v136, v144, v145
v_cvt_pk_bf16_f32 v138, v148, v149
v_cvt_pk_bf16_f32 v137, v146, v147
v_cvt_pk_bf16_f32 v139, v150, v151
v_permlane16_swap_b32 v136, v138
s_nop 0
v_permlane16_swap_b32 v137, v139
v_mfma_f32_16x16x32_bf16 v[196:199], v[224:227], v[132:135], 0
ds_read_b128 v[224:227], v248 offset:320
s_waitcnt lgkmcnt(5)
v_mfma_f32_16x16x32_bf16 v[212:215], v[228:231], v[132:135], 0
v_mul_f32 v152, s72, v152
v_mul_f32 v153, s72, v153
v_mul_f32 v154, s72, v154
v_mul_f32 v155, s72, v155
v_mul_f32 v156, s72, v156
v_mul_f32 v157, s72, v157
v_mul_f32 v158, s72, v158
v_mul_f32 v159, s72, v159
v_cvt_pk_bf16_f32 v140, v152, v153
v_cvt_pk_bf16_f32 v142, v156, v157
v_cvt_pk_bf16_f32 v141, v154, v155
v_cvt_pk_bf16_f32 v143, v158, v159
v_permlane16_swap_b32 v140, v142
s_nop 0
v_permlane16_swap_b32 v141, v143
s_waitcnt lgkmcnt(3)
v_mfma_f32_16x16x32_bf16 v[208:211], v[228:231], v[128:131], 0
ds_read_b128 v[228:231], v248 offset:8768
v_mfma_f32_16x16x32_bf16 v[192:195], v[232:235], v[136:139], v[192:195]
v_mul_f32 v160, s72, v160
v_mul_f32 v161, s72, v161
v_mul_f32 v162, s72, v162
v_mul_f32 v163, s72, v163
v_mul_f32 v164, s72, v164
v_mul_f32 v165, s72, v165
v_mul_f32 v166, s72, v166
v_mul_f32 v167, s72, v167
v_cvt_pk_bf16_f32 v144, v160, v161
v_cvt_pk_bf16_f32 v146, v164, v165
v_cvt_pk_bf16_f32 v145, v162, v163
v_cvt_pk_bf16_f32 v147, v166, v167
v_permlane16_swap_b32 v144, v146
s_nop 0
v_permlane16_swap_b32 v145, v147
s_barrier
ds_read_b128 v[160:163], v254 offset:0
ds_read_b128 v[164:167], v254 offset:1024
v_mfma_f32_16x16x32_bf16 v[196:199], v[232:235], v[140:143], v[196:199]
ds_read_b128 v[232:235], v248 offset:512
v_mfma_f32_16x16x32_bf16 v[212:215], v[236:239], v[140:143], v[212:215]
v_mul_f32 v168, s72, v168
v_mul_f32 v169, s72, v169
v_mul_f32 v170, s72, v170
v_mul_f32 v171, s72, v171
v_mul_f32 v172, s72, v172
v_mul_f32 v173, s72, v173
v_mul_f32 v174, s72, v174
v_mul_f32 v175, s72, v175
v_cvt_pk_bf16_f32 v148, v168, v169
v_cvt_pk_bf16_f32 v150, v172, v173
v_cvt_pk_bf16_f32 v149, v170, v171
v_cvt_pk_bf16_f32 v151, v174, v175
v_permlane16_swap_b32 v148, v150
s_nop 0
v_permlane16_swap_b32 v149, v151
ds_read_b128 v[168:171], v254 offset:2048
ds_read_b128 v[172:175], v254 offset:3072
s_waitcnt lgkmcnt(7)
v_mfma_f32_16x16x32_bf16 v[208:211], v[236:239], v[136:139], v[208:211]
ds_read_b128 v[236:239], v248 offset:8960
v_mfma_f32_16x16x32_bf16 v[192:195], v[240:243], v[144:147], v[192:195]
v_mul_f32 v176, s72, v176
v_mul_f32 v177, s72, v177
v_mul_f32 v178, s72, v178
v_mul_f32 v179, s72, v179
v_mul_f32 v180, s72, v180
v_mul_f32 v181, s72, v181
v_mul_f32 v182, s72, v182
v_mul_f32 v183, s72, v183
v_cvt_pk_bf16_f32 v152, v176, v177
v_cvt_pk_bf16_f32 v154, v180, v181
v_cvt_pk_bf16_f32 v153, v178, v179
v_cvt_pk_bf16_f32 v155, v182, v183
v_permlane16_swap_b32 v152, v154
s_nop 0
v_permlane16_swap_b32 v153, v155
ds_read_b128 v[176:179], v254 offset:4096
ds_read_b128 v[180:183], v254 offset:5120
v_mfma_f32_16x16x32_bf16 v[196:199], v[240:243], v[148:151], v[196:199]
ds_read_b128 v[240:243], v248 offset:576
v_mfma_f32_16x16x32_bf16 v[212:215], v[244:247], v[148:151], v[212:215]
v_mul_f32 v184, s72, v184
v_mul_f32 v185, s72, v185
v_mul_f32 v186, s72, v186
v_mul_f32 v187, s72, v187
v_mul_f32 v188, s72, v188
v_mul_f32 v189, s72, v189
v_mul_f32 v190, s72, v190
v_mul_f32_e64 v191, s72, v191
v_cvt_pk_bf16_f32 v156, v184, v185
v_cvt_pk_bf16_f32 v158, v188, v189
v_cvt_pk_bf16_f32 v157, v186, v187
v_cvt_pk_bf16_f32 v159, v190, v191
v_permlane16_swap_b32 v156, v158
s_nop 0
v_permlane16_swap_b32 v157, v159
ds_read_b128 v[184:187], v254 offset:6144
ds_read_b128 v[188:191], v254 offset:7168
s_waitcnt lgkmcnt(11)
v_mfma_f32_16x16x32_bf16 v[208:211], v[244:247], v[144:147], v[208:211]
ds_read_b128 v[244:247], v248 offset:9024
v_mfma_f32_16x16x32_bf16 v[192:195], v[224:227], v[152:155], v[192:195]
v_mfma_f32_16x16x32_bf16 v[196:199], v[224:227], v[156:159], v[196:199]
ds_read_b128 v[224:227], v248 offset:768
v_mfma_f32_16x16x32_bf16 v[212:215], v[228:231], v[156:159], v[212:215]
s_waitcnt lgkmcnt(7)
s_nop 0
v_mfma_f32_16x16x32_bf16 v[208:211], v[228:231], v[152:155], v[208:211]
ds_read_b128 v[228:231], v248 offset:9216
v_mfma_f32_16x16x32_bf16 v[192:195], v[232:235], v[160:163], v[192:195]
v_mfma_f32_16x16x32_bf16 v[196:199], v[232:235], v[164:167], v[196:199]
ds_read_b128 v[232:235], v248 offset:832
v_mfma_f32_16x16x32_bf16 v[212:215], v[236:239], v[164:167], v[212:215]
s_waitcnt lgkmcnt(3)
s_nop 0
v_mfma_f32_16x16x32_bf16 v[208:211], v[236:239], v[160:163], v[208:211]
ds_read_b128 v[236:239], v248 offset:9280
v_mfma_f32_16x16x32_bf16 v[192:195], v[240:243], v[168:171], v[192:195]
v_mfma_f32_16x16x32_bf16 v[196:199], v[240:243], v[172:175], v[196:199]
v_mfma_f32_16x16x32_bf16 v[212:215], v[244:247], v[172:175], v[212:215]
s_waitcnt lgkmcnt(2)
s_nop 0
v_mfma_f32_16x16x32_bf16 v[208:211], v[244:247], v[168:171], v[208:211]
v_mfma_f32_16x16x32_bf16 v[192:195], v[224:227], v[176:179], v[192:195]
v_mfma_f32_16x16x32_bf16 v[196:199], v[224:227], v[180:183], v[196:199]
v_mfma_f32_16x16x32_bf16 v[212:215], v[228:231], v[180:183], v[212:215]
s_waitcnt lgkmcnt(0)
s_nop 0
v_mfma_f32_16x16x32_bf16 v[208:211], v[228:231], v[176:179], v[208:211]
v_mfma_f32_16x16x32_bf16 v[192:195], v[232:235], v[184:187], v[192:195]
v_mfma_f32_16x16x32_bf16 v[196:199], v[232:235], v[188:191], v[196:199]
v_mfma_f32_16x16x32_bf16 v[212:215], v[236:239], v[188:191], v[212:215]
v_mfma_f32_16x16x32_bf16 v[208:211], v[236:239], v[184:187], v[208:211]
s_waitcnt vmcnt(0)
ds_read_b128 v[224:227], v248 offset:16896
ds_read_b128 v[228:231], v248 offset:16960
ds_read_b128 v[232:235], v248 offset:17152
ds_read_b128 v[236:239], v248 offset:17216
ds_read_b128 v[240:243], v248 offset:17408
ds_read_b128 v[244:247], v248 offset:17472
s_cmp_lg_u32 s79, 0
s_cbranch_scc1 L_havem
v_max3_f32 v216, v192, v193, v194
v_max3_f32 v216, v216, v195, v208
v_max3_f32 v216, v216, v209, v210
v_max_f32 v216, v216, v211
v_max3_f32 v220, v196, v197, v198
v_max3_f32 v220, v220, v199, v212
v_max3_f32 v220, v220, v213, v214
v_max_f32 v220, v220, v215
v_mov_b32 v217, v216
s_nop 1
v_permlane16_swap_b32 v216, v217
v_max_f32 v216, v216, v217
v_mov_b32 v217, v216
s_nop 1
v_permlane32_swap_b32 v216, v217
v_max_f32 v216, v216, v217
v_mov_b32 v221, v220
s_nop 1
v_permlane16_swap_b32 v220, v221
v_max_f32 v220, v220, v221
v_mov_b32 v221, v220
s_nop 1
v_permlane32_swap_b32 v220, v221
v_max_f32 v220, v220, v221
v_sub_f32 v217, 0x0, v216
v_sub_f32 v218, 0x0, v216
v_sub_f32 v219, 0x0, v216
v_sub_f32 v216, 0x0, v216
v_sub_f32 v221, 0x0, v220
v_sub_f32 v222, 0x0, v220
v_sub_f32 v223, 0x0, v220
v_sub_f32 v220, 0x0, v220
L_havem:
v_add_f32 v192, v192, v216
v_add_f32 v208, v208, v216
v_add_f32 v193, v193, v216
v_add_f32 v209, v209, v216
v_add_f32 v194, v194, v216
v_add_f32 v210, v210, v216
v_add_f32 v195, v195, v216
v_add_f32 v211, v211, v216
v_add_f32 v196, v196, v220
v_add_f32 v212, v212, v220
v_add_f32 v197, v197, v220
v_add_f32 v213, v213, v220
v_add_f32 v198, v198, v220
v_add_f32 v214, v214, v220
v_add_f32 v199, v199, v220
v_add_f32 v215, v215, v220
v_mov_b32 v250, 0
v_mov_b32 v251, 0
v_exp_f32 v192, v192
s_nop 0
v_add_f32 v250, v250, v192
v_exp_f32 v193, v193
v_exp_f32 v196, v196
v_add_f32 v250, v250, v193
v_add_f32 v251, v251, v196
v_cvt_pk_bf16_f32 v192, v192, v193
v_exp_f32 v197, v197
s_nop 0
v_add_f32 v251, v251, v197
v_exp_f32 v194, v194
v_exp_f32 v195, v195
v_add_f32 v250, v250, v194
v_add_f32_e64 v250, v250, v195
v_cvt_pk_bf16_f32 v193, v194, v195
v_exp_f32 v198, v198
s_nop 0
v_add_f32 v251, v251, v198
v_exp_f32 v199, v199
s_nop 0
v_add_f32 v251, v251, v199
v_cvt_pk_bf16_f32 v196, v196, v197
v_exp_f32 v208, v208
v_exp_f32 v209, v209
v_add_f32 v250, v250, v208
v_add_f32 v250, v250, v209
v_cvt_pk_bf16_f32 v194, v208, v209
v_cvt_pk_bf16_f32 v197, v198, v199
v_exp_f32 v212, v212
v_exp_f32 v213, v213
v_add_f32 v251, v251, v212
v_add_f32 v251, v251, v213
s_mov_b32 s75, 15
s_waitcnt lgkmcnt(0)
s_branch L_it0
.p2align 6
L_loop:
v_mfma_f32_16x16x32_bf16 v[192:195], v[224:227], v[128:131], v[216:219]
v_exp_f32_e64 v210, v210
v_mfma_f32_16x16x32_bf16 v[196:199], v[224:227], v[132:135], v[220:223]
ds_read_b128 v[252:255], v248 offset:768
v_add_f32_e64 v250, v250, v210
v_mfma_f32_16x16x32_bf16 v[196:199], v[228:231], v[140:143], v[196:199]
v_exp_f32_e64 v211, v211
v_mfma_f32_16x16x32_bf16 v[192:195], v[228:231], v[136:139], v[192:195]
ds_read_b128 v[224:227], v248 offset:832
v_add_f32_e64 v250, v250, v211
v_mfma_f32_16x16x32_bf16 v[192:195], v[232:235], v[144:147], v[192:195]
v_exp_f32_e64 v214, v214
v_mfma_f32_16x16x32_bf16 v[196:199], v[232:235], v[148:151], v[196:199]
ds_read_b128 v[228:231], v248 offset:8448
s_waitcnt lgkmcnt(3)
v_mfma_f32_16x16x32_bf16 v[196:199], v[236:239], v[156:159], v[196:199]
v_exp_f32 v215, v215
v_mfma_f32_16x16x32_bf16 v[192:195], v[236:239], v[152:155], v[192:195]
ds_read_b128 v[232:235], v248 offset:8512
v_add_f32_e64 v251, v251, v214
v_mfma_f32_16x16x32_bf16 v[192:195], v[240:243], v[160:163], v[192:195]
v_add_f32_e64 v251, v251, v215
v_cvt_pk_bf16_f32 v203, v210, v211
v_mfma_f32_16x16x32_bf16 v[196:199], v[240:243], v[164:167], v[196:199]
ds_read_b128 v[236:239], v248 offset:8704
v_cvt_pk_bf16_f32 v206, v212, v213
v_mfma_f32_16x16x32_bf16 v[196:199], v[244:247], v[172:175], v[196:199]
v_cvt_pk_bf16_f32 v207, v214, v215
v_mfma_f32_16x16x32_bf16 v[192:195], v[244:247], v[168:171], v[192:195]
ds_read_b128 v[240:243], v248 offset:8768
s_waitcnt lgkmcnt(3)
v_mfma_f32_16x16x32_bf16 v[192:195], v[252:255], v[176:179], v[192:195]
s_nop 0
v_mfma_f32_16x16x32_bf16 v[196:199], v[252:255], v[180:183], v[196:199]
ds_read_b128 v[244:247], v248 offset:8960
v_mfma_f32_16x16x32_bf16 v[196:199], v[224:227], v[188:191], v[196:199]
v_mfma_f32_16x16x32_bf16 v[192:195], v[224:227], v[184:187], v[192:195]
ds_read_b128 v[224:227], v248 offset:9024
s_barrier
v_mfma_f32_16x16x32_bf16 v[208:211], v[228:231], v[128:131], v[216:219]
s_nop 0
v_mfma_f32_16x16x32_bf16 v[212:215], v[228:231], v[132:135], v[220:223]
ds_read_b128 v[228:231], v248 offset:9216
s_waitcnt lgkmcnt(3)
v_mfma_f32_16x16x32_bf16 v[212:215], v[232:235], v[140:143], v[212:215]
s_nop 0
v_mfma_f32_16x16x32_bf16 v[208:211], v[232:235], v[136:139], v[208:211]
ds_read_b128 v[232:235], v248 offset:9280
v_mfma_f32_16x16x32_bf16 v[208:211], v[236:239], v[144:147], v[208:211]
v_exp_f32_e64 v192, v192
v_mfma_f32_16x16x32_bf16 v[212:215], v[236:239], v[148:151], v[212:215]
ds_read_b64_tr_b16 v[236:237], v249 offset:50688
ds_read_b64_tr_b16 v[238:239], v249 offset:59136
v_mfma_f32_16x16x32_bf16 v[212:215], v[240:243], v[156:159], v[212:215]
v_add_f32 v250, v250, v192
s_waitcnt lgkmcnt(3)
v_mfma_f32_16x16x32_bf16 v[208:211], v[240:243], v[152:155], v[208:211]
ds_read_b64_tr_b16 v[240:241], v249 offset:50720
ds_read_b64_tr_b16 v[242:243], v249 offset:59168
v_mfma_f32_16x16x32_bf16 v[208:211], v[244:247], v[160:163], v[208:211]
v_exp_f32_e64 v193, v193
v_mfma_f32_16x16x32_bf16 v[212:215], v[244:247], v[164:167], v[212:215]
ds_read_b64_tr_b16 v[244:245], v249 offset:50752
ds_read_b64_tr_b16 v[246:247], v249 offset:59200
v_mfma_f32_16x16x32_bf16 v[212:215], v[224:227], v[172:175], v[212:215]
v_exp_f32_e64 v196, v196
v_mfma_f32_16x16x32_bf16 v[208:211], v[224:227], v[168:171], v[208:211]
ds_read_b64_tr_b16 v[224:225], v249 offset:50784
ds_read_b64_tr_b16 v[226:227], v249 offset:59232
v_mfma_f32_16x16x32_bf16 v[208:211], v[228:231], v[176:179], v[208:211]
v_add_f32 v250, v250, v193
s_waitcnt lgkmcnt(4)
v_mfma_f32_16x16x32_bf16 v[212:215], v[228:231], v[180:183], v[212:215]
ds_read_b64_tr_b16 v[228:229], v249 offset:50944
ds_read_b64_tr_b16 v[230:231], v249 offset:59392
v_mfma_f32_16x16x32_bf16 v[212:215], v[232:235], v[188:191], v[212:215]
v_add_f32_e64 v251, v251, v196
v_cvt_pk_bf16_f32 v192, v192, v193
v_mfma_f32_16x16x32_bf16 v[208:211], v[232:235], v[184:187], v[208:211]
ds_read_b64_tr_b16 v[232:233], v249 offset:50976
ds_read_b64_tr_b16 v[234:235], v249 offset:59424
v_mfma_f32_16x16x32_bf16 v[0:3], v[236:239], v[200:203], v[0:3]
v_exp_f32_e64 v197, v197
v_mfma_f32_16x16x32_bf16 v[8:11], v[236:239], v[204:207], v[8:11]
ds_read_b64_tr_b16 v[236:237], v249 offset:51008
ds_read_b64_tr_b16 v[238:239], v249 offset:59456
v_mfma_f32_16x16x32_bf16 v[12:15], v[240:243], v[204:207], v[12:15]
v_add_f32 v251, v251, v197
s_waitcnt lgkmcnt(4)
v_mfma_f32_16x16x32_bf16 v[4:7], v[240:243], v[200:203], v[4:7]
ds_read_b64_tr_b16 v[240:241], v249 offset:51040
ds_read_b64_tr_b16 v[242:243], v249 offset:59488
v_mfma_f32_16x16x32_bf16 v[16:19], v[244:247], v[200:203], v[16:19]
v_exp_f32_e64 v194, v194
v_mfma_f32_16x16x32_bf16 v[24:27], v[244:247], v[204:207], v[24:27]
ds_read_b64_tr_b16 v[244:245], v249 offset:51200
ds_read_b64_tr_b16 v[246:247], v249 offset:59648
v_mfma_f32_16x16x32_bf16 v[28:31], v[224:227], v[204:207], v[28:31]
v_exp_f32_e64 v195, v195
v_mfma_f32_16x16x32_bf16 v[20:23], v[224:227], v[200:203], v[20:23]
ds_read_b64_tr_b16 v[252:253], v249 offset:51232
ds_read_b64_tr_b16 v[254:255], v249 offset:59680
v_mfma_f32_16x16x32_bf16 v[32:35], v[228:231], v[200:203], v[32:35]
v_add_f32 v250, v250, v194
s_waitcnt lgkmcnt(4)
v_mfma_f32_16x16x32_bf16 v[40:43], v[228:231], v[204:207], v[40:43]
ds_read_b64_tr_b16 v[224:225], v249 offset:51264
ds_read_b64_tr_b16 v[226:227], v249 offset:59712
v_mfma_f32_16x16x32_bf16 v[44:47], v[232:235], v[204:207], v[44:47]
v_add_f32_e64 v250, v250, v195
v_cvt_pk_bf16_f32 v193, v194, v195
v_mfma_f32_16x16x32_bf16 v[36:39], v[232:235], v[200:203], v[36:39]
ds_read_b64_tr_b16 v[228:229], v249 offset:51296
ds_read_b64_tr_b16 v[230:231], v249 offset:59744
v_mfma_f32_16x16x32_bf16 v[48:51], v[236:239], v[200:203], v[48:51]
v_exp_f32_e64 v198, v198
v_mfma_f32_16x16x32_bf16 v[56:59], v[236:239], v[204:207], v[56:59]
ds_read_b64_tr_b16 v[232:233], v249 offset:51456
ds_read_b64_tr_b16 v[234:235], v249 offset:59904
v_mfma_f32_16x16x32_bf16 v[60:63], v[240:243], v[204:207], v[60:63]
v_add_f32 v251, v251, v198
s_waitcnt lgkmcnt(4)
v_mfma_f32_16x16x32_bf16 v[52:55], v[240:243], v[200:203], v[52:55]
ds_read_b64_tr_b16 v[236:237], v249 offset:51488
ds_read_b64_tr_b16 v[238:239], v249 offset:59936
v_mfma_f32_16x16x32_bf16 v[64:67], v[244:247], v[200:203], v[64:67]
v_exp_f32_e64 v199, v199
v_mfma_f32_16x16x32_bf16 v[72:75], v[244:247], v[204:207], v[72:75]
ds_read_b64_tr_b16 v[240:241], v249 offset:51520
ds_read_b64_tr_b16 v[242:243], v249 offset:59968
v_mfma_f32_16x16x32_bf16 v[76:79], v[252:255], v[204:207], v[76:79]
v_add_f32_e64 v251, v251, v199
v_cvt_pk_bf16_f32 v196, v196, v197
v_mfma_f32_16x16x32_bf16 v[68:71], v[252:255], v[200:203], v[68:71]
ds_read_b64_tr_b16 v[244:245], v249 offset:51552
ds_read_b64_tr_b16 v[246:247], v249 offset:60000
v_mfma_f32_16x16x32_bf16 v[80:83], v[224:227], v[200:203], v[80:83]
v_exp_f32_e64 v208, v208
v_mfma_f32_16x16x32_bf16 v[88:91], v[224:227], v[204:207], v[88:91]
ds_read_b128 v[224:227], v248 offset:16896
s_waitcnt lgkmcnt(5)
v_mfma_f32_16x16x32_bf16 v[92:95], v[228:231], v[204:207], v[92:95]
v_exp_f32 v209, v209
v_mfma_f32_16x16x32_bf16 v[84:87], v[228:231], v[200:203], v[84:87]
ds_read_b128 v[228:231], v248 offset:16960
v_add_f32_e64 v250, v250, v208
v_mfma_f32_16x16x32_bf16 v[96:99], v[232:235], v[200:203], v[96:99]
v_add_f32_e64 v250, v250, v209
v_cvt_pk_bf16_f32 v194, v208, v209
v_mfma_f32_16x16x32_bf16 v[104:107], v[232:235], v[204:207], v[104:107]
ds_read_b128 v[232:235], v248 offset:17152
v_cvt_pk_bf16_f32 v197, v198, v199
v_mfma_f32_16x16x32_bf16 v[108:111], v[236:239], v[204:207], v[108:111]
v_exp_f32_e64 v212, v212
v_mfma_f32_16x16x32_bf16 v[100:103], v[236:239], v[200:203], v[100:103]
ds_read_b128 v[236:239], v248 offset:17216
s_waitcnt lgkmcnt(4)
v_mfma_f32_16x16x32_bf16 v[112:115], v[240:243], v[200:203], v[112:115]
v_exp_f32 v213, v213
v_mfma_f32_16x16x32_bf16 v[120:123], v[240:243], v[204:207], v[120:123]
ds_read_b128 v[240:243], v248 offset:17408
v_add_f32_e64 v251, v251, v212
v_mfma_f32_16x16x32_bf16 v[124:127], v[244:247], v[204:207], v[124:127]
v_add_f32 v251, v251, v213
s_waitcnt lgkmcnt(2)
v_mfma_f32_16x16x32_bf16 v[116:119], v[244:247], v[200:203], v[116:119]
ds_read_b128 v[244:247], v248 offset:17472
L_it0:
v_mfma_f32_16x16x32_bf16 v[200:203], v[224:227], v[128:131], v[216:219]
v_exp_f32_e64 v210, v210
v_mfma_f32_16x16x32_bf16 v[204:207], v[224:227], v[132:135], v[220:223]
ds_read_b128 v[252:255], v248 offset:17664
v_add_f32_e64 v250, v250, v210
v_mfma_f32_16x16x32_bf16 v[204:207], v[228:231], v[140:143], v[204:207]
v_exp_f32_e64 v211, v211
v_mfma_f32_16x16x32_bf16 v[200:203], v[228:231], v[136:139], v[200:203]
ds_read_b128 v[224:227], v248 offset:17728
v_add_f32_e64 v250, v250, v211
v_mfma_f32_16x16x32_bf16 v[200:203], v[232:235], v[144:147], v[200:203]
v_exp_f32_e64 v214, v214
v_mfma_f32_16x16x32_bf16 v[204:207], v[232:235], v[148:151], v[204:207]
ds_read_b128 v[228:231], v248 offset:25344
s_waitcnt lgkmcnt(3)
v_mfma_f32_16x16x32_bf16 v[204:207], v[236:239], v[156:159], v[204:207]
v_exp_f32 v215, v215
v_mfma_f32_16x16x32_bf16 v[200:203], v[236:239], v[152:155], v[200:203]
ds_read_b128 v[232:235], v248 offset:25408
v_add_f32_e64 v251, v251, v214
v_mfma_f32_16x16x32_bf16 v[200:203], v[240:243], v[160:163], v[200:203]
v_add_f32_e64 v251, v251, v215
v_cvt_pk_bf16_f32 v195, v210, v211
v_mfma_f32_16x16x32_bf16 v[204:207], v[240:243], v[164:167], v[204:207]
ds_read_b128 v[236:239], v248 offset:25600
v_cvt_pk_bf16_f32 v198, v212, v213
v_mfma_f32_16x16x32_bf16 v[204:207], v[244:247], v[172:175], v[204:207]
v_cvt_pk_bf16_f32 v199, v214, v215
v_mfma_f32_16x16x32_bf16 v[200:203], v[244:247], v[168:171], v[200:203]
ds_read_b128 v[240:243], v248 offset:25664
s_waitcnt lgkmcnt(3)
v_mfma_f32_16x16x32_bf16 v[200:203], v[252:255], v[176:179], v[200:203]
s_nop 0
v_mfma_f32_16x16x32_bf16 v[204:207], v[252:255], v[180:183], v[204:207]
ds_read_b128 v[244:247], v248 offset:25856
v_mfma_f32_16x16x32_bf16 v[204:207], v[224:227], v[188:191], v[204:207]
v_mfma_f32_16x16x32_bf16 v[200:203], v[224:227], v[184:187], v[200:203]
ds_read_b128 v[224:227], v248 offset:25920
s_barrier
v_mfma_f32_16x16x32_bf16 v[208:211], v[228:231], v[128:131], v[216:219]
s_nop 0
v_mfma_f32_16x16x32_bf16 v[212:215], v[228:231], v[132:135], v[220:223]
ds_read_b128 v[228:231], v248 offset:26112
s_waitcnt lgkmcnt(3)
v_mfma_f32_16x16x32_bf16 v[212:215], v[232:235], v[140:143], v[212:215]
s_nop 0
v_mfma_f32_16x16x32_bf16 v[208:211], v[232:235], v[136:139], v[208:211]
ds_read_b128 v[232:235], v248 offset:26176
v_mfma_f32_16x16x32_bf16 v[208:211], v[236:239], v[144:147], v[208:211]
v_exp_f32_e64 v200, v200
v_mfma_f32_16x16x32_bf16 v[212:215], v[236:239], v[148:151], v[212:215]
ds_read_b64_tr_b16 v[236:237], v249 offset:0
ds_read_b64_tr_b16 v[238:239], v249 offset:8448
v_mfma_f32_16x16x32_bf16 v[212:215], v[240:243], v[156:159], v[212:215]
v_add_f32 v250, v250, v200
s_waitcnt lgkmcnt(3)
v_mfma_f32_16x16x32_bf16 v[208:211], v[240:243], v[152:155], v[208:211]
ds_read_b64_tr_b16 v[240:241], v249 offset:32
ds_read_b64_tr_b16 v[242:243], v249 offset:8480
v_mfma_f32_16x16x32_bf16 v[208:211], v[244:247], v[160:163], v[208:211]
v_exp_f32_e64 v201, v201
v_mfma_f32_16x16x32_bf16 v[212:215], v[244:247], v[164:167], v[212:215]
ds_read_b64_tr_b16 v[244:245], v249 offset:64
ds_read_b64_tr_b16 v[246:247], v249 offset:8512
v_mfma_f32_16x16x32_bf16 v[212:215], v[224:227], v[172:175], v[212:215]
v_exp_f32_e64 v204, v204
v_mfma_f32_16x16x32_bf16 v[208:211], v[224:227], v[168:171], v[208:211]
ds_read_b64_tr_b16 v[224:225], v249 offset:96
ds_read_b64_tr_b16 v[226:227], v249 offset:8544
v_mfma_f32_16x16x32_bf16 v[208:211], v[228:231], v[176:179], v[208:211]
v_add_f32 v250, v250, v201
s_waitcnt lgkmcnt(4)
v_mfma_f32_16x16x32_bf16 v[212:215], v[228:231], v[180:183], v[212:215]
ds_read_b64_tr_b16 v[228:229], v249 offset:256
ds_read_b64_tr_b16 v[230:231], v249 offset:8704
v_mfma_f32_16x16x32_bf16 v[212:215], v[232:235], v[188:191], v[212:215]
v_add_f32_e64 v251, v251, v204
v_cvt_pk_bf16_f32 v200, v200, v201
v_mfma_f32_16x16x32_bf16 v[208:211], v[232:235], v[184:187], v[208:211]
ds_read_b64_tr_b16 v[232:233], v249 offset:288
ds_read_b64_tr_b16 v[234:235], v249 offset:8736
v_mfma_f32_16x16x32_bf16 v[0:3], v[236:239], v[192:195], v[0:3]
v_exp_f32_e64 v205, v205
v_mfma_f32_16x16x32_bf16 v[8:11], v[236:239], v[196:199], v[8:11]
ds_read_b64_tr_b16 v[236:237], v249 offset:320
ds_read_b64_tr_b16 v[238:239], v249 offset:8768
v_mfma_f32_16x16x32_bf16 v[12:15], v[240:243], v[196:199], v[12:15]
v_add_f32 v251, v251, v205
s_waitcnt lgkmcnt(4)
v_mfma_f32_16x16x32_bf16 v[4:7], v[240:243], v[192:195], v[4:7]
ds_read_b64_tr_b16 v[240:241], v249 offset:352
ds_read_b64_tr_b16 v[242:243], v249 offset:8800
v_mfma_f32_16x16x32_bf16 v[16:19], v[244:247], v[192:195], v[16:19]
v_exp_f32_e64 v202, v202
v_mfma_f32_16x16x32_bf16 v[24:27], v[244:247], v[196:199], v[24:27]
ds_read_b64_tr_b16 v[244:245], v249 offset:512
ds_read_b64_tr_b16 v[246:247], v249 offset:8960
v_mfma_f32_16x16x32_bf16 v[28:31], v[224:227], v[196:199], v[28:31]
v_exp_f32_e64 v203, v203
v_mfma_f32_16x16x32_bf16 v[20:23], v[224:227], v[192:195], v[20:23]
ds_read_b64_tr_b16 v[252:253], v249 offset:544
ds_read_b64_tr_b16 v[254:255], v249 offset:8992
v_mfma_f32_16x16x32_bf16 v[32:35], v[228:231], v[192:195], v[32:35]
v_add_f32 v250, v250, v202
s_waitcnt lgkmcnt(4)
v_mfma_f32_16x16x32_bf16 v[40:43], v[228:231], v[196:199], v[40:43]
ds_read_b64_tr_b16 v[224:225], v249 offset:576
ds_read_b64_tr_b16 v[226:227], v249 offset:9024
v_mfma_f32_16x16x32_bf16 v[44:47], v[232:235], v[196:199], v[44:47]
v_add_f32_e64 v250, v250, v203
v_cvt_pk_bf16_f32 v201, v202, v203
v_mfma_f32_16x16x32_bf16 v[36:39], v[232:235], v[192:195], v[36:39]
ds_read_b64_tr_b16 v[228:229], v249 offset:608
ds_read_b64_tr_b16 v[230:231], v249 offset:9056
v_mfma_f32_16x16x32_bf16 v[48:51], v[236:239], v[192:195], v[48:51]
v_exp_f32_e64 v206, v206
v_mfma_f32_16x16x32_bf16 v[56:59], v[236:239], v[196:199], v[56:59]
ds_read_b64_tr_b16 v[232:233], v249 offset:768
ds_read_b64_tr_b16 v[234:235], v249 offset:9216
v_mfma_f32_16x16x32_bf16 v[60:63], v[240:243], v[196:199], v[60:63]
v_add_f32 v251, v251, v206
s_waitcnt lgkmcnt(4)
v_mfma_f32_16x16x32_bf16 v[52:55], v[240:243], v[192:195], v[52:55]
ds_read_b64_tr_b16 v[236:237], v249 offset:800
ds_read_b64_tr_b16 v[238:239], v249 offset:9248
v_mfma_f32_16x16x32_bf16 v[64:67], v[244:247], v[192:195], v[64:67]
v_exp_f32_e64 v207, v207
v_mfma_f32_16x16x32_bf16 v[72:75], v[244:247], v[196:199], v[72:75]
ds_read_b64_tr_b16 v[240:241], v249 offset:832
ds_read_b64_tr_b16 v[242:243], v249 offset:9280
v_mfma_f32_16x16x32_bf16 v[76:79], v[252:255], v[196:199], v[76:79]
v_add_f32_e64 v251, v251, v207
v_cvt_pk_bf16_f32 v204, v204, v205
v_mfma_f32_16x16x32_bf16 v[68:71], v[252:255], v[192:195], v[68:71]
ds_read_b64_tr_b16 v[244:245], v249 offset:864
ds_read_b64_tr_b16 v[246:247], v249 offset:9312
v_mfma_f32_16x16x32_bf16 v[80:83], v[224:227], v[192:195], v[80:83]
v_exp_f32_e64 v208, v208
v_mfma_f32_16x16x32_bf16 v[88:91], v[224:227], v[196:199], v[88:91]
ds_read_b128 v[224:227], v248 offset:33792
s_waitcnt lgkmcnt(5)
v_mfma_f32_16x16x32_bf16 v[92:95], v[228:231], v[196:199], v[92:95]
v_exp_f32 v209, v209
v_mfma_f32_16x16x32_bf16 v[84:87], v[228:231], v[192:195], v[84:87]
ds_read_b128 v[228:231], v248 offset:33856
v_add_f32_e64 v250, v250, v208
v_mfma_f32_16x16x32_bf16 v[96:99], v[232:235], v[192:195], v[96:99]
v_add_f32_e64 v250, v250, v209
v_cvt_pk_bf16_f32 v202, v208, v209
v_mfma_f32_16x16x32_bf16 v[104:107], v[232:235], v[196:199], v[104:107]
ds_read_b128 v[232:235], v248 offset:34048
v_cvt_pk_bf16_f32 v205, v206, v207
v_mfma_f32_16x16x32_bf16 v[108:111], v[236:239], v[196:199], v[108:111]
v_exp_f32_e64 v212, v212
v_mfma_f32_16x16x32_bf16 v[100:103], v[236:239], v[192:195], v[100:103]
ds_read_b128 v[236:239], v248 offset:34112
s_waitcnt lgkmcnt(4)
v_mfma_f32_16x16x32_bf16 v[112:115], v[240:243], v[192:195], v[112:115]
v_exp_f32 v213, v213
v_mfma_f32_16x16x32_bf16 v[120:123], v[240:243], v[196:199], v[120:123]
ds_read_b128 v[240:243], v248 offset:34304
v_add_f32_e64 v251, v251, v212
v_mfma_f32_16x16x32_bf16 v[124:127], v[244:247], v[196:199], v[124:127]
v_add_f32 v251, v251, v213
s_waitcnt lgkmcnt(2)
v_mfma_f32_16x16x32_bf16 v[116:119], v[244:247], v[192:195], v[116:119]
ds_read_b128 v[244:247], v248 offset:34368
v_mfma_f32_16x16x32_bf16 v[192:195], v[224:227], v[128:131], v[216:219]
v_exp_f32_e64 v210, v210
v_mfma_f32_16x16x32_bf16 v[196:199], v[224:227], v[132:135], v[220:223]
ds_read_b128 v[252:255], v248 offset:34560
v_add_f32_e64 v250, v250, v210
v_mfma_f32_16x16x32_bf16 v[196:199], v[228:231], v[140:143], v[196:199]
v_exp_f32_e64 v211, v211
v_mfma_f32_16x16x32_bf16 v[192:195], v[228:231], v[136:139], v[192:195]
ds_read_b128 v[224:227], v248 offset:34624
v_add_f32_e64 v250, v250, v211
v_mfma_f32_16x16x32_bf16 v[192:195], v[232:235], v[144:147], v[192:195]
v_exp_f32_e64 v214, v214
v_mfma_f32_16x16x32_bf16 v[196:199], v[232:235], v[148:151], v[196:199]
ds_read_b128 v[228:231], v248 offset:42240
s_waitcnt lgkmcnt(3)
v_mfma_f32_16x16x32_bf16 v[196:199], v[236:239], v[156:159], v[196:199]
v_exp_f32 v215, v215
v_mfma_f32_16x16x32_bf16 v[192:195], v[236:239], v[152:155], v[192:195]
ds_read_b128 v[232:235], v248 offset:42304
v_add_f32_e64 v251, v251, v214
v_mfma_f32_16x16x32_bf16 v[192:195], v[240:243], v[160:163], v[192:195]
v_add_f32_e64 v251, v251, v215
v_cvt_pk_bf16_f32 v203, v210, v211
v_mfma_f32_16x16x32_bf16 v[196:199], v[240:243], v[164:167], v[196:199]
ds_read_b128 v[236:239], v248 offset:42496
v_cvt_pk_bf16_f32 v206, v212, v213
v_mfma_f32_16x16x32_bf16 v[196:199], v[244:247], v[172:175], v[196:199]
v_cvt_pk_bf16_f32 v207, v214, v215
v_mfma_f32_16x16x32_bf16 v[192:195], v[244:247], v[168:171], v[192:195]
ds_read_b128 v[240:243], v248 offset:42560
s_waitcnt lgkmcnt(3)
v_mfma_f32_16x16x32_bf16 v[192:195], v[252:255], v[176:179], v[192:195]
s_nop 0
v_mfma_f32_16x16x32_bf16 v[196:199], v[252:255], v[180:183], v[196:199]
ds_read_b128 v[244:247], v248 offset:42752
v_mfma_f32_16x16x32_bf16 v[196:199], v[224:227], v[188:191], v[196:199]
v_mfma_f32_16x16x32_bf16 v[192:195], v[224:227], v[184:187], v[192:195]
ds_read_b128 v[224:227], v248 offset:42816
s_barrier
v_mfma_f32_16x16x32_bf16 v[208:211], v[228:231], v[128:131], v[216:219]
s_nop 0
v_mfma_f32_16x16x32_bf16 v[212:215], v[228:231], v[132:135], v[220:223]
ds_read_b128 v[228:231], v248 offset:43008
s_waitcnt lgkmcnt(3)
v_mfma_f32_16x16x32_bf16 v[212:215], v[232:235], v[140:143], v[212:215]
s_nop 0
v_mfma_f32_16x16x32_bf16 v[208:211], v[232:235], v[136:139], v[208:211]
ds_read_b128 v[232:235], v248 offset:43072
v_mfma_f32_16x16x32_bf16 v[208:211], v[236:239], v[144:147], v[208:211]
v_exp_f32_e64 v192, v192
v_mfma_f32_16x16x32_bf16 v[212:215], v[236:239], v[148:151], v[212:215]
ds_read_b64_tr_b16 v[236:237], v249 offset:16896
ds_read_b64_tr_b16 v[238:239], v249 offset:25344
v_mfma_f32_16x16x32_bf16 v[212:215], v[240:243], v[156:159], v[212:215]
v_add_f32 v250, v250, v192
s_waitcnt lgkmcnt(3)
v_mfma_f32_16x16x32_bf16 v[208:211], v[240:243], v[152:155], v[208:211]
ds_read_b64_tr_b16 v[240:241], v249 offset:16928
ds_read_b64_tr_b16 v[242:243], v249 offset:25376
v_mfma_f32_16x16x32_bf16 v[208:211], v[244:247], v[160:163], v[208:211]
v_exp_f32_e64 v193, v193
v_mfma_f32_16x16x32_bf16 v[212:215], v[244:247], v[164:167], v[212:215]
ds_read_b64_tr_b16 v[244:245], v249 offset:16960
ds_read_b64_tr_b16 v[246:247], v249 offset:25408
v_mfma_f32_16x16x32_bf16 v[212:215], v[224:227], v[172:175], v[212:215]
v_exp_f32_e64 v196, v196
v_mfma_f32_16x16x32_bf16 v[208:211], v[224:227], v[168:171], v[208:211]
ds_read_b64_tr_b16 v[224:225], v249 offset:16992
ds_read_b64_tr_b16 v[226:227], v249 offset:25440
v_mfma_f32_16x16x32_bf16 v[208:211], v[228:231], v[176:179], v[208:211]
v_add_f32 v250, v250, v193
s_waitcnt lgkmcnt(4)
v_mfma_f32_16x16x32_bf16 v[212:215], v[228:231], v[180:183], v[212:215]
ds_read_b64_tr_b16 v[228:229], v249 offset:17152
ds_read_b64_tr_b16 v[230:231], v249 offset:25600
v_mfma_f32_16x16x32_bf16 v[212:215], v[232:235], v[188:191], v[212:215]
v_add_f32_e64 v251, v251, v196
v_cvt_pk_bf16_f32 v192, v192, v193
v_mfma_f32_16x16x32_bf16 v[208:211], v[232:235], v[184:187], v[208:211]
ds_read_b64_tr_b16 v[232:233], v249 offset:17184
ds_read_b64_tr_b16 v[234:235], v249 offset:25632
v_mfma_f32_16x16x32_bf16 v[0:3], v[236:239], v[200:203], v[0:3]
v_exp_f32_e64 v197, v197
v_mfma_f32_16x16x32_bf16 v[8:11], v[236:239], v[204:207], v[8:11]
ds_read_b64_tr_b16 v[236:237], v249 offset:17216
ds_read_b64_tr_b16 v[238:239], v249 offset:25664
v_mfma_f32_16x16x32_bf16 v[12:15], v[240:243], v[204:207], v[12:15]
v_add_f32 v251, v251, v197
s_waitcnt lgkmcnt(4)
v_mfma_f32_16x16x32_bf16 v[4:7], v[240:243], v[200:203], v[4:7]
ds_read_b64_tr_b16 v[240:241], v249 offset:17248
ds_read_b64_tr_b16 v[242:243], v249 offset:25696
v_mfma_f32_16x16x32_bf16 v[16:19], v[244:247], v[200:203], v[16:19]
v_exp_f32_e64 v194, v194
v_mfma_f32_16x16x32_bf16 v[24:27], v[244:247], v[204:207], v[24:27]
ds_read_b64_tr_b16 v[244:245], v249 offset:17408
ds_read_b64_tr_b16 v[246:247], v249 offset:25856
v_mfma_f32_16x16x32_bf16 v[28:31], v[224:227], v[204:207], v[28:31]
v_exp_f32_e64 v195, v195
v_mfma_f32_16x16x32_bf16 v[20:23], v[224:227], v[200:203], v[20:23]
ds_read_b64_tr_b16 v[252:253], v249 offset:17440
ds_read_b64_tr_b16 v[254:255], v249 offset:25888
v_mfma_f32_16x16x32_bf16 v[32:35], v[228:231], v[200:203], v[32:35]
v_add_f32 v250, v250, v194
s_waitcnt lgkmcnt(4)
v_mfma_f32_16x16x32_bf16 v[40:43], v[228:231], v[204:207], v[40:43]
ds_read_b64_tr_b16 v[224:225], v249 offset:17472
ds_read_b64_tr_b16 v[226:227], v249 offset:25920
v_mfma_f32_16x16x32_bf16 v[44:47], v[232:235], v[204:207], v[44:47]
v_add_f32_e64 v250, v250, v195
v_cvt_pk_bf16_f32 v193, v194, v195
v_mfma_f32_16x16x32_bf16 v[36:39], v[232:235], v[200:203], v[36:39]
ds_read_b64_tr_b16 v[228:229], v249 offset:17504
ds_read_b64_tr_b16 v[230:231], v249 offset:25952
v_mfma_f32_16x16x32_bf16 v[48:51], v[236:239], v[200:203], v[48:51]
v_exp_f32_e64 v198, v198
v_mfma_f32_16x16x32_bf16 v[56:59], v[236:239], v[204:207], v[56:59]
ds_read_b64_tr_b16 v[232:233], v249 offset:17664
ds_read_b64_tr_b16 v[234:235], v249 offset:26112
v_mfma_f32_16x16x32_bf16 v[60:63], v[240:243], v[204:207], v[60:63]
v_add_f32 v251, v251, v198
s_waitcnt lgkmcnt(4)
v_mfma_f32_16x16x32_bf16 v[52:55], v[240:243], v[200:203], v[52:55]
ds_read_b64_tr_b16 v[236:237], v249 offset:17696
ds_read_b64_tr_b16 v[238:239], v249 offset:26144
v_mfma_f32_16x16x32_bf16 v[64:67], v[244:247], v[200:203], v[64:67]
v_exp_f32_e64 v199, v199
v_mfma_f32_16x16x32_bf16 v[72:75], v[244:247], v[204:207], v[72:75]
ds_read_b64_tr_b16 v[240:241], v249 offset:17728
ds_read_b64_tr_b16 v[242:243], v249 offset:26176
v_mfma_f32_16x16x32_bf16 v[76:79], v[252:255], v[204:207], v[76:79]
v_add_f32_e64 v251, v251, v199
v_cvt_pk_bf16_f32 v196, v196, v197
v_mfma_f32_16x16x32_bf16 v[68:71], v[252:255], v[200:203], v[68:71]
ds_read_b64_tr_b16 v[244:245], v249 offset:17760
ds_read_b64_tr_b16 v[246:247], v249 offset:26208
v_mfma_f32_16x16x32_bf16 v[80:83], v[224:227], v[200:203], v[80:83]
v_exp_f32_e64 v208, v208
v_mfma_f32_16x16x32_bf16 v[88:91], v[224:227], v[204:207], v[88:91]
ds_read_b128 v[224:227], v248 offset:50688
s_waitcnt lgkmcnt(5)
v_mfma_f32_16x16x32_bf16 v[92:95], v[228:231], v[204:207], v[92:95]
v_exp_f32 v209, v209
v_mfma_f32_16x16x32_bf16 v[84:87], v[228:231], v[200:203], v[84:87]
ds_read_b128 v[228:231], v248 offset:50752
v_add_f32_e64 v250, v250, v208
v_mfma_f32_16x16x32_bf16 v[96:99], v[232:235], v[200:203], v[96:99]
v_add_f32_e64 v250, v250, v209
v_cvt_pk_bf16_f32 v194, v208, v209
v_mfma_f32_16x16x32_bf16 v[104:107], v[232:235], v[204:207], v[104:107]
ds_read_b128 v[232:235], v248 offset:50944
v_cvt_pk_bf16_f32 v197, v198, v199
v_mfma_f32_16x16x32_bf16 v[108:111], v[236:239], v[204:207], v[108:111]
v_exp_f32_e64 v212, v212
v_mfma_f32_16x16x32_bf16 v[100:103], v[236:239], v[200:203], v[100:103]
ds_read_b128 v[236:239], v248 offset:51008
s_waitcnt lgkmcnt(4)
v_mfma_f32_16x16x32_bf16 v[112:115], v[240:243], v[200:203], v[112:115]
v_exp_f32 v213, v213
v_mfma_f32_16x16x32_bf16 v[120:123], v[240:243], v[204:207], v[120:123]
ds_read_b128 v[240:243], v248 offset:51200
v_add_f32_e64 v251, v251, v212
v_mfma_f32_16x16x32_bf16 v[124:127], v[244:247], v[204:207], v[124:127]
v_add_f32 v251, v251, v213
s_waitcnt lgkmcnt(2)
v_mfma_f32_16x16x32_bf16 v[116:119], v[244:247], v[200:203], v[116:119]
ds_read_b128 v[244:247], v248 offset:51264
v_mfma_f32_16x16x32_bf16 v[200:203], v[224:227], v[128:131], v[216:219]
v_exp_f32_e64 v210, v210
v_mfma_f32_16x16x32_bf16 v[204:207], v[224:227], v[132:135], v[220:223]
ds_read_b128 v[252:255], v248 offset:51456
v_add_f32_e64 v250, v250, v210
v_mfma_f32_16x16x32_bf16 v[204:207], v[228:231], v[140:143], v[204:207]
v_exp_f32_e64 v211, v211
v_mfma_f32_16x16x32_bf16 v[200:203], v[228:231], v[136:139], v[200:203]
ds_read_b128 v[224:227], v248 offset:51520
v_add_f32_e64 v250, v250, v211
v_mfma_f32_16x16x32_bf16 v[200:203], v[232:235], v[144:147], v[200:203]
v_exp_f32_e64 v214, v214
v_mfma_f32_16x16x32_bf16 v[204:207], v[232:235], v[148:151], v[204:207]
ds_read_b128 v[228:231], v248 offset:59136
s_waitcnt lgkmcnt(3)
v_mfma_f32_16x16x32_bf16 v[204:207], v[236:239], v[156:159], v[204:207]
v_exp_f32 v215, v215
v_mfma_f32_16x16x32_bf16 v[200:203], v[236:239], v[152:155], v[200:203]
ds_read_b128 v[232:235], v248 offset:59200
v_add_f32_e64 v251, v251, v214
v_mfma_f32_16x16x32_bf16 v[200:203], v[240:243], v[160:163], v[200:203]
v_add_f32_e64 v251, v251, v215
v_cvt_pk_bf16_f32 v195, v210, v211
v_mfma_f32_16x16x32_bf16 v[204:207], v[240:243], v[164:167], v[204:207]
ds_read_b128 v[236:239], v248 offset:59392
v_cvt_pk_bf16_f32 v198, v212, v213
v_mfma_f32_16x16x32_bf16 v[204:207], v[244:247], v[172:175], v[204:207]
v_cvt_pk_bf16_f32 v199, v214, v215
v_mfma_f32_16x16x32_bf16 v[200:203], v[244:247], v[168:171], v[200:203]
ds_read_b128 v[240:243], v248 offset:59456
s_waitcnt lgkmcnt(3)
v_mfma_f32_16x16x32_bf16 v[200:203], v[252:255], v[176:179], v[200:203]
s_nop 0
v_mfma_f32_16x16x32_bf16 v[204:207], v[252:255], v[180:183], v[204:207]
ds_read_b128 v[244:247], v248 offset:59648
v_mfma_f32_16x16x32_bf16 v[204:207], v[224:227], v[188:191], v[204:207]
v_mfma_f32_16x16x32_bf16 v[200:203], v[224:227], v[184:187], v[200:203]
ds_read_b128 v[224:227], v248 offset:59712
s_barrier
v_mfma_f32_16x16x32_bf16 v[208:211], v[228:231], v[128:131], v[216:219]
s_nop 0
v_mfma_f32_16x16x32_bf16 v[212:215], v[228:231], v[132:135], v[220:223]
ds_read_b128 v[228:231], v248 offset:59904
s_waitcnt lgkmcnt(3)
v_mfma_f32_16x16x32_bf16 v[212:215], v[232:235], v[140:143], v[212:215]
s_sub_u32 s75, s75, 1
v_mfma_f32_16x16x32_bf16 v[208:211], v[232:235], v[136:139], v[208:211]
ds_read_b128 v[232:235], v248 offset:59968
v_mfma_f32_16x16x32_bf16 v[208:211], v[236:239], v[144:147], v[208:211]
v_exp_f32_e64 v200, v200
v_mfma_f32_16x16x32_bf16 v[212:215], v[236:239], v[148:151], v[212:215]
ds_read_b64_tr_b16 v[236:237], v249 offset:33792
ds_read_b64_tr_b16 v[238:239], v249 offset:42240
v_mfma_f32_16x16x32_bf16 v[212:215], v[240:243], v[156:159], v[212:215]
v_add_f32 v250, v250, v200
s_waitcnt lgkmcnt(3)
v_mfma_f32_16x16x32_bf16 v[208:211], v[240:243], v[152:155], v[208:211]
ds_read_b64_tr_b16 v[240:241], v249 offset:33824
ds_read_b64_tr_b16 v[242:243], v249 offset:42272
v_mfma_f32_16x16x32_bf16 v[208:211], v[244:247], v[160:163], v[208:211]
v_exp_f32_e64 v201, v201
v_mfma_f32_16x16x32_bf16 v[212:215], v[244:247], v[164:167], v[212:215]
ds_read_b64_tr_b16 v[244:245], v249 offset:33856
ds_read_b64_tr_b16 v[246:247], v249 offset:42304
v_mfma_f32_16x16x32_bf16 v[212:215], v[224:227], v[172:175], v[212:215]
v_exp_f32_e64 v204, v204
v_mfma_f32_16x16x32_bf16 v[208:211], v[224:227], v[168:171], v[208:211]
ds_read_b64_tr_b16 v[224:225], v249 offset:33888
ds_read_b64_tr_b16 v[226:227], v249 offset:42336
v_mfma_f32_16x16x32_bf16 v[208:211], v[228:231], v[176:179], v[208:211]
v_add_f32 v250, v250, v201
s_waitcnt lgkmcnt(4)
v_mfma_f32_16x16x32_bf16 v[212:215], v[228:231], v[180:183], v[212:215]
ds_read_b64_tr_b16 v[228:229], v249 offset:34048
ds_read_b64_tr_b16 v[230:231], v249 offset:42496
v_mfma_f32_16x16x32_bf16 v[212:215], v[232:235], v[188:191], v[212:215]
v_add_f32_e64 v251, v251, v204
v_cvt_pk_bf16_f32 v200, v200, v201
v_mfma_f32_16x16x32_bf16 v[208:211], v[232:235], v[184:187], v[208:211]
ds_read_b64_tr_b16 v[232:233], v249 offset:34080
ds_read_b64_tr_b16 v[234:235], v249 offset:42528
v_mfma_f32_16x16x32_bf16 v[0:3], v[236:239], v[192:195], v[0:3]
v_exp_f32_e64 v205, v205
v_mfma_f32_16x16x32_bf16 v[8:11], v[236:239], v[196:199], v[8:11]
ds_read_b64_tr_b16 v[236:237], v249 offset:34112
ds_read_b64_tr_b16 v[238:239], v249 offset:42560
v_mfma_f32_16x16x32_bf16 v[12:15], v[240:243], v[196:199], v[12:15]
v_add_f32 v251, v251, v205
s_waitcnt lgkmcnt(4)
v_mfma_f32_16x16x32_bf16 v[4:7], v[240:243], v[192:195], v[4:7]
ds_read_b64_tr_b16 v[240:241], v249 offset:34144
ds_read_b64_tr_b16 v[242:243], v249 offset:42592
v_mfma_f32_16x16x32_bf16 v[16:19], v[244:247], v[192:195], v[16:19]
v_exp_f32_e64 v202, v202
v_mfma_f32_16x16x32_bf16 v[24:27], v[244:247], v[196:199], v[24:27]
ds_read_b64_tr_b16 v[244:245], v249 offset:34304
ds_read_b64_tr_b16 v[246:247], v249 offset:42752
v_mfma_f32_16x16x32_bf16 v[28:31], v[224:227], v[196:199], v[28:31]
v_exp_f32_e64 v203, v203
v_mfma_f32_16x16x32_bf16 v[20:23], v[224:227], v[192:195], v[20:23]
ds_read_b64_tr_b16 v[252:253], v249 offset:34336
ds_read_b64_tr_b16 v[254:255], v249 offset:42784
v_mfma_f32_16x16x32_bf16 v[32:35], v[228:231], v[192:195], v[32:35]
v_add_f32 v250, v250, v202
s_waitcnt lgkmcnt(4)
v_mfma_f32_16x16x32_bf16 v[40:43], v[228:231], v[196:199], v[40:43]
ds_read_b64_tr_b16 v[224:225], v249 offset:34368
ds_read_b64_tr_b16 v[226:227], v249 offset:42816
v_mfma_f32_16x16x32_bf16 v[44:47], v[232:235], v[196:199], v[44:47]
v_add_f32_e64 v250, v250, v203
v_cvt_pk_bf16_f32 v201, v202, v203
v_mfma_f32_16x16x32_bf16 v[36:39], v[232:235], v[192:195], v[36:39]
ds_read_b64_tr_b16 v[228:229], v249 offset:34400
ds_read_b64_tr_b16 v[230:231], v249 offset:42848
v_mfma_f32_16x16x32_bf16 v[48:51], v[236:239], v[192:195], v[48:51]
v_exp_f32_e64 v206, v206
v_mfma_f32_16x16x32_bf16 v[56:59], v[236:239], v[196:199], v[56:59]
ds_read_b64_tr_b16 v[232:233], v249 offset:34560
ds_read_b64_tr_b16 v[234:235], v249 offset:43008
v_mfma_f32_16x16x32_bf16 v[60:63], v[240:243], v[196:199], v[60:63]
v_add_f32 v251, v251, v206
s_waitcnt lgkmcnt(4)
v_mfma_f32_16x16x32_bf16 v[52:55], v[240:243], v[192:195], v[52:55]
ds_read_b64_tr_b16 v[236:237], v249 offset:34592
ds_read_b64_tr_b16 v[238:239], v249 offset:43040
v_mfma_f32_16x16x32_bf16 v[64:67], v[244:247], v[192:195], v[64:67]
v_exp_f32_e64 v207, v207
v_mfma_f32_16x16x32_bf16 v[72:75], v[244:247], v[196:199], v[72:75]
ds_read_b64_tr_b16 v[240:241], v249 offset:34624
ds_read_b64_tr_b16 v[242:243], v249 offset:43072
v_mfma_f32_16x16x32_bf16 v[76:79], v[252:255], v[196:199], v[76:79]
v_add_f32_e64 v251, v251, v207
v_cvt_pk_bf16_f32 v204, v204, v205
v_mfma_f32_16x16x32_bf16 v[68:71], v[252:255], v[192:195], v[68:71]
ds_read_b64_tr_b16 v[244:245], v249 offset:34656
ds_read_b64_tr_b16 v[246:247], v249 offset:43104
v_mfma_f32_16x16x32_bf16 v[80:83], v[224:227], v[192:195], v[80:83]
v_exp_f32_e64 v208, v208
v_mfma_f32_16x16x32_bf16 v[88:91], v[224:227], v[196:199], v[88:91]
ds_read_b128 v[224:227], v248 offset:0
s_waitcnt lgkmcnt(5)
v_mfma_f32_16x16x32_bf16 v[92:95], v[228:231], v[196:199], v[92:95]
v_exp_f32 v209, v209
v_mfma_f32_16x16x32_bf16 v[84:87], v[228:231], v[192:195], v[84:87]
ds_read_b128 v[228:231], v248 offset:64
v_add_f32_e64 v250, v250, v208
v_mfma_f32_16x16x32_bf16 v[96:99], v[232:235], v[192:195], v[96:99]
v_add_f32_e64 v250, v250, v209
v_cvt_pk_bf16_f32 v202, v208, v209
v_mfma_f32_16x16x32_bf16 v[104:107], v[232:235], v[196:199], v[104:107]
ds_read_b128 v[232:235], v248 offset:256
v_cvt_pk_bf16_f32 v205, v206, v207
v_mfma_f32_16x16x32_bf16 v[108:111], v[236:239], v[196:199], v[108:111]
v_exp_f32_e64 v212, v212
v_mfma_f32_16x16x32_bf16 v[100:103], v[236:239], v[192:195], v[100:103]
ds_read_b128 v[236:239], v248 offset:320
s_waitcnt lgkmcnt(4)
v_mfma_f32_16x16x32_bf16 v[112:115], v[240:243], v[192:195], v[112:115]
v_exp_f32 v213, v213
v_mfma_f32_16x16x32_bf16 v[120:123], v[240:243], v[196:199], v[120:123]
ds_read_b128 v[240:243], v248 offset:512
v_add_f32_e64 v251, v251, v212
v_mfma_f32_16x16x32_bf16 v[124:127], v[244:247], v[196:199], v[124:127]
v_add_f32 v251, v251, v213
s_waitcnt lgkmcnt(2)
v_mfma_f32_16x16x32_bf16 v[116:119], v[244:247], v[192:195], v[116:119]
ds_read_b128 v[244:247], v248 offset:576
s_cbranch_scc0 L_loop
L_tail:
s_barrier
s_waitcnt lgkmcnt(2)
ds_read_b64_tr_b16 v[236:237], v249 offset:50688
ds_read_b64_tr_b16 v[238:239], v249 offset:59136
s_waitcnt lgkmcnt(3)
ds_read_b64_tr_b16 v[240:241], v249 offset:50720
ds_read_b64_tr_b16 v[242:243], v249 offset:59168
s_waitcnt lgkmcnt(4)
ds_read_b64_tr_b16 v[244:245], v249 offset:50752
ds_read_b64_tr_b16 v[246:247], v249 offset:59200
ds_read_b64_tr_b16 v[224:225], v249 offset:50784
ds_read_b64_tr_b16 v[226:227], v249 offset:59232
ds_read_b64_tr_b16 v[228:229], v249 offset:50944
ds_read_b64_tr_b16 v[230:231], v249 offset:59392
ds_read_b64_tr_b16 v[232:233], v249 offset:50976
ds_read_b64_tr_b16 v[234:235], v249 offset:59424
v_exp_f32 v210, v210
s_nop 0
v_add_f32 v250, v250, v210
v_exp_f32 v211, v211
s_nop 0
v_add_f32 v250, v250, v211
v_exp_f32 v214, v214
v_exp_f32 v215, v215
v_add_f32 v251, v251, v214
v_add_f32_e64 v251, v251, v215
v_cvt_pk_bf16_f32 v203, v210, v211
v_cvt_pk_bf16_f32 v206, v212, v213
v_cvt_pk_bf16_f32 v207, v214, v215
s_waitcnt lgkmcnt(10)
v_mfma_f32_16x16x32_bf16 v[0:3], v[236:239], v[200:203], v[0:3]
v_mov_b32 v208, v250
s_nop 1
v_permlane16_swap_b32 v250, v208
v_mfma_f32_16x16x32_bf16 v[8:11], v[236:239], v[204:207], v[8:11]
ds_read_b64_tr_b16 v[236:237], v249 offset:51008
ds_read_b64_tr_b16 v[238:239], v249 offset:59456
s_waitcnt lgkmcnt(10)
v_mfma_f32_16x16x32_bf16 v[4:7], v[240:243], v[200:203], v[4:7]
v_add_f32 v250, v250, v208
v_mov_b32 v208, v250
s_waitcnt lgkmcnt(4)
v_mfma_f32_16x16x32_bf16 v[12:15], v[240:243], v[204:207], v[12:15]
ds_read_b64_tr_b16 v[240:241], v249 offset:51040
ds_read_b64_tr_b16 v[242:243], v249 offset:59488
v_mfma_f32_16x16x32_bf16 v[16:19], v[244:247], v[200:203], v[16:19]
v_permlane32_swap_b32 v250, v208
v_add_f32 v250, v250, v208
v_mfma_f32_16x16x32_bf16 v[24:27], v[244:247], v[204:207], v[24:27]
ds_read_b64_tr_b16 v[244:245], v249 offset:51200
ds_read_b64_tr_b16 v[246:247], v249 offset:59648
v_mfma_f32_16x16x32_bf16 v[20:23], v[224:227], v[200:203], v[20:23]
v_mov_b32_e64 v209, v251
s_nop 1
v_permlane16_swap_b32 v251, v209
v_mfma_f32_16x16x32_bf16 v[28:31], v[224:227], v[204:207], v[28:31]
ds_read_b64_tr_b16 v[252:253], v249 offset:51232
ds_read_b64_tr_b16 v[254:255], v249 offset:59680
v_mfma_f32_16x16x32_bf16 v[32:35], v[228:231], v[200:203], v[32:35]
v_add_f32_e64 v251, v251, v209
v_mov_b32 v209, v251
s_waitcnt lgkmcnt(4)
v_mfma_f32_16x16x32_bf16 v[40:43], v[228:231], v[204:207], v[40:43]
ds_read_b64_tr_b16 v[224:225], v249 offset:51264
ds_read_b64_tr_b16 v[226:227], v249 offset:59712
v_mfma_f32_16x16x32_bf16 v[36:39], v[232:235], v[200:203], v[36:39]
v_permlane32_swap_b32 v251, v209
v_add_f32 v251, v251, v209
v_mfma_f32_16x16x32_bf16 v[44:47], v[232:235], v[204:207], v[44:47]
ds_read_b64_tr_b16 v[228:229], v249 offset:51296
ds_read_b64_tr_b16 v[230:231], v249 offset:59744
v_mfma_f32_16x16x32_bf16 v[48:51], v[236:239], v[200:203], v[48:51]
v_max_f32 v208, v250, v251
v_add_f32 v209, v250, v251
v_mfma_f32_16x16x32_bf16 v[56:59], v[236:239], v[204:207], v[56:59]
ds_read_b64_tr_b16 v[232:233], v249 offset:51456
ds_read_b64_tr_b16 v[234:235], v249 offset:59904
v_mfma_f32_16x16x32_bf16 v[52:55], v[240:243], v[200:203], v[52:55]
v_rcp_f32_e64 v250, v250
v_rcp_f32 v251, v251
s_waitcnt lgkmcnt(4)
v_mfma_f32_16x16x32_bf16 v[60:63], v[240:243], v[204:207], v[60:63]
ds_read_b64_tr_b16 v[236:237], v249 offset:51488
ds_read_b64_tr_b16 v[238:239], v249 offset:59936
v_mfma_f32_16x16x32_bf16 v[64:67], v[244:247], v[200:203], v[64:67]
v_mbcnt_lo_u32_b32 v210, -1, 0
v_mbcnt_hi_u32_b32 v210, -1, v210
v_mfma_f32_16x16x32_bf16 v[72:75], v[244:247], v[204:207], v[72:75]
ds_read_b64_tr_b16 v[240:241], v249 offset:51520
ds_read_b64_tr_b16 v[242:243], v249 offset:59968
v_mfma_f32_16x16x32_bf16 v[68:71], v[252:255], v[200:203], v[68:71]
v_lshrrev_b32_e64 v211, 4, v210
v_bfe_u32 v212, v210, 2, 2
v_mfma_f32_16x16x32_bf16 v[76:79], v[252:255], v[204:207], v[76:79]
ds_read_b64_tr_b16 v[244:245], v249 offset:51552
ds_read_b64_tr_b16 v[246:247], v249 offset:60000
v_mfma_f32_16x16x32_bf16 v[80:83], v[224:227], v[200:203], v[80:83]
v_and_b32 v213, 3, v210
v_lshrrev_b32 v212, 2, v210
v_mfma_f32_16x16x32_bf16 v[88:91], v[224:227], v[204:207], v[88:91]
v_lshlrev_b32_e64 v192, 7, v212
v_lshl_add_u32 v192, v213, 3, v192
s_waitcnt lgkmcnt(4)
v_mfma_f32_16x16x32_bf16 v[84:87], v[228:231], v[200:203], v[84:87]
v_bfe_u32 v212, v210, 3, 2
v_lshl_add_u32 v192, v212, 5, v192
v_mfma_f32_16x16x32_bf16 v[92:95], v[228:231], v[204:207], v[92:95]
v_xor_b32 v193, 32, v192
v_xor_b32_e64 v194, 64, v192
v_mfma_f32_16x16x32_bf16 v[96:99], v[232:235], v[200:203], v[96:99]
v_xor_b32 v195, 96, v192
v_add_u32 v196, 101376, v192
v_mfma_f32_16x16x32_bf16 v[104:107], v[232:235], v[204:207], v[104:107]
v_add_u32 v197, 101376, v193
v_add_u32 v198, 101376, v194
v_mfma_f32_16x16x32_bf16 v[100:103], v[236:239], v[200:203], v[100:103]
v_add_u32 v199, 101376, v195
v_lshlrev_b32_e64 v248, 4, v210
v_mfma_f32_16x16x32_bf16 v[108:111], v[236:239], v[204:207], v[108:111]
v_mov_b32 v214, 135136
v_mov_b32 v215, 1
s_waitcnt lgkmcnt(0)
v_mfma_f32_16x16x32_bf16 v[112:115], v[240:243], v[200:203], v[112:115]
v_mfma_f32_16x16x32_bf16 v[120:123], v[240:243], v[204:207], v[120:123]
v_mfma_f32_16x16x32_bf16 v[116:119], v[244:247], v[200:203], v[116:119]
v_mfma_f32_16x16x32_bf16 v[124:127], v[244:247], v[204:207], v[124:127]
v_cmp_ngt_f32 vcc, 0x5f800000, v209
s_cbranch_vccz L_noflag
ds_write_b32 v214, v215
s_waitcnt lgkmcnt(0)
L_noflag:
s_barrier
ds_read_b32 v215, v214
ds_read_b64_tr_b16 v[216:217], v196 offset:33792
ds_read_b64_tr_b16 v[218:219], v196 offset:35840
ds_read_b64_tr_b16 v[220:221], v197 offset:33792
ds_read_b64_tr_b16 v[222:223], v197 offset:35840
ds_read_b64_tr_b16 v[224:225], v198 offset:33792
ds_read_b64_tr_b16 v[226:227], v198 offset:35840
ds_read_b64_tr_b16 v[228:229], v199 offset:33792
ds_read_b64_tr_b16 v[230:231], v199 offset:35840
ds_read_b64_tr_b16 v[232:233], v196 offset:37888
ds_read_b64_tr_b16 v[234:235], v196 offset:39936
ds_read_b64_tr_b16 v[236:237], v197 offset:37888
ds_read_b64_tr_b16 v[238:239], v197 offset:39936
ds_read_b64_tr_b16 v[240:241], v198 offset:37888
ds_read_b64_tr_b16 v[242:243], v198 offset:39936
v_add_u32 v200, 50688, v192
v_add_u32 v201, 50688, v193
v_add_u32 v202, 50688, v194
v_add_u32 v203, 50688, v195
v_mov_b32 v249, 0
v_mov_b32 v254, 1
v_add_u32 v204, s85, v248
v_add_u32 v205, s90, v248
v_mul_f32 v0, v0, v250
v_mul_f32 v1, v1, v250
v_mul_f32 v2, v2, v250
v_mul_f32 v3, v3, v250
v_mul_f32 v4, v4, v250
v_mul_f32 v5, v5, v250
v_mul_f32 v6, v6, v250
v_mul_f32_e64 v7, v7, v250
v_cvt_pk_bf16_f32 v0, v0, v1
v_cvt_pk_bf16_f32 v1, v2, v3
v_cvt_pk_bf16_f32 v2, v4, v5
v_cvt_pk_bf16_f32 v3, v6, v7
v_mul_f32 v8, v8, v251
v_mul_f32 v9, v9, v251
v_mul_f32 v10, v10, v251
v_mul_f32 v11, v11, v251
v_mul_f32 v12, v12, v251
v_mul_f32 v13, v13, v251
v_mul_f32 v14, v14, v251
v_mul_f32 v15, v15, v251
v_cvt_pk_bf16_f32 v4, v8, v9
v_cvt_pk_bf16_f32 v5, v10, v11
v_cvt_pk_bf16_f32 v6, v12, v13
v_cvt_pk_bf16_f32 v7, v14, v15
s_waitcnt lgkmcnt(14)
v_readfirstlane_b32 s7, v215
s_andn2_b32 s7, s7, s79
s_cbranch_scc1 L_maxpass
s_waitcnt lgkmcnt(12)
v_mfma_f32_16x16x32_bf16 v[128:131], v[216:219], v[0:3], 0
v_mul_f32 v16, v16, v250
v_mul_f32 v17, v17, v250
v_mul_f32 v18, v18, v250
v_mul_f32 v19, v19, v250
v_mul_f32 v20, v20, v250
v_mul_f32_e64 v21, v21, v250
v_mfma_f32_16x16x32_bf16 v[136:139], v[216:219], v[4:7], 0
ds_read_b64_tr_b16 v[244:245], v199 offset:37888
ds_read_b64_tr_b16 v[246:247], v199 offset:39936
s_waitcnt lgkmcnt(12)
v_mfma_f32_16x16x32_bf16 v[140:143], v[220:223], v[4:7], 0
v_mul_f32 v22, v22, v250
v_mul_f32_e64 v23, v23, v250
v_cvt_pk_bf16_f32 v8, v16, v17
v_cvt_pk_bf16_f32 v9, v18, v19
v_cvt_pk_bf16_f32 v10, v20, v21
v_cvt_pk_bf16_f32 v11, v22, v23
v_mfma_f32_16x16x32_bf16 v[132:135], v[220:223], v[0:3], 0
ds_read_b64_tr_b16 v[216:217], v196 offset:41984
ds_read_b64_tr_b16 v[218:219], v196 offset:44032
s_waitcnt lgkmcnt(12)
v_mfma_f32_16x16x32_bf16 v[144:147], v[224:227], v[0:3], 0
v_mul_f32 v24, v24, v251
v_mul_f32 v25, v25, v251
v_mul_f32 v26, v26, v251
v_mul_f32 v27, v27, v251
v_mul_f32 v28, v28, v251
v_mul_f32_e64 v29, v29, v251
v_mfma_f32_16x16x32_bf16 v[152:155], v[224:227], v[4:7], 0
ds_read_b64_tr_b16 v[220:221], v197 offset:41984
ds_read_b64_tr_b16 v[222:223], v197 offset:44032
s_waitcnt lgkmcnt(12)
v_mfma_f32_16x16x32_bf16 v[156:159], v[228:231], v[4:7], 0
v_mul_f32 v30, v30, v251
v_mul_f32_e64 v31, v31, v251
v_cvt_pk_bf16_f32 v12, v24, v25
v_cvt_pk_bf16_f32 v13, v26, v27
v_cvt_pk_bf16_f32 v14, v28, v29
v_cvt_pk_bf16_f32 v15, v30, v31
s_waitcnt lgkmcnt(4)
v_mfma_f32_16x16x32_bf16 v[148:151], v[228:231], v[0:3], 0
ds_read_b64_tr_b16 v[224:225], v198 offset:41984
ds_read_b64_tr_b16 v[226:227], v198 offset:44032
v_mfma_f32_16x16x32_bf16 v[128:131], v[232:235], v[8:11], v[128:131]
v_mul_f32 v32, v32, v250
v_mul_f32 v33, v33, v250
v_mul_f32 v34, v34, v250
v_mul_f32 v35, v35, v250
v_mul_f32 v36, v36, v250
v_mul_f32_e64 v37, v37, v250
v_mfma_f32_16x16x32_bf16 v[136:139], v[232:235], v[12:15], v[136:139]
ds_read_b64_tr_b16 v[228:229], v199 offset:41984
ds_read_b64_tr_b16 v[230:231], v199 offset:44032
v_mfma_f32_16x16x32_bf16 v[140:143], v[236:239], v[12:15], v[140:143]
v_mul_f32 v38, v38, v250
v_mul_f32 v39, v39, v250
v_cvt_pk_bf16_f32 v16, v32, v33
v_cvt_pk_bf16_f32 v17, v34, v35
v_cvt_pk_bf16_f32 v18, v36, v37
v_cvt_pk_bf16_f32 v19, v38, v39
v_mfma_f32_16x16x32_bf16 v[132:135], v[236:239], v[8:11], v[132:135]
ds_read_b64_tr_b16 v[232:233], v196 offset:46080
ds_read_b64_tr_b16 v[234:235], v196 offset:48128
v_mfma_f32_16x16x32_bf16 v[144:147], v[240:243], v[8:11], v[144:147]
v_mul_f32 v40, v40, v251
v_mul_f32 v41, v41, v251
v_mul_f32 v42, v42, v251
v_mul_f32 v43, v43, v251
v_mul_f32 v44, v44, v251
v_mul_f32 v45, v45, v251
v_mfma_f32_16x16x32_bf16 v[152:155], v[240:243], v[12:15], v[152:155]
ds_read_b64_tr_b16 v[236:237], v197 offset:46080
ds_read_b64_tr_b16 v[238:239], v197 offset:48128
v_mfma_f32_16x16x32_bf16 v[156:159], v[244:247], v[12:15], v[156:159]
v_mul_f32 v46, v46, v251
v_mul_f32 v47, v47, v251
v_cvt_pk_bf16_f32 v20, v40, v41
v_cvt_pk_bf16_f32 v21, v42, v43
v_cvt_pk_bf16_f32 v22, v44, v45
v_cvt_pk_bf16_f32 v23, v46, v47
s_waitcnt lgkmcnt(4)
v_mfma_f32_16x16x32_bf16 v[148:151], v[244:247], v[8:11], v[148:151]
ds_read_b64_tr_b16 v[240:241], v198 offset:46080
ds_read_b64_tr_b16 v[242:243], v198 offset:48128
v_mfma_f32_16x16x32_bf16 v[128:131], v[216:219], v[16:19], v[128:131]
v_mul_f32 v48, v48, v250
v_mul_f32 v49, v49, v250
v_mul_f32 v50, v50, v250
v_mul_f32 v51, v51, v250
v_mul_f32 v52, v52, v250
v_mul_f32_e64 v53, v53, v250
v_mfma_f32_16x16x32_bf16 v[136:139], v[216:219], v[20:23], v[136:139]
ds_read_b64_tr_b16 v[244:245], v199 offset:46080
ds_read_b64_tr_b16 v[246:247], v199 offset:48128
v_mfma_f32_16x16x32_bf16 v[140:143], v[220:223], v[20:23], v[140:143]
v_mul_f32 v54, v54, v250
v_mul_f32 v55, v55, v250
v_cvt_pk_bf16_f32 v24, v48, v49
v_cvt_pk_bf16_f32 v25, v50, v51
v_cvt_pk_bf16_f32 v26, v52, v53
v_cvt_pk_bf16_f32 v27, v54, v55
v_mfma_f32_16x16x32_bf16 v[132:135], v[220:223], v[16:19], v[132:135]
ds_read_b64_tr_b16 v[216:217], v192 offset:0
ds_read_b64_tr_b16 v[218:219], v192 offset:2048
v_mfma_f32_16x16x32_bf16 v[144:147], v[224:227], v[16:19], v[144:147]
v_mul_f32 v56, v56, v251
v_mul_f32 v57, v57, v251
v_mul_f32 v58, v58, v251
v_mul_f32 v59, v59, v251
v_mul_f32 v60, v60, v251
v_mul_f32 v61, v61, v251
v_mfma_f32_16x16x32_bf16 v[152:155], v[224:227], v[20:23], v[152:155]
ds_read_b64_tr_b16 v[220:221], v193 offset:0
ds_read_b64_tr_b16 v[222:223], v193 offset:2048
v_mfma_f32_16x16x32_bf16 v[156:159], v[228:231], v[20:23], v[156:159]
v_mul_f32 v62, v62, v251
v_mul_f32 v63, v63, v251
v_cvt_pk_bf16_f32 v28, v56, v57
v_cvt_pk_bf16_f32 v29, v58, v59
v_cvt_pk_bf16_f32 v30, v60, v61
v_cvt_pk_bf16_f32 v31, v62, v63
s_waitcnt lgkmcnt(4)
v_mfma_f32_16x16x32_bf16 v[148:151], v[228:231], v[16:19], v[148:151]
ds_read_b64_tr_b16 v[224:225], v194 offset:0
ds_read_b64_tr_b16 v[226:227], v194 offset:2048
v_mfma_f32_16x16x32_bf16 v[128:131], v[232:235], v[24:27], v[128:131]
v_mul_f32 v64, v64, v250
v_mul_f32 v65, v65, v250
v_mul_f32 v66, v66, v250
v_mul_f32 v67, v67, v250
v_mul_f32 v68, v68, v250
v_mul_f32_e64 v69, v69, v250
v_mfma_f32_16x16x32_bf16 v[136:139], v[232:235], v[28:31], v[136:139]
ds_read_b64_tr_b16 v[228:229], v195 offset:0
ds_read_b64_tr_b16 v[230:231], v195 offset:2048
v_mfma_f32_16x16x32_bf16 v[140:143], v[236:239], v[28:31], v[140:143]
v_mul_f32 v70, v70, v250
v_mul_f32 v71, v71, v250
v_cvt_pk_bf16_f32 v32, v64, v65
v_cvt_pk_bf16_f32 v33, v66, v67
v_cvt_pk_bf16_f32 v34, v68, v69
v_cvt_pk_bf16_f32 v35, v70, v71
v_mfma_f32_16x16x32_bf16 v[132:135], v[236:239], v[24:27], v[132:135]
ds_read_b64_tr_b16 v[232:233], v192 offset:4096
ds_read_b64_tr_b16 v[234:235], v192 offset:6144
v_mfma_f32_16x16x32_bf16 v[144:147], v[240:243], v[24:27], v[144:147]
v_mul_f32 v72, v72, v251
v_mul_f32 v73, v73, v251
v_mul_f32 v74, v74, v251
v_mul_f32 v75, v75, v251
v_mul_f32 v76, v76, v251
v_mul_f32 v77, v77, v251
v_mfma_f32_16x16x32_bf16 v[152:155], v[240:243], v[28:31], v[152:155]
ds_read_b64_tr_b16 v[236:237], v193 offset:4096
ds_read_b64_tr_b16 v[238:239], v193 offset:6144
v_mfma_f32_16x16x32_bf16 v[156:159], v[244:247], v[28:31], v[156:159]
v_mul_f32 v78, v78, v251
v_mul_f32 v79, v79, v251
v_cvt_pk_bf16_f32 v36, v72, v73
v_cvt_pk_bf16_f32 v37, v74, v75
v_cvt_pk_bf16_f32 v38, v76, v77
v_cvt_pk_bf16_f32 v39, v78, v79
s_waitcnt lgkmcnt(4)
v_mfma_f32_16x16x32_bf16 v[148:151], v[244:247], v[24:27], v[148:151]
ds_read_b64_tr_b16 v[240:241], v194 offset:4096
ds_read_b64_tr_b16 v[242:243], v194 offset:6144
v_mfma_f32_16x16x32_bf16 v[128:131], v[216:219], v[32:35], v[128:131]
v_mul_f32 v80, v80, v250
v_mul_f32 v81, v81, v250
v_mul_f32 v82, v82, v250
v_mul_f32 v83, v83, v250
v_mul_f32 v84, v84, v250
v_mul_f32_e64 v85, v85, v250
v_mfma_f32_16x16x32_bf16 v[136:139], v[216:219], v[36:39], v[136:139]
ds_read_b64_tr_b16 v[244:245], v195 offset:4096
ds_read_b64_tr_b16 v[246:247], v195 offset:6144
v_mfma_f32_16x16x32_bf16 v[140:143], v[220:223], v[36:39], v[140:143]
v_mul_f32 v86, v86, v250
v_mul_f32 v87, v87, v250
v_cvt_pk_bf16_f32 v40, v80, v81
v_cvt_pk_bf16_f32 v41, v82, v83
v_cvt_pk_bf16_f32 v42, v84, v85
v_cvt_pk_bf16_f32 v43, v86, v87
v_mfma_f32_16x16x32_bf16 v[132:135], v[220:223], v[32:35], v[132:135]
ds_read_b64_tr_b16 v[216:217], v192 offset:8192
ds_read_b64_tr_b16 v[218:219], v192 offset:10240
v_mfma_f32_16x16x32_bf16 v[144:147], v[224:227], v[32:35], v[144:147]
v_mul_f32 v88, v88, v251
v_mul_f32 v89, v89, v251
v_mul_f32 v90, v90, v251
v_mul_f32 v91, v91, v251
v_mul_f32 v92, v92, v251
v_mul_f32 v93, v93, v251
v_mfma_f32_16x16x32_bf16 v[152:155], v[224:227], v[36:39], v[152:155]
ds_read_b64_tr_b16 v[220:221], v193 offset:8192
ds_read_b64_tr_b16 v[222:223], v193 offset:10240
v_mfma_f32_16x16x32_bf16 v[156:159], v[228:231], v[36:39], v[156:159]
v_mul_f32 v94, v94, v251
v_mul_f32 v95, v95, v251
v_cvt_pk_bf16_f32 v44, v88, v89
v_cvt_pk_bf16_f32 v45, v90, v91
v_cvt_pk_bf16_f32 v46, v92, v93
v_cvt_pk_bf16_f32 v47, v94, v95
s_waitcnt lgkmcnt(4)
v_mfma_f32_16x16x32_bf16 v[148:151], v[228:231], v[32:35], v[148:151]
ds_read_b64_tr_b16 v[224:225], v194 offset:8192
ds_read_b64_tr_b16 v[226:227], v194 offset:10240
v_mfma_f32_16x16x32_bf16 v[128:131], v[232:235], v[40:43], v[128:131]
v_mul_f32 v96, v96, v250
v_mul_f32 v97, v97, v250
v_mul_f32 v98, v98, v250
v_mul_f32 v99, v99, v250
v_mul_f32 v100, v100, v250
v_mul_f32_e64 v101, v101, v250
v_mfma_f32_16x16x32_bf16 v[136:139], v[232:235], v[44:47], v[136:139]
ds_read_b64_tr_b16 v[228:229], v195 offset:8192
ds_read_b64_tr_b16 v[230:231], v195 offset:10240
v_mfma_f32_16x16x32_bf16 v[140:143], v[236:239], v[44:47], v[140:143]
v_mul_f32 v102, v102, v250
v_mul_f32 v103, v103, v250
v_cvt_pk_bf16_f32 v48, v96, v97
v_cvt_pk_bf16_f32 v49, v98, v99
v_cvt_pk_bf16_f32 v50, v100, v101
v_cvt_pk_bf16_f32 v51, v102, v103
v_mfma_f32_16x16x32_bf16 v[132:135], v[236:239], v[40:43], v[132:135]
ds_read_b64_tr_b16 v[232:233], v192 offset:12288
ds_read_b64_tr_b16 v[234:235], v192 offset:14336
v_mfma_f32_16x16x32_bf16 v[144:147], v[240:243], v[40:43], v[144:147]
v_mul_f32 v104, v104, v251
v_mul_f32 v105, v105, v251
v_mul_f32 v106, v106, v251
v_mul_f32 v107, v107, v251
v_mul_f32 v108, v108, v251
v_mul_f32 v109, v109, v251
v_mfma_f32_16x16x32_bf16 v[152:155], v[240:243], v[44:47], v[152:155]
ds_read_b64_tr_b16 v[236:237], v193 offset:12288
ds_read_b64_tr_b16 v[238:239], v193 offset:14336
v_mfma_f32_16x16x32_bf16 v[156:159], v[244:247], v[44:47], v[156:159]
v_mul_f32 v110, v110, v251
v_mul_f32 v111, v111, v251
v_cvt_pk_bf16_f32 v52, v104, v105
v_cvt_pk_bf16_f32 v53, v106, v107
v_cvt_pk_bf16_f32 v54, v108, v109
v_cvt_pk_bf16_f32 v55, v110, v111
s_waitcnt lgkmcnt(4)
v_mfma_f32_16x16x32_bf16 v[148:151], v[244:247], v[40:43], v[148:151]
ds_read_b64_tr_b16 v[240:241], v194 offset:12288
ds_read_b64_tr_b16 v[242:243], v194 offset:14336
v_mfma_f32_16x16x32_bf16 v[128:131], v[216:219], v[48:51], v[128:131]
v_mul_f32 v112, v112, v250
v_mul_f32 v113, v113, v250
v_mul_f32 v114, v114, v250
v_mul_f32 v115, v115, v250
v_mul_f32 v116, v116, v250
v_mul_f32_e64 v117, v117, v250
v_mfma_f32_16x16x32_bf16 v[136:139], v[216:219], v[52:55], v[136:139]
ds_read_b64_tr_b16 v[244:245], v195 offset:12288
ds_read_b64_tr_b16 v[246:247], v195 offset:14336
v_mfma_f32_16x16x32_bf16 v[140:143], v[220:223], v[52:55], v[140:143]
v_mul_f32 v118, v118, v250
v_mul_f32 v119, v119, v250
v_cvt_pk_bf16_f32 v56, v112, v113
v_cvt_pk_bf16_f32 v57, v114, v115
v_cvt_pk_bf16_f32 v58, v116, v117
v_cvt_pk_bf16_f32 v59, v118, v119
v_mfma_f32_16x16x32_bf16 v[132:135], v[220:223], v[48:51], v[132:135]
s_barrier
ds_read_b64_tr_b16 v[216:217], v192 offset:16896
ds_read_b64_tr_b16 v[218:219], v192 offset:18944
v_mfma_f32_16x16x32_bf16 v[144:147], v[224:227], v[48:51], v[144:147]
v_mul_f32 v120, v120, v251
v_mul_f32 v121, v121, v251
v_mul_f32 v122, v122, v251
v_mul_f32 v123, v123, v251
v_mul_f32 v124, v124, v251
v_mul_f32_e64 v125, v125, v251
v_mfma_f32_16x16x32_bf16 v[152:155], v[224:227], v[52:55], v[152:155]
ds_read_b64_tr_b16 v[220:221], v193 offset:16896
ds_read_b64_tr_b16 v[222:223], v193 offset:18944
v_mfma_f32_16x16x32_bf16 v[156:159], v[228:231], v[52:55], v[156:159]
v_mul_f32 v126, v126, v251
v_mul_f32 v127, v127, v251
v_cvt_pk_bf16_f32 v60, v120, v121
v_cvt_pk_bf16_f32 v61, v122, v123
v_cvt_pk_bf16_f32 v62, v124, v125
v_cvt_pk_bf16_f32 v63, v126, v127
s_waitcnt lgkmcnt(4)
v_mfma_f32_16x16x32_bf16 v[148:151], v[228:231], v[48:51], v[148:151]
ds_read_b64_tr_b16 v[224:225], v194 offset:16896
ds_read_b64_tr_b16 v[226:227], v194 offset:18944
v_mfma_f32_16x16x32_bf16 v[128:131], v[232:235], v[56:59], v[128:131]
s_nop 0
v_mfma_f32_16x16x32_bf16 v[136:139], v[232:235], v[60:63], v[136:139]
ds_read_b64_tr_b16 v[228:229], v195 offset:16896
ds_read_b64_tr_b16 v[230:231], v195 offset:18944
v_mfma_f32_16x16x32_bf16 v[140:143], v[236:239], v[60:63], v[140:143]
v_mfma_f32_16x16x32_bf16 v[132:135], v[236:239], v[56:59], v[132:135]
ds_read_b64_tr_b16 v[232:233], v192 offset:20992
ds_read_b64_tr_b16 v[234:235], v192 offset:23040
v_mfma_f32_16x16x32_bf16 v[144:147], v[240:243], v[56:59], v[144:147]
v_mfma_f32_16x16x32_bf16 v[152:155], v[240:243], v[60:63], v[152:155]
ds_read_b64_tr_b16 v[236:237], v193 offset:20992
ds_read_b64_tr_b16 v[238:239], v193 offset:23040
v_mfma_f32_16x16x32_bf16 v[156:159], v[244:247], v[60:63], v[156:159]
s_waitcnt lgkmcnt(4)
s_nop 0
v_mfma_f32_16x16x32_bf16 v[148:151], v[244:247], v[56:59], v[148:151]
ds_read_b64_tr_b16 v[240:241], v194 offset:20992
ds_read_b64_tr_b16 v[242:243], v194 offset:23040
v_mfma_f32_16x16x32_bf16 v[64:67], v[216:219], v[0:3], 0
v_cvt_pk_bf16_f32 v160, v128, v129
v_cvt_pk_bf16_f32 v161, v130, v131
v_mfma_f32_16x16x32_bf16 v[72:75], v[216:219], v[4:7], 0
ds_read_b64_tr_b16 v[244:245], v195 offset:20992
ds_read_b64_tr_b16 v[246:247], v195 offset:23040
v_mfma_f32_16x16x32_bf16 v[76:79], v[220:223], v[4:7], 0
v_cvt_pk_bf16_f32 v162, v132, v133
v_cvt_pk_bf16_f32 v163, v134, v135
v_mfma_f32_16x16x32_bf16 v[68:71], v[220:223], v[0:3], 0
ds_read_b64_tr_b16 v[216:217], v192 offset:25088
ds_read_b64_tr_b16 v[218:219], v192 offset:27136
v_mfma_f32_16x16x32_bf16 v[80:83], v[224:227], v[0:3], 0
s_mov_b32 s80, 0
buffer_store_dwordx4 v[160:163], v248, s[40:43], s80 offen sc1
v_mfma_f32_16x16x32_bf16 v[88:91], v[224:227], v[4:7], 0
ds_read_b64_tr_b16 v[220:221], v193 offset:25088
ds_read_b64_tr_b16 v[222:223], v193 offset:27136
v_mfma_f32_16x16x32_bf16 v[92:95], v[228:231], v[4:7], 0
s_waitcnt lgkmcnt(4)
v_mfma_f32_16x16x32_bf16 v[84:87], v[228:231], v[0:3], 0
ds_read_b64_tr_b16 v[224:225], v194 offset:25088
ds_read_b64_tr_b16 v[226:227], v194 offset:27136
v_mfma_f32_16x16x32_bf16 v[64:67], v[232:235], v[8:11], v[64:67]
v_cvt_pk_bf16_f32 v164, v136, v137
v_cvt_pk_bf16_f32 v165, v138, v139
v_mfma_f32_16x16x32_bf16 v[72:75], v[232:235], v[12:15], v[72:75]
ds_read_b64_tr_b16 v[228:229], v195 offset:25088
ds_read_b64_tr_b16 v[230:231], v195 offset:27136
v_mfma_f32_16x16x32_bf16 v[76:79], v[236:239], v[12:15], v[76:79]
v_cvt_pk_bf16_f32 v166, v140, v141
v_cvt_pk_bf16_f32 v167, v142, v143
v_mfma_f32_16x16x32_bf16 v[68:71], v[236:239], v[8:11], v[68:71]
ds_read_b64_tr_b16 v[232:233], v192 offset:29184
ds_read_b64_tr_b16 v[234:235], v192 offset:31232
v_mfma_f32_16x16x32_bf16 v[80:83], v[240:243], v[8:11], v[80:83]
s_mov_b32 s80, 16384
buffer_store_dwordx4 v[164:167], v248, s[40:43], s80 offen sc1
v_mfma_f32_16x16x32_bf16 v[88:91], v[240:243], v[12:15], v[88:91]
ds_read_b64_tr_b16 v[236:237], v193 offset:29184
ds_read_b64_tr_b16 v[238:239], v193 offset:31232
v_mfma_f32_16x16x32_bf16 v[92:95], v[244:247], v[12:15], v[92:95]
s_waitcnt lgkmcnt(4)
s_nop 0
v_mfma_f32_16x16x32_bf16 v[84:87], v[244:247], v[8:11], v[84:87]
ds_read_b64_tr_b16 v[240:241], v194 offset:29184
ds_read_b64_tr_b16 v[242:243], v194 offset:31232
v_mfma_f32_16x16x32_bf16 v[64:67], v[216:219], v[16:19], v[64:67]
v_cvt_pk_bf16_f32 v168, v144, v145
v_cvt_pk_bf16_f32 v169, v146, v147
v_mfma_f32_16x16x32_bf16 v[72:75], v[216:219], v[20:23], v[72:75]
ds_read_b64_tr_b16 v[244:245], v195 offset:29184
ds_read_b64_tr_b16 v[246:247], v195 offset:31232
v_mfma_f32_16x16x32_bf16 v[76:79], v[220:223], v[20:23], v[76:79]
v_cvt_pk_bf16_f32 v170, v148, v149
v_cvt_pk_bf16_f32 v171, v150, v151
v_mfma_f32_16x16x32_bf16 v[68:71], v[220:223], v[16:19], v[68:71]
s_barrier
ds_read_b64_tr_b16 v[216:217], v200 offset:16896
ds_read_b64_tr_b16 v[218:219], v200 offset:18944
v_mfma_f32_16x16x32_bf16 v[80:83], v[224:227], v[16:19], v[80:83]
s_mov_b32 s80, 32768
buffer_store_dwordx4 v[168:171], v248, s[40:43], s80 offen sc1
v_mfma_f32_16x16x32_bf16 v[88:91], v[224:227], v[20:23], v[88:91]
ds_read_b64_tr_b16 v[220:221], v201 offset:16896
ds_read_b64_tr_b16 v[222:223], v201 offset:18944
v_mfma_f32_16x16x32_bf16 v[92:95], v[228:231], v[20:23], v[92:95]
s_waitcnt lgkmcnt(4)
v_mfma_f32_16x16x32_bf16 v[84:87], v[228:231], v[16:19], v[84:87]
ds_read_b64_tr_b16 v[224:225], v202 offset:16896
ds_read_b64_tr_b16 v[226:227], v202 offset:18944
v_mfma_f32_16x16x32_bf16 v[64:67], v[232:235], v[24:27], v[64:67]
v_cvt_pk_bf16_f32 v172, v152, v153
v_cvt_pk_bf16_f32 v173, v154, v155
v_mfma_f32_16x16x32_bf16 v[72:75], v[232:235], v[28:31], v[72:75]
ds_read_b64_tr_b16 v[228:229], v203 offset:16896
ds_read_b64_tr_b16 v[230:231], v203 offset:18944
v_mfma_f32_16x16x32_bf16 v[76:79], v[236:239], v[28:31], v[76:79]
v_cvt_pk_bf16_f32 v174, v156, v157
v_cvt_pk_bf16_f32 v175, v158, v159
v_mfma_f32_16x16x32_bf16 v[68:71], v[236:239], v[24:27], v[68:71]
ds_read_b64_tr_b16 v[232:233], v200 offset:20992
ds_read_b64_tr_b16 v[234:235], v200 offset:23040
v_mfma_f32_16x16x32_bf16 v[80:83], v[240:243], v[24:27], v[80:83]
s_mov_b32 s80, 49152
buffer_store_dwordx4 v[172:175], v248, s[40:43], s80 offen sc1
v_mfma_f32_16x16x32_bf16 v[88:91], v[240:243], v[28:31], v[88:91]
ds_read_b64_tr_b16 v[236:237], v201 offset:20992
ds_read_b64_tr_b16 v[238:239], v201 offset:23040
v_mfma_f32_16x16x32_bf16 v[92:95], v[244:247], v[28:31], v[92:95]
s_waitcnt lgkmcnt(4)
s_nop 0
v_mfma_f32_16x16x32_bf16 v[84:87], v[244:247], v[24:27], v[84:87]
ds_read_b64_tr_b16 v[240:241], v202 offset:20992
ds_read_b64_tr_b16 v[242:243], v202 offset:23040
v_mfma_f32_16x16x32_bf16 v[64:67], v[216:219], v[32:35], v[64:67]
v_mfma_f32_16x16x32_bf16 v[72:75], v[216:219], v[36:39], v[72:75]
ds_read_b64_tr_b16 v[244:245], v203 offset:20992
ds_read_b64_tr_b16 v[246:247], v203 offset:23040
v_mfma_f32_16x16x32_bf16 v[76:79], v[220:223], v[36:39], v[76:79]
v_mfma_f32_16x16x32_bf16 v[68:71], v[220:223], v[32:35], v[68:71]
ds_read_b64_tr_b16 v[216:217], v200 offset:25088
ds_read_b64_tr_b16 v[218:219], v200 offset:27136
v_mfma_f32_16x16x32_bf16 v[80:83], v[224:227], v[32:35], v[80:83]
v_mfma_f32_16x16x32_bf16 v[88:91], v[224:227], v[36:39], v[88:91]
ds_read_b64_tr_b16 v[220:221], v201 offset:25088
ds_read_b64_tr_b16 v[222:223], v201 offset:27136
v_mfma_f32_16x16x32_bf16 v[92:95], v[228:231], v[36:39], v[92:95]
s_waitcnt lgkmcnt(4)
s_nop 0
v_mfma_f32_16x16x32_bf16 v[84:87], v[228:231], v[32:35], v[84:87]
ds_read_b64_tr_b16 v[224:225], v202 offset:25088
ds_read_b64_tr_b16 v[226:227], v202 offset:27136
v_mfma_f32_16x16x32_bf16 v[64:67], v[232:235], v[40:43], v[64:67]
v_mfma_f32_16x16x32_bf16 v[72:75], v[232:235], v[44:47], v[72:75]
ds_read_b64_tr_b16 v[228:229], v203 offset:25088
ds_read_b64_tr_b16 v[230:231], v203 offset:27136
v_mfma_f32_16x16x32_bf16 v[76:79], v[236:239], v[44:47], v[76:79]
v_mfma_f32_16x16x32_bf16 v[68:71], v[236:239], v[40:43], v[68:71]
ds_read_b64_tr_b16 v[232:233], v200 offset:29184
ds_read_b64_tr_b16 v[234:235], v200 offset:31232
v_mfma_f32_16x16x32_bf16 v[80:83], v[240:243], v[40:43], v[80:83]
v_mfma_f32_16x16x32_bf16 v[88:91], v[240:243], v[44:47], v[88:91]
ds_read_b64_tr_b16 v[236:237], v201 offset:29184
ds_read_b64_tr_b16 v[238:239], v201 offset:31232
v_mfma_f32_16x16x32_bf16 v[92:95], v[244:247], v[44:47], v[92:95]
s_waitcnt lgkmcnt(4)
s_nop 0
v_mfma_f32_16x16x32_bf16 v[84:87], v[244:247], v[40:43], v[84:87]
ds_read_b64_tr_b16 v[240:241], v202 offset:29184
ds_read_b64_tr_b16 v[242:243], v202 offset:31232
v_mfma_f32_16x16x32_bf16 v[64:67], v[216:219], v[48:51], v[64:67]
v_mfma_f32_16x16x32_bf16 v[72:75], v[216:219], v[52:55], v[72:75]
ds_read_b64_tr_b16 v[244:245], v203 offset:29184
ds_read_b64_tr_b16 v[246:247], v203 offset:31232
v_mfma_f32_16x16x32_bf16 v[76:79], v[220:223], v[52:55], v[76:79]
v_mfma_f32_16x16x32_bf16 v[68:71], v[220:223], v[48:51], v[68:71]
s_barrier
ds_read_b64_tr_b16 v[216:217], v192 offset:33792
ds_read_b64_tr_b16 v[218:219], v192 offset:35840
v_mfma_f32_16x16x32_bf16 v[80:83], v[224:227], v[48:51], v[80:83]
s_nop 0
v_mfma_f32_16x16x32_bf16 v[88:91], v[224:227], v[52:55], v[88:91]
ds_read_b64_tr_b16 v[220:221], v193 offset:33792
ds_read_b64_tr_b16 v[222:223], v193 offset:35840
v_mfma_f32_16x16x32_bf16 v[92:95], v[228:231], v[52:55], v[92:95]
s_waitcnt lgkmcnt(4)
s_nop 0
v_mfma_f32_16x16x32_bf16 v[84:87], v[228:231], v[48:51], v[84:87]
ds_read_b64_tr_b16 v[224:225], v194 offset:33792
ds_read_b64_tr_b16 v[226:227], v194 offset:35840
v_mfma_f32_16x16x32_bf16 v[64:67], v[232:235], v[56:59], v[64:67]
v_mfma_f32_16x16x32_bf16 v[72:75], v[232:235], v[60:63], v[72:75]
ds_read_b64_tr_b16 v[228:229], v195 offset:33792
ds_read_b64_tr_b16 v[230:231], v195 offset:35840
v_mfma_f32_16x16x32_bf16 v[76:79], v[236:239], v[60:63], v[76:79]
v_mfma_f32_16x16x32_bf16 v[68:71], v[236:239], v[56:59], v[68:71]
ds_read_b64_tr_b16 v[232:233], v192 offset:37888
ds_read_b64_tr_b16 v[234:235], v192 offset:39936
v_mfma_f32_16x16x32_bf16 v[80:83], v[240:243], v[56:59], v[80:83]
v_mfma_f32_16x16x32_bf16 v[88:91], v[240:243], v[60:63], v[88:91]
ds_read_b64_tr_b16 v[236:237], v193 offset:37888
ds_read_b64_tr_b16 v[238:239], v193 offset:39936
v_mfma_f32_16x16x32_bf16 v[92:95], v[244:247], v[60:63], v[92:95]
s_waitcnt lgkmcnt(4)
s_nop 0
v_mfma_f32_16x16x32_bf16 v[84:87], v[244:247], v[56:59], v[84:87]
ds_read_b64_tr_b16 v[240:241], v194 offset:37888
ds_read_b64_tr_b16 v[242:243], v194 offset:39936
v_mfma_f32_16x16x32_bf16 v[128:131], v[216:219], v[0:3], 0
v_cvt_pk_bf16_f32 v176, v64, v65
v_cvt_pk_bf16_f32 v177, v66, v67
v_mfma_f32_16x16x32_bf16 v[136:139], v[216:219], v[4:7], 0
ds_read_b64_tr_b16 v[244:245], v195 offset:37888
ds_read_b64_tr_b16 v[246:247], v195 offset:39936
v_mfma_f32_16x16x32_bf16 v[140:143], v[220:223], v[4:7], 0
v_cvt_pk_bf16_f32 v178, v68, v69
v_cvt_pk_bf16_f32 v179, v70, v71
v_mfma_f32_16x16x32_bf16 v[132:135], v[220:223], v[0:3], 0
ds_read_b64_tr_b16 v[216:217], v192 offset:41984
ds_read_b64_tr_b16 v[218:219], v192 offset:44032
v_mfma_f32_16x16x32_bf16 v[144:147], v[224:227], v[0:3], 0
s_mov_b32 s80, 262144
buffer_store_dwordx4 v[176:179], v248, s[40:43], s80 offen sc1
v_mfma_f32_16x16x32_bf16 v[152:155], v[224:227], v[4:7], 0
ds_read_b64_tr_b16 v[220:221], v193 offset:41984
ds_read_b64_tr_b16 v[222:223], v193 offset:44032
v_mfma_f32_16x16x32_bf16 v[156:159], v[228:231], v[4:7], 0
s_waitcnt lgkmcnt(4)
s_nop 0
v_mfma_f32_16x16x32_bf16 v[148:151], v[228:231], v[0:3], 0
ds_read_b64_tr_b16 v[224:225], v194 offset:41984
ds_read_b64_tr_b16 v[226:227], v194 offset:44032
v_mfma_f32_16x16x32_bf16 v[128:131], v[232:235], v[8:11], v[128:131]
v_cvt_pk_bf16_f32 v180, v72, v73
v_cvt_pk_bf16_f32 v181, v74, v75
v_mfma_f32_16x16x32_bf16 v[136:139], v[232:235], v[12:15], v[136:139]
ds_read_b64_tr_b16 v[228:229], v195 offset:41984
ds_read_b64_tr_b16 v[230:231], v195 offset:44032
v_mfma_f32_16x16x32_bf16 v[140:143], v[236:239], v[12:15], v[140:143]
v_cvt_pk_bf16_f32 v182, v76, v77
v_cvt_pk_bf16_f32 v183, v78, v79
v_mfma_f32_16x16x32_bf16 v[132:135], v[236:239], v[8:11], v[132:135]
ds_read_b64_tr_b16 v[232:233], v192 offset:46080
ds_read_b64_tr_b16 v[234:235], v192 offset:48128
v_mfma_f32_16x16x32_bf16 v[144:147], v[240:243], v[8:11], v[144:147]
s_mov_b32 s80, 278528
buffer_store_dwordx4 v[180:183], v248, s[40:43], s80 offen sc1
v_mfma_f32_16x16x32_bf16 v[152:155], v[240:243], v[12:15], v[152:155]
ds_read_b64_tr_b16 v[236:237], v193 offset:46080
ds_read_b64_tr_b16 v[238:239], v193 offset:48128
v_mfma_f32_16x16x32_bf16 v[156:159], v[244:247], v[12:15], v[156:159]
s_waitcnt lgkmcnt(4)
s_nop 0
v_mfma_f32_16x16x32_bf16 v[148:151], v[244:247], v[8:11], v[148:151]
ds_read_b64_tr_b16 v[240:241], v194 offset:46080
ds_read_b64_tr_b16 v[242:243], v194 offset:48128
v_mfma_f32_16x16x32_bf16 v[128:131], v[216:219], v[16:19], v[128:131]
v_cvt_pk_bf16_f32 v184, v80, v81
v_cvt_pk_bf16_f32 v185, v82, v83
v_mfma_f32_16x16x32_bf16 v[136:139], v[216:219], v[20:23], v[136:139]
ds_read_b64_tr_b16 v[244:245], v195 offset:46080
ds_read_b64_tr_b16 v[246:247], v195 offset:48128
v_mfma_f32_16x16x32_bf16 v[140:143], v[220:223], v[20:23], v[140:143]
v_cvt_pk_bf16_f32 v186, v84, v85
v_cvt_pk_bf16_f32 v187, v86, v87
v_mfma_f32_16x16x32_bf16 v[132:135], v[220:223], v[16:19], v[132:135]
s_barrier
ds_read_b64_tr_b16 v[216:217], v200 offset:33792
ds_read_b64_tr_b16 v[218:219], v200 offset:35840
v_mfma_f32_16x16x32_bf16 v[144:147], v[224:227], v[16:19], v[144:147]
s_mov_b32 s80, 294912
buffer_store_dwordx4 v[184:187], v248, s[40:43], s80 offen sc1
v_mfma_f32_16x16x32_bf16 v[152:155], v[224:227], v[20:23], v[152:155]
ds_read_b64_tr_b16 v[220:221], v201 offset:33792
ds_read_b64_tr_b16 v[222:223], v201 offset:35840
v_mfma_f32_16x16x32_bf16 v[156:159], v[228:231], v[20:23], v[156:159]
s_waitcnt lgkmcnt(4)
v_mfma_f32_16x16x32_bf16 v[148:151], v[228:231], v[16:19], v[148:151]
ds_read_b64_tr_b16 v[224:225], v202 offset:33792
ds_read_b64_tr_b16 v[226:227], v202 offset:35840
v_mfma_f32_16x16x32_bf16 v[128:131], v[232:235], v[24:27], v[128:131]
v_cvt_pk_bf16_f32 v188, v88, v89
v_cvt_pk_bf16_f32 v189, v90, v91
v_mfma_f32_16x16x32_bf16 v[136:139], v[232:235], v[28:31], v[136:139]
ds_read_b64_tr_b16 v[228:229], v203 offset:33792
ds_read_b64_tr_b16 v[230:231], v203 offset:35840
v_mfma_f32_16x16x32_bf16 v[140:143], v[236:239], v[28:31], v[140:143]
v_cvt_pk_bf16_f32 v190, v92, v93
v_cvt_pk_bf16_f32 v191, v94, v95
s_waitcnt vmcnt(3)
s_mov_b64 exec, 1
global_store_dword v249, v254, s[100:101] offset:0 sc1
s_mov_b64 exec, -1
v_mfma_f32_16x16x32_bf16 v[132:135], v[236:239], v[24:27], v[132:135]
ds_read_b64_tr_b16 v[232:233], v200 offset:37888
ds_read_b64_tr_b16 v[234:235], v200 offset:39936
v_mfma_f32_16x16x32_bf16 v[144:147], v[240:243], v[24:27], v[144:147]
s_mov_b32 s80, 311296
buffer_store_dwordx4 v[188:191], v248, s[40:43], s80 offen sc1
v_mfma_f32_16x16x32_bf16 v[152:155], v[240:243], v[28:31], v[152:155]
ds_read_b64_tr_b16 v[236:237], v201 offset:37888
ds_read_b64_tr_b16 v[238:239], v201 offset:39936
v_mfma_f32_16x16x32_bf16 v[156:159], v[244:247], v[28:31], v[156:159]
s_waitcnt lgkmcnt(4)
v_mfma_f32_16x16x32_bf16 v[148:151], v[244:247], v[24:27], v[148:151]
ds_read_b64_tr_b16 v[240:241], v202 offset:37888
ds_read_b64_tr_b16 v[242:243], v202 offset:39936
v_mfma_f32_16x16x32_bf16 v[128:131], v[216:219], v[32:35], v[128:131]
v_mfma_f32_16x16x32_bf16 v[136:139], v[216:219], v[36:39], v[136:139]
ds_read_b64_tr_b16 v[244:245], v203 offset:37888
ds_read_b64_tr_b16 v[246:247], v203 offset:39936
v_mfma_f32_16x16x32_bf16 v[140:143], v[220:223], v[36:39], v[140:143]
v_mfma_f32_16x16x32_bf16 v[132:135], v[220:223], v[32:35], v[132:135]
ds_read_b64_tr_b16 v[216:217], v200 offset:41984
ds_read_b64_tr_b16 v[218:219], v200 offset:44032
v_mfma_f32_16x16x32_bf16 v[144:147], v[224:227], v[32:35], v[144:147]
v_mfma_f32_16x16x32_bf16 v[152:155], v[224:227], v[36:39], v[152:155]
ds_read_b64_tr_b16 v[220:221], v201 offset:41984
ds_read_b64_tr_b16 v[222:223], v201 offset:44032
v_mfma_f32_16x16x32_bf16 v[156:159], v[228:231], v[36:39], v[156:159]
s_waitcnt lgkmcnt(4)
s_nop 0
v_mfma_f32_16x16x32_bf16 v[148:151], v[228:231], v[32:35], v[148:151]
ds_read_b64_tr_b16 v[224:225], v202 offset:41984
ds_read_b64_tr_b16 v[226:227], v202 offset:44032
v_mfma_f32_16x16x32_bf16 v[128:131], v[232:235], v[40:43], v[128:131]
v_mfma_f32_16x16x32_bf16 v[136:139], v[232:235], v[44:47], v[136:139]
ds_read_b64_tr_b16 v[228:229], v203 offset:41984
ds_read_b64_tr_b16 v[230:231], v203 offset:44032
v_mfma_f32_16x16x32_bf16 v[140:143], v[236:239], v[44:47], v[140:143]
v_mfma_f32_16x16x32_bf16 v[132:135], v[236:239], v[40:43], v[132:135]
ds_read_b64_tr_b16 v[232:233], v200 offset:46080
ds_read_b64_tr_b16 v[234:235], v200 offset:48128
v_mfma_f32_16x16x32_bf16 v[144:147], v[240:243], v[40:43], v[144:147]
v_mfma_f32_16x16x32_bf16 v[152:155], v[240:243], v[44:47], v[152:155]
ds_read_b64_tr_b16 v[236:237], v201 offset:46080
ds_read_b64_tr_b16 v[238:239], v201 offset:48128
v_mfma_f32_16x16x32_bf16 v[156:159], v[244:247], v[44:47], v[156:159]
s_waitcnt lgkmcnt(4)
s_nop 0
v_mfma_f32_16x16x32_bf16 v[148:151], v[244:247], v[40:43], v[148:151]
ds_read_b64_tr_b16 v[240:241], v202 offset:46080
ds_read_b64_tr_b16 v[242:243], v202 offset:48128
v_mfma_f32_16x16x32_bf16 v[128:131], v[216:219], v[48:51], v[128:131]
v_mfma_f32_16x16x32_bf16 v[136:139], v[216:219], v[52:55], v[136:139]
ds_read_b64_tr_b16 v[244:245], v203 offset:46080
ds_read_b64_tr_b16 v[246:247], v203 offset:48128
v_mfma_f32_16x16x32_bf16 v[140:143], v[220:223], v[52:55], v[140:143]
v_mfma_f32_16x16x32_bf16 v[132:135], v[220:223], v[48:51], v[132:135]
s_barrier
ds_read_b64_tr_b16 v[216:217], v200 offset:0
ds_read_b64_tr_b16 v[218:219], v200 offset:2048
v_mfma_f32_16x16x32_bf16 v[144:147], v[224:227], v[48:51], v[144:147]
s_nop 0
v_mfma_f32_16x16x32_bf16 v[152:155], v[224:227], v[52:55], v[152:155]
ds_read_b64_tr_b16 v[220:221], v201 offset:0
ds_read_b64_tr_b16 v[222:223], v201 offset:2048
v_mfma_f32_16x16x32_bf16 v[156:159], v[228:231], v[52:55], v[156:159]
s_waitcnt lgkmcnt(4)
s_nop 0
v_mfma_f32_16x16x32_bf16 v[148:151], v[228:231], v[48:51], v[148:151]
ds_read_b64_tr_b16 v[224:225], v202 offset:0
ds_read_b64_tr_b16 v[226:227], v202 offset:2048
v_mfma_f32_16x16x32_bf16 v[128:131], v[232:235], v[56:59], v[128:131]
v_mfma_f32_16x16x32_bf16 v[136:139], v[232:235], v[60:63], v[136:139]
ds_read_b64_tr_b16 v[228:229], v203 offset:0
ds_read_b64_tr_b16 v[230:231], v203 offset:2048
v_mfma_f32_16x16x32_bf16 v[140:143], v[236:239], v[60:63], v[140:143]
v_mfma_f32_16x16x32_bf16 v[132:135], v[236:239], v[56:59], v[132:135]
ds_read_b64_tr_b16 v[232:233], v200 offset:4096
ds_read_b64_tr_b16 v[234:235], v200 offset:6144
v_mfma_f32_16x16x32_bf16 v[144:147], v[240:243], v[56:59], v[144:147]
v_mfma_f32_16x16x32_bf16 v[152:155], v[240:243], v[60:63], v[152:155]
ds_read_b64_tr_b16 v[236:237], v201 offset:4096
ds_read_b64_tr_b16 v[238:239], v201 offset:6144
v_mfma_f32_16x16x32_bf16 v[156:159], v[244:247], v[60:63], v[156:159]
s_waitcnt lgkmcnt(4)
s_nop 0
v_mfma_f32_16x16x32_bf16 v[148:151], v[244:247], v[56:59], v[148:151]
ds_read_b64_tr_b16 v[240:241], v202 offset:4096
ds_read_b64_tr_b16 v[242:243], v202 offset:6144
v_mfma_f32_16x16x32_bf16 v[64:67], v[216:219], v[0:3], 0
v_cvt_pk_bf16_f32 v160, v128, v129
v_cvt_pk_bf16_f32 v161, v130, v131
v_mfma_f32_16x16x32_bf16 v[72:75], v[216:219], v[4:7], 0
ds_read_b64_tr_b16 v[244:245], v203 offset:4096
ds_read_b64_tr_b16 v[246:247], v203 offset:6144
v_mfma_f32_16x16x32_bf16 v[76:79], v[220:223], v[4:7], 0
v_cvt_pk_bf16_f32 v162, v132, v133
v_cvt_pk_bf16_f32 v163, v134, v135
v_mfma_f32_16x16x32_bf16 v[68:71], v[220:223], v[0:3], 0
ds_read_b64_tr_b16 v[216:217], v200 offset:8192
ds_read_b64_tr_b16 v[218:219], v200 offset:10240
v_mfma_f32_16x16x32_bf16 v[80:83], v[224:227], v[0:3], 0
s_mov_b32 s80, 524288
buffer_store_dwordx4 v[160:163], v248, s[40:43], s80 offen sc1
v_mfma_f32_16x16x32_bf16 v[88:91], v[224:227], v[4:7], 0
ds_read_b64_tr_b16 v[220:221], v201 offset:8192
ds_read_b64_tr_b16 v[222:223], v201 offset:10240
v_mfma_f32_16x16x32_bf16 v[92:95], v[228:231], v[4:7], 0
s_waitcnt lgkmcnt(4)
s_nop 0
v_mfma_f32_16x16x32_bf16 v[84:87], v[228:231], v[0:3], 0
ds_read_b64_tr_b16 v[224:225], v202 offset:8192
ds_read_b64_tr_b16 v[226:227], v202 offset:10240
v_mfma_f32_16x16x32_bf16 v[64:67], v[232:235], v[8:11], v[64:67]
v_cvt_pk_bf16_f32 v164, v136, v137
v_cvt_pk_bf16_f32 v165, v138, v139
v_mfma_f32_16x16x32_bf16 v[72:75], v[232:235], v[12:15], v[72:75]
ds_read_b64_tr_b16 v[228:229], v203 offset:8192
ds_read_b64_tr_b16 v[230:231], v203 offset:10240
v_mfma_f32_16x16x32_bf16 v[76:79], v[236:239], v[12:15], v[76:79]
v_cvt_pk_bf16_f32 v166, v140, v141
v_cvt_pk_bf16_f32 v167, v142, v143
v_mfma_f32_16x16x32_bf16 v[68:71], v[236:239], v[8:11], v[68:71]
ds_read_b64_tr_b16 v[232:233], v200 offset:12288
ds_read_b64_tr_b16 v[234:235], v200 offset:14336
v_mfma_f32_16x16x32_bf16 v[80:83], v[240:243], v[8:11], v[80:83]
s_mov_b32 s80, 540672
buffer_store_dwordx4 v[164:167], v248, s[40:43], s80 offen sc1
v_mfma_f32_16x16x32_bf16 v[88:91], v[240:243], v[12:15], v[88:91]
ds_read_b64_tr_b16 v[236:237], v201 offset:12288
ds_read_b64_tr_b16 v[238:239], v201 offset:14336
v_mfma_f32_16x16x32_bf16 v[92:95], v[244:247], v[12:15], v[92:95]
s_waitcnt lgkmcnt(4)
s_nop 0
v_mfma_f32_16x16x32_bf16 v[84:87], v[244:247], v[8:11], v[84:87]
ds_read_b64_tr_b16 v[240:241], v202 offset:12288
ds_read_b64_tr_b16 v[242:243], v202 offset:14336
v_mfma_f32_16x16x32_bf16 v[64:67], v[216:219], v[16:19], v[64:67]
v_cvt_pk_bf16_f32 v168, v144, v145
v_cvt_pk_bf16_f32 v169, v146, v147
v_mfma_f32_16x16x32_bf16 v[72:75], v[216:219], v[20:23], v[72:75]
ds_read_b64_tr_b16 v[244:245], v203 offset:12288
ds_read_b64_tr_b16 v[246:247], v203 offset:14336
v_mfma_f32_16x16x32_bf16 v[76:79], v[220:223], v[20:23], v[76:79]
v_cvt_pk_bf16_f32 v170, v148, v149
v_cvt_pk_bf16_f32 v171, v150, v151
v_mfma_f32_16x16x32_bf16 v[68:71], v[220:223], v[16:19], v[68:71]
ds_read_b64_tr_b16 v[216:217], v196 offset:0
ds_read_b64_tr_b16 v[218:219], v196 offset:2048
v_mfma_f32_16x16x32_bf16 v[80:83], v[224:227], v[16:19], v[80:83]
s_mov_b32 s80, 557056
buffer_store_dwordx4 v[168:171], v248, s[40:43], s80 offen sc1
v_mfma_f32_16x16x32_bf16 v[88:91], v[224:227], v[20:23], v[88:91]
ds_read_b64_tr_b16 v[220:221], v197 offset:0
ds_read_b64_tr_b16 v[222:223], v197 offset:2048
v_mfma_f32_16x16x32_bf16 v[92:95], v[228:231], v[20:23], v[92:95]
s_waitcnt lgkmcnt(4)
s_nop 0
v_mfma_f32_16x16x32_bf16 v[84:87], v[228:231], v[16:19], v[84:87]
ds_read_b64_tr_b16 v[224:225], v198 offset:0
ds_read_b64_tr_b16 v[226:227], v198 offset:2048
v_mfma_f32_16x16x32_bf16 v[64:67], v[232:235], v[24:27], v[64:67]
v_cvt_pk_bf16_f32 v172, v152, v153
v_cvt_pk_bf16_f32 v173, v154, v155
v_mfma_f32_16x16x32_bf16 v[72:75], v[232:235], v[28:31], v[72:75]
ds_read_b64_tr_b16 v[228:229], v199 offset:0
ds_read_b64_tr_b16 v[230:231], v199 offset:2048
v_mfma_f32_16x16x32_bf16 v[76:79], v[236:239], v[28:31], v[76:79]
v_cvt_pk_bf16_f32 v174, v156, v157
v_cvt_pk_bf16_f32 v175, v158, v159
s_waitcnt vmcnt(3)
s_mov_b64 exec, 1
global_store_dword v249, v254, s[100:101] offset:128 sc1
s_mov_b64 exec, -1
v_mfma_f32_16x16x32_bf16 v[68:71], v[236:239], v[24:27], v[68:71]
ds_read_b64_tr_b16 v[232:233], v196 offset:4096
ds_read_b64_tr_b16 v[234:235], v196 offset:6144
v_mfma_f32_16x16x32_bf16 v[80:83], v[240:243], v[24:27], v[80:83]
s_mov_b32 s80, 573440
buffer_store_dwordx4 v[172:175], v248, s[40:43], s80 offen sc1
v_mfma_f32_16x16x32_bf16 v[88:91], v[240:243], v[28:31], v[88:91]
ds_read_b64_tr_b16 v[236:237], v197 offset:4096
ds_read_b64_tr_b16 v[238:239], v197 offset:6144
v_mfma_f32_16x16x32_bf16 v[92:95], v[244:247], v[28:31], v[92:95]
s_waitcnt lgkmcnt(4)
v_mfma_f32_16x16x32_bf16 v[84:87], v[244:247], v[24:27], v[84:87]
ds_read_b64_tr_b16 v[240:241], v198 offset:4096
ds_read_b64_tr_b16 v[242:243], v198 offset:6144
v_mfma_f32_16x16x32_bf16 v[64:67], v[216:219], v[32:35], v[64:67]
v_mfma_f32_16x16x32_bf16 v[72:75], v[216:219], v[36:39], v[72:75]
ds_read_b64_tr_b16 v[244:245], v199 offset:4096
ds_read_b64_tr_b16 v[246:247], v199 offset:6144
v_mfma_f32_16x16x32_bf16 v[76:79], v[220:223], v[36:39], v[76:79]
v_mfma_f32_16x16x32_bf16 v[68:71], v[220:223], v[32:35], v[68:71]
ds_read_b64_tr_b16 v[216:217], v196 offset:8192
ds_read_b64_tr_b16 v[218:219], v196 offset:10240
v_mfma_f32_16x16x32_bf16 v[80:83], v[224:227], v[32:35], v[80:83]
v_mfma_f32_16x16x32_bf16 v[88:91], v[224:227], v[36:39], v[88:91]
ds_read_b64_tr_b16 v[220:221], v197 offset:8192
ds_read_b64_tr_b16 v[222:223], v197 offset:10240
v_mfma_f32_16x16x32_bf16 v[92:95], v[228:231], v[36:39], v[92:95]
s_waitcnt lgkmcnt(4)
s_nop 0
v_mfma_f32_16x16x32_bf16 v[84:87], v[228:231], v[32:35], v[84:87]
ds_read_b64_tr_b16 v[224:225], v198 offset:8192
ds_read_b64_tr_b16 v[226:227], v198 offset:10240
v_mfma_f32_16x16x32_bf16 v[64:67], v[232:235], v[40:43], v[64:67]
v_mfma_f32_16x16x32_bf16 v[72:75], v[232:235], v[44:47], v[72:75]
ds_read_b64_tr_b16 v[228:229], v199 offset:8192
ds_read_b64_tr_b16 v[230:231], v199 offset:10240
v_mfma_f32_16x16x32_bf16 v[76:79], v[236:239], v[44:47], v[76:79]
v_mfma_f32_16x16x32_bf16 v[68:71], v[236:239], v[40:43], v[68:71]
ds_read_b64_tr_b16 v[232:233], v196 offset:12288
ds_read_b64_tr_b16 v[234:235], v196 offset:14336
v_mfma_f32_16x16x32_bf16 v[80:83], v[240:243], v[40:43], v[80:83]
v_mfma_f32_16x16x32_bf16 v[88:91], v[240:243], v[44:47], v[88:91]
ds_read_b64_tr_b16 v[236:237], v197 offset:12288
ds_read_b64_tr_b16 v[238:239], v197 offset:14336
v_mfma_f32_16x16x32_bf16 v[92:95], v[244:247], v[44:47], v[92:95]
s_waitcnt lgkmcnt(4)
s_nop 0
v_mfma_f32_16x16x32_bf16 v[84:87], v[244:247], v[40:43], v[84:87]
ds_read_b64_tr_b16 v[240:241], v198 offset:12288
ds_read_b64_tr_b16 v[242:243], v198 offset:14336
v_mfma_f32_16x16x32_bf16 v[64:67], v[216:219], v[48:51], v[64:67]
v_mfma_f32_16x16x32_bf16 v[72:75], v[216:219], v[52:55], v[72:75]
ds_read_b64_tr_b16 v[244:245], v199 offset:12288
ds_read_b64_tr_b16 v[246:247], v199 offset:14336
v_mfma_f32_16x16x32_bf16 v[76:79], v[220:223], v[52:55], v[76:79]
v_mfma_f32_16x16x32_bf16 v[68:71], v[220:223], v[48:51], v[68:71]
ds_read_b64_tr_b16 v[216:217], v196 offset:16896
ds_read_b64_tr_b16 v[218:219], v196 offset:18944
v_mfma_f32_16x16x32_bf16 v[80:83], v[224:227], v[48:51], v[80:83]
v_mfma_f32_16x16x32_bf16 v[88:91], v[224:227], v[52:55], v[88:91]
ds_read_b64_tr_b16 v[220:221], v197 offset:16896
ds_read_b64_tr_b16 v[222:223], v197 offset:18944
v_mfma_f32_16x16x32_bf16 v[92:95], v[228:231], v[52:55], v[92:95]
s_waitcnt lgkmcnt(4)
s_nop 0
v_mfma_f32_16x16x32_bf16 v[84:87], v[228:231], v[48:51], v[84:87]
ds_read_b64_tr_b16 v[224:225], v198 offset:16896
ds_read_b64_tr_b16 v[226:227], v198 offset:18944
v_mfma_f32_16x16x32_bf16 v[64:67], v[232:235], v[56:59], v[64:67]
v_mfma_f32_16x16x32_bf16 v[72:75], v[232:235], v[60:63], v[72:75]
ds_read_b64_tr_b16 v[228:229], v199 offset:16896
ds_read_b64_tr_b16 v[230:231], v199 offset:18944
v_mfma_f32_16x16x32_bf16 v[76:79], v[236:239], v[60:63], v[76:79]
v_mfma_f32_16x16x32_bf16 v[68:71], v[236:239], v[56:59], v[68:71]
ds_read_b64_tr_b16 v[232:233], v196 offset:20992
ds_read_b64_tr_b16 v[234:235], v196 offset:23040
v_mfma_f32_16x16x32_bf16 v[80:83], v[240:243], v[56:59], v[80:83]
v_mfma_f32_16x16x32_bf16 v[88:91], v[240:243], v[60:63], v[88:91]
ds_read_b64_tr_b16 v[236:237], v197 offset:20992
ds_read_b64_tr_b16 v[238:239], v197 offset:23040
v_mfma_f32_16x16x32_bf16 v[92:95], v[244:247], v[60:63], v[92:95]
s_waitcnt lgkmcnt(4)
s_nop 0
v_mfma_f32_16x16x32_bf16 v[84:87], v[244:247], v[56:59], v[84:87]
ds_read_b64_tr_b16 v[240:241], v198 offset:20992
ds_read_b64_tr_b16 v[242:243], v198 offset:23040
v_mfma_f32_16x16x32_bf16 v[128:131], v[216:219], v[0:3], 0
v_cvt_pk_bf16_f32 v176, v64, v65
v_cvt_pk_bf16_f32 v177, v66, v67
v_mfma_f32_16x16x32_bf16 v[136:139], v[216:219], v[4:7], 0
ds_read_b64_tr_b16 v[244:245], v199 offset:20992
ds_read_b64_tr_b16 v[246:247], v199 offset:23040
v_mfma_f32_16x16x32_bf16 v[140:143], v[220:223], v[4:7], 0
v_cvt_pk_bf16_f32 v178, v68, v69
v_cvt_pk_bf16_f32 v179, v70, v71
v_mfma_f32_16x16x32_bf16 v[132:135], v[220:223], v[0:3], 0
ds_read_b64_tr_b16 v[216:217], v196 offset:25088
ds_read_b64_tr_b16 v[218:219], v196 offset:27136
v_mfma_f32_16x16x32_bf16 v[144:147], v[224:227], v[0:3], 0
s_mov_b32 s80, 786432
buffer_store_dwordx4 v[176:179], v248, s[40:43], s80 offen sc1
v_mfma_f32_16x16x32_bf16 v[152:155], v[224:227], v[4:7], 0
ds_read_b64_tr_b16 v[220:221], v197 offset:25088
ds_read_b64_tr_b16 v[222:223], v197 offset:27136
v_mfma_f32_16x16x32_bf16 v[156:159], v[228:231], v[4:7], 0
s_waitcnt lgkmcnt(4)
s_nop 0
v_mfma_f32_16x16x32_bf16 v[148:151], v[228:231], v[0:3], 0
ds_read_b64_tr_b16 v[224:225], v198 offset:25088
ds_read_b64_tr_b16 v[226:227], v198 offset:27136
v_mfma_f32_16x16x32_bf16 v[128:131], v[232:235], v[8:11], v[128:131]
v_cvt_pk_bf16_f32 v180, v72, v73
v_cvt_pk_bf16_f32 v181, v74, v75
v_mfma_f32_16x16x32_bf16 v[136:139], v[232:235], v[12:15], v[136:139]
ds_read_b64_tr_b16 v[228:229], v199 offset:25088
ds_read_b64_tr_b16 v[230:231], v199 offset:27136
v_mfma_f32_16x16x32_bf16 v[140:143], v[236:239], v[12:15], v[140:143]
v_cvt_pk_bf16_f32 v182, v76, v77
v_cvt_pk_bf16_f32 v183, v78, v79
v_mfma_f32_16x16x32_bf16 v[132:135], v[236:239], v[8:11], v[132:135]
ds_read_b64_tr_b16 v[232:233], v196 offset:29184
ds_read_b64_tr_b16 v[234:235], v196 offset:31232
v_mfma_f32_16x16x32_bf16 v[144:147], v[240:243], v[8:11], v[144:147]
s_mov_b32 s80, 802816
buffer_store_dwordx4 v[180:183], v248, s[40:43], s80 offen sc1
v_mfma_f32_16x16x32_bf16 v[152:155], v[240:243], v[12:15], v[152:155]
ds_read_b64_tr_b16 v[236:237], v197 offset:29184
ds_read_b64_tr_b16 v[238:239], v197 offset:31232
v_mfma_f32_16x16x32_bf16 v[156:159], v[244:247], v[12:15], v[156:159]
s_waitcnt lgkmcnt(4)
s_nop 0
v_mfma_f32_16x16x32_bf16 v[148:151], v[244:247], v[8:11], v[148:151]
ds_read_b64_tr_b16 v[240:241], v198 offset:29184
ds_read_b64_tr_b16 v[242:243], v198 offset:31232
v_mfma_f32_16x16x32_bf16 v[128:131], v[216:219], v[16:19], v[128:131]
v_cvt_pk_bf16_f32 v184, v80, v81
v_cvt_pk_bf16_f32 v185, v82, v83
v_mfma_f32_16x16x32_bf16 v[136:139], v[216:219], v[20:23], v[136:139]
ds_read_b64_tr_b16 v[244:245], v199 offset:29184
ds_read_b64_tr_b16 v[246:247], v199 offset:31232
v_mfma_f32_16x16x32_bf16 v[140:143], v[220:223], v[20:23], v[140:143]
v_cvt_pk_bf16_f32 v186, v84, v85
v_cvt_pk_bf16_f32 v187, v86, v87
v_mfma_f32_16x16x32_bf16 v[132:135], v[220:223], v[16:19], v[132:135]
s_barrier
ds_read_b64_tr_b16 v[216:217], v196 offset:33792
ds_read_b64_tr_b16 v[218:219], v196 offset:35840
v_mfma_f32_16x16x32_bf16 v[144:147], v[224:227], v[16:19], v[144:147]
s_mov_b32 s80, 819200
buffer_store_dwordx4 v[184:187], v248, s[40:43], s80 offen sc1
v_mfma_f32_16x16x32_bf16 v[152:155], v[224:227], v[20:23], v[152:155]
ds_read_b64_tr_b16 v[220:221], v197 offset:33792
ds_read_b64_tr_b16 v[222:223], v197 offset:35840
v_mfma_f32_16x16x32_bf16 v[156:159], v[228:231], v[20:23], v[156:159]
s_waitcnt lgkmcnt(4)
v_mfma_f32_16x16x32_bf16 v[148:151], v[228:231], v[16:19], v[148:151]
ds_read_b64_tr_b16 v[224:225], v198 offset:33792
ds_read_b64_tr_b16 v[226:227], v198 offset:35840
v_mfma_f32_16x16x32_bf16 v[128:131], v[232:235], v[24:27], v[128:131]
v_cvt_pk_bf16_f32 v188, v88, v89
v_cvt_pk_bf16_f32 v189, v90, v91
v_mfma_f32_16x16x32_bf16 v[136:139], v[232:235], v[28:31], v[136:139]
ds_read_b64_tr_b16 v[228:229], v199 offset:33792
ds_read_b64_tr_b16 v[230:231], v199 offset:35840
v_mfma_f32_16x16x32_bf16 v[140:143], v[236:239], v[28:31], v[140:143]
v_cvt_pk_bf16_f32 v190, v92, v93
v_cvt_pk_bf16_f32 v191, v94, v95
s_waitcnt vmcnt(3)
s_mov_b64 exec, 1
global_store_dword v249, v254, s[100:101] offset:256 sc1
s_mov_b64 exec, -1
v_mfma_f32_16x16x32_bf16 v[132:135], v[236:239], v[24:27], v[132:135]
ds_read_b64_tr_b16 v[232:233], v196 offset:37888
ds_read_b64_tr_b16 v[234:235], v196 offset:39936
v_mfma_f32_16x16x32_bf16 v[144:147], v[240:243], v[24:27], v[144:147]
s_mov_b32 s80, 835584
buffer_store_dwordx4 v[188:191], v248, s[40:43], s80 offen sc1
v_mfma_f32_16x16x32_bf16 v[152:155], v[240:243], v[28:31], v[152:155]
ds_read_b64_tr_b16 v[236:237], v197 offset:37888
ds_read_b64_tr_b16 v[238:239], v197 offset:39936
v_mfma_f32_16x16x32_bf16 v[156:159], v[244:247], v[28:31], v[156:159]
s_waitcnt lgkmcnt(4)
v_mfma_f32_16x16x32_bf16 v[148:151], v[244:247], v[24:27], v[148:151]
ds_read_b64_tr_b16 v[240:241], v198 offset:37888
ds_read_b64_tr_b16 v[242:243], v198 offset:39936
v_mfma_f32_16x16x32_bf16 v[128:131], v[216:219], v[32:35], v[128:131]
v_mfma_f32_16x16x32_bf16 v[136:139], v[216:219], v[36:39], v[136:139]
ds_read_b64_tr_b16 v[244:245], v199 offset:37888
ds_read_b64_tr_b16 v[246:247], v199 offset:39936
v_mfma_f32_16x16x32_bf16 v[140:143], v[220:223], v[36:39], v[140:143]
v_mfma_f32_16x16x32_bf16 v[132:135], v[220:223], v[32:35], v[132:135]
ds_read_b64_tr_b16 v[216:217], v196 offset:41984
ds_read_b64_tr_b16 v[218:219], v196 offset:44032
v_mfma_f32_16x16x32_bf16 v[144:147], v[224:227], v[32:35], v[144:147]
v_mfma_f32_16x16x32_bf16 v[152:155], v[224:227], v[36:39], v[152:155]
ds_read_b64_tr_b16 v[220:221], v197 offset:41984
ds_read_b64_tr_b16 v[222:223], v197 offset:44032
v_mfma_f32_16x16x32_bf16 v[156:159], v[228:231], v[36:39], v[156:159]
s_waitcnt lgkmcnt(4)
s_nop 0
v_mfma_f32_16x16x32_bf16 v[148:151], v[228:231], v[32:35], v[148:151]
ds_read_b64_tr_b16 v[224:225], v198 offset:41984
ds_read_b64_tr_b16 v[226:227], v198 offset:44032
v_mfma_f32_16x16x32_bf16 v[128:131], v[232:235], v[40:43], v[128:131]
v_mfma_f32_16x16x32_bf16 v[136:139], v[232:235], v[44:47], v[136:139]
ds_read_b64_tr_b16 v[228:229], v199 offset:41984
ds_read_b64_tr_b16 v[230:231], v199 offset:44032
v_mfma_f32_16x16x32_bf16 v[140:143], v[236:239], v[44:47], v[140:143]
v_mfma_f32_16x16x32_bf16 v[132:135], v[236:239], v[40:43], v[132:135]
ds_read_b64_tr_b16 v[232:233], v196 offset:46080
ds_read_b64_tr_b16 v[234:235], v196 offset:48128
v_mfma_f32_16x16x32_bf16 v[144:147], v[240:243], v[40:43], v[144:147]
v_mfma_f32_16x16x32_bf16 v[152:155], v[240:243], v[44:47], v[152:155]
ds_read_b64_tr_b16 v[236:237], v197 offset:46080
ds_read_b64_tr_b16 v[238:239], v197 offset:48128
v_mfma_f32_16x16x32_bf16 v[156:159], v[244:247], v[44:47], v[156:159]
s_waitcnt lgkmcnt(4)
s_nop 0
v_mfma_f32_16x16x32_bf16 v[148:151], v[244:247], v[40:43], v[148:151]
ds_read_b64_tr_b16 v[240:241], v198 offset:46080
ds_read_b64_tr_b16 v[242:243], v198 offset:48128
v_mfma_f32_16x16x32_bf16 v[128:131], v[216:219], v[48:51], v[128:131]
v_mfma_f32_16x16x32_bf16 v[136:139], v[216:219], v[52:55], v[136:139]
ds_read_b64_tr_b16 v[244:245], v199 offset:46080
ds_read_b64_tr_b16 v[246:247], v199 offset:48128
v_mfma_f32_16x16x32_bf16 v[140:143], v[220:223], v[52:55], v[140:143]
v_mfma_f32_16x16x32_bf16 v[132:135], v[220:223], v[48:51], v[132:135]
ds_read_b64_tr_b16 v[216:217], v192 offset:0
ds_read_b64_tr_b16 v[218:219], v192 offset:2048
v_mfma_f32_16x16x32_bf16 v[144:147], v[224:227], v[48:51], v[144:147]
v_mfma_f32_16x16x32_bf16 v[152:155], v[224:227], v[52:55], v[152:155]
ds_read_b64_tr_b16 v[220:221], v193 offset:0
ds_read_b64_tr_b16 v[222:223], v193 offset:2048
v_mfma_f32_16x16x32_bf16 v[156:159], v[228:231], v[52:55], v[156:159]
s_waitcnt lgkmcnt(4)
s_nop 0
v_mfma_f32_16x16x32_bf16 v[148:151], v[228:231], v[48:51], v[148:151]
ds_read_b64_tr_b16 v[224:225], v194 offset:0
ds_read_b64_tr_b16 v[226:227], v194 offset:2048
v_mfma_f32_16x16x32_bf16 v[128:131], v[232:235], v[56:59], v[128:131]
v_mfma_f32_16x16x32_bf16 v[136:139], v[232:235], v[60:63], v[136:139]
ds_read_b64_tr_b16 v[228:229], v195 offset:0
ds_read_b64_tr_b16 v[230:231], v195 offset:2048
v_mfma_f32_16x16x32_bf16 v[140:143], v[236:239], v[60:63], v[140:143]
v_mfma_f32_16x16x32_bf16 v[132:135], v[236:239], v[56:59], v[132:135]
ds_read_b64_tr_b16 v[232:233], v192 offset:4096
ds_read_b64_tr_b16 v[234:235], v192 offset:6144
v_mfma_f32_16x16x32_bf16 v[144:147], v[240:243], v[56:59], v[144:147]
v_mfma_f32_16x16x32_bf16 v[152:155], v[240:243], v[60:63], v[152:155]
ds_read_b64_tr_b16 v[236:237], v193 offset:4096
ds_read_b64_tr_b16 v[238:239], v193 offset:6144
v_mfma_f32_16x16x32_bf16 v[156:159], v[244:247], v[60:63], v[156:159]
s_waitcnt lgkmcnt(4)
s_nop 0
v_mfma_f32_16x16x32_bf16 v[148:151], v[244:247], v[56:59], v[148:151]
ds_read_b64_tr_b16 v[240:241], v194 offset:4096
ds_read_b64_tr_b16 v[242:243], v194 offset:6144
v_mfma_f32_16x16x32_bf16 v[64:67], v[216:219], v[0:3], 0
v_cvt_pk_bf16_f32 v160, v128, v129
v_cvt_pk_bf16_f32 v161, v130, v131
v_mfma_f32_16x16x32_bf16 v[72:75], v[216:219], v[4:7], 0
ds_read_b64_tr_b16 v[244:245], v195 offset:4096
ds_read_b64_tr_b16 v[246:247], v195 offset:6144
v_mfma_f32_16x16x32_bf16 v[76:79], v[220:223], v[4:7], 0
v_cvt_pk_bf16_f32 v162, v132, v133
v_cvt_pk_bf16_f32 v163, v134, v135
v_mfma_f32_16x16x32_bf16 v[68:71], v[220:223], v[0:3], 0
ds_read_b64_tr_b16 v[216:217], v192 offset:8192
ds_read_b64_tr_b16 v[218:219], v192 offset:10240
v_mfma_f32_16x16x32_bf16 v[80:83], v[224:227], v[0:3], 0
s_mov_b32 s80, 1048576
buffer_store_dwordx4 v[160:163], v248, s[40:43], s80 offen sc1
v_mfma_f32_16x16x32_bf16 v[88:91], v[224:227], v[4:7], 0
ds_read_b64_tr_b16 v[220:221], v193 offset:8192
ds_read_b64_tr_b16 v[222:223], v193 offset:10240
v_mfma_f32_16x16x32_bf16 v[92:95], v[228:231], v[4:7], 0
s_waitcnt lgkmcnt(4)
s_nop 0
v_mfma_f32_16x16x32_bf16 v[84:87], v[228:231], v[0:3], 0
ds_read_b64_tr_b16 v[224:225], v194 offset:8192
ds_read_b64_tr_b16 v[226:227], v194 offset:10240
v_mfma_f32_16x16x32_bf16 v[64:67], v[232:235], v[8:11], v[64:67]
v_cvt_pk_bf16_f32 v164, v136, v137
v_cvt_pk_bf16_f32 v165, v138, v139
v_mfma_f32_16x16x32_bf16 v[72:75], v[232:235], v[12:15], v[72:75]
ds_read_b64_tr_b16 v[228:229], v195 offset:8192
ds_read_b64_tr_b16 v[230:231], v195 offset:10240
v_mfma_f32_16x16x32_bf16 v[76:79], v[236:239], v[12:15], v[76:79]
v_cvt_pk_bf16_f32 v166, v140, v141
v_cvt_pk_bf16_f32 v167, v142, v143
v_mfma_f32_16x16x32_bf16 v[68:71], v[236:239], v[8:11], v[68:71]
ds_read_b64_tr_b16 v[232:233], v192 offset:12288
ds_read_b64_tr_b16 v[234:235], v192 offset:14336
v_mfma_f32_16x16x32_bf16 v[80:83], v[240:243], v[8:11], v[80:83]
s_mov_b32 s80, 1064960
buffer_store_dwordx4 v[164:167], v248, s[40:43], s80 offen sc1
v_mfma_f32_16x16x32_bf16 v[88:91], v[240:243], v[12:15], v[88:91]
ds_read_b64_tr_b16 v[236:237], v193 offset:12288
ds_read_b64_tr_b16 v[238:239], v193 offset:14336
v_mfma_f32_16x16x32_bf16 v[92:95], v[244:247], v[12:15], v[92:95]
s_waitcnt lgkmcnt(4)
s_nop 0
v_mfma_f32_16x16x32_bf16 v[84:87], v[244:247], v[8:11], v[84:87]
ds_read_b64_tr_b16 v[240:241], v194 offset:12288
ds_read_b64_tr_b16 v[242:243], v194 offset:14336
v_mfma_f32_16x16x32_bf16 v[64:67], v[216:219], v[16:19], v[64:67]
v_cvt_pk_bf16_f32 v168, v144, v145
v_cvt_pk_bf16_f32 v169, v146, v147
v_mfma_f32_16x16x32_bf16 v[72:75], v[216:219], v[20:23], v[72:75]
ds_read_b64_tr_b16 v[244:245], v195 offset:12288
ds_read_b64_tr_b16 v[246:247], v195 offset:14336
v_mfma_f32_16x16x32_bf16 v[76:79], v[220:223], v[20:23], v[76:79]
v_cvt_pk_bf16_f32 v170, v148, v149
v_cvt_pk_bf16_f32 v171, v150, v151
v_mfma_f32_16x16x32_bf16 v[68:71], v[220:223], v[16:19], v[68:71]
ds_read_b64_tr_b16 v[216:217], v192 offset:16896
ds_read_b64_tr_b16 v[218:219], v192 offset:18944
v_mfma_f32_16x16x32_bf16 v[80:83], v[224:227], v[16:19], v[80:83]
s_mov_b32 s80, 1081344
buffer_store_dwordx4 v[168:171], v248, s[40:43], s80 offen sc1
v_mfma_f32_16x16x32_bf16 v[88:91], v[224:227], v[20:23], v[88:91]
ds_read_b64_tr_b16 v[220:221], v193 offset:16896
ds_read_b64_tr_b16 v[222:223], v193 offset:18944
v_mfma_f32_16x16x32_bf16 v[92:95], v[228:231], v[20:23], v[92:95]
s_waitcnt lgkmcnt(4)
s_nop 0
v_mfma_f32_16x16x32_bf16 v[84:87], v[228:231], v[16:19], v[84:87]
ds_read_b64_tr_b16 v[224:225], v194 offset:16896
ds_read_b64_tr_b16 v[226:227], v194 offset:18944
v_mfma_f32_16x16x32_bf16 v[64:67], v[232:235], v[24:27], v[64:67]
v_cvt_pk_bf16_f32 v172, v152, v153
v_cvt_pk_bf16_f32 v173, v154, v155
v_mfma_f32_16x16x32_bf16 v[72:75], v[232:235], v[28:31], v[72:75]
ds_read_b64_tr_b16 v[228:229], v195 offset:16896
ds_read_b64_tr_b16 v[230:231], v195 offset:18944
v_mfma_f32_16x16x32_bf16 v[76:79], v[236:239], v[28:31], v[76:79]
v_cvt_pk_bf16_f32 v174, v156, v157
v_cvt_pk_bf16_f32 v175, v158, v159
s_waitcnt vmcnt(3)
s_mov_b64 exec, 1
global_store_dword v249, v254, s[100:101] offset:384 sc1
s_mov_b64 exec, -1
v_mfma_f32_16x16x32_bf16 v[68:71], v[236:239], v[24:27], v[68:71]
ds_read_b64_tr_b16 v[232:233], v192 offset:20992
ds_read_b64_tr_b16 v[234:235], v192 offset:23040
v_mfma_f32_16x16x32_bf16 v[80:83], v[240:243], v[24:27], v[80:83]
s_mov_b32 s80, 1097728
buffer_store_dwordx4 v[172:175], v248, s[40:43], s80 offen sc1
v_mfma_f32_16x16x32_bf16 v[88:91], v[240:243], v[28:31], v[88:91]
ds_read_b64_tr_b16 v[236:237], v193 offset:20992
ds_read_b64_tr_b16 v[238:239], v193 offset:23040
v_mfma_f32_16x16x32_bf16 v[92:95], v[244:247], v[28:31], v[92:95]
s_waitcnt lgkmcnt(4)
v_mfma_f32_16x16x32_bf16 v[84:87], v[244:247], v[24:27], v[84:87]
ds_read_b64_tr_b16 v[240:241], v194 offset:20992
ds_read_b64_tr_b16 v[242:243], v194 offset:23040
v_mfma_f32_16x16x32_bf16 v[64:67], v[216:219], v[32:35], v[64:67]
v_mfma_f32_16x16x32_bf16 v[72:75], v[216:219], v[36:39], v[72:75]
ds_read_b64_tr_b16 v[244:245], v195 offset:20992
ds_read_b64_tr_b16 v[246:247], v195 offset:23040
v_mfma_f32_16x16x32_bf16 v[76:79], v[220:223], v[36:39], v[76:79]
v_mfma_f32_16x16x32_bf16 v[68:71], v[220:223], v[32:35], v[68:71]
ds_read_b64_tr_b16 v[216:217], v192 offset:25088
ds_read_b64_tr_b16 v[218:219], v192 offset:27136
v_mfma_f32_16x16x32_bf16 v[80:83], v[224:227], v[32:35], v[80:83]
v_mfma_f32_16x16x32_bf16 v[88:91], v[224:227], v[36:39], v[88:91]
ds_read_b64_tr_b16 v[220:221], v193 offset:25088
ds_read_b64_tr_b16 v[222:223], v193 offset:27136
v_mfma_f32_16x16x32_bf16 v[92:95], v[228:231], v[36:39], v[92:95]
s_waitcnt lgkmcnt(4)
s_nop 0
v_mfma_f32_16x16x32_bf16 v[84:87], v[228:231], v[32:35], v[84:87]
ds_read_b64_tr_b16 v[224:225], v194 offset:25088
ds_read_b64_tr_b16 v[226:227], v194 offset:27136
v_mfma_f32_16x16x32_bf16 v[64:67], v[232:235], v[40:43], v[64:67]
v_mfma_f32_16x16x32_bf16 v[72:75], v[232:235], v[44:47], v[72:75]
ds_read_b64_tr_b16 v[228:229], v195 offset:25088
ds_read_b64_tr_b16 v[230:231], v195 offset:27136
v_mfma_f32_16x16x32_bf16 v[76:79], v[236:239], v[44:47], v[76:79]
v_mfma_f32_16x16x32_bf16 v[68:71], v[236:239], v[40:43], v[68:71]
ds_read_b64_tr_b16 v[232:233], v192 offset:29184
ds_read_b64_tr_b16 v[234:235], v192 offset:31232
v_mfma_f32_16x16x32_bf16 v[80:83], v[240:243], v[40:43], v[80:83]
v_mfma_f32_16x16x32_bf16 v[88:91], v[240:243], v[44:47], v[88:91]
ds_read_b64_tr_b16 v[236:237], v193 offset:29184
ds_read_b64_tr_b16 v[238:239], v193 offset:31232
v_mfma_f32_16x16x32_bf16 v[92:95], v[244:247], v[44:47], v[92:95]
s_waitcnt lgkmcnt(4)
s_nop 0
v_mfma_f32_16x16x32_bf16 v[84:87], v[244:247], v[40:43], v[84:87]
ds_read_b64_tr_b16 v[240:241], v194 offset:29184
ds_read_b64_tr_b16 v[242:243], v194 offset:31232
v_mfma_f32_16x16x32_bf16 v[64:67], v[216:219], v[48:51], v[64:67]
v_mfma_f32_16x16x32_bf16 v[72:75], v[216:219], v[52:55], v[72:75]
ds_read_b64_tr_b16 v[244:245], v195 offset:29184
ds_read_b64_tr_b16 v[246:247], v195 offset:31232
v_mfma_f32_16x16x32_bf16 v[76:79], v[220:223], v[52:55], v[76:79]
v_mfma_f32_16x16x32_bf16 v[68:71], v[220:223], v[48:51], v[68:71]
ds_read_b64_tr_b16 v[216:217], v200 offset:16896
ds_read_b64_tr_b16 v[218:219], v200 offset:18944
v_mfma_f32_16x16x32_bf16 v[80:83], v[224:227], v[48:51], v[80:83]
v_mfma_f32_16x16x32_bf16 v[88:91], v[224:227], v[52:55], v[88:91]
ds_read_b64_tr_b16 v[220:221], v201 offset:16896
ds_read_b64_tr_b16 v[222:223], v201 offset:18944
v_mfma_f32_16x16x32_bf16 v[92:95], v[228:231], v[52:55], v[92:95]
s_waitcnt lgkmcnt(4)
s_nop 0
v_mfma_f32_16x16x32_bf16 v[84:87], v[228:231], v[48:51], v[84:87]
ds_read_b64_tr_b16 v[224:225], v202 offset:16896
ds_read_b64_tr_b16 v[226:227], v202 offset:18944
v_mfma_f32_16x16x32_bf16 v[64:67], v[232:235], v[56:59], v[64:67]
v_mfma_f32_16x16x32_bf16 v[72:75], v[232:235], v[60:63], v[72:75]
ds_read_b64_tr_b16 v[228:229], v203 offset:16896
ds_read_b64_tr_b16 v[230:231], v203 offset:18944
v_mfma_f32_16x16x32_bf16 v[76:79], v[236:239], v[60:63], v[76:79]
v_mfma_f32_16x16x32_bf16 v[68:71], v[236:239], v[56:59], v[68:71]
ds_read_b64_tr_b16 v[232:233], v200 offset:20992
ds_read_b64_tr_b16 v[234:235], v200 offset:23040
v_mfma_f32_16x16x32_bf16 v[80:83], v[240:243], v[56:59], v[80:83]
v_mfma_f32_16x16x32_bf16 v[88:91], v[240:243], v[60:63], v[88:91]
ds_read_b64_tr_b16 v[236:237], v201 offset:20992
ds_read_b64_tr_b16 v[238:239], v201 offset:23040
v_mfma_f32_16x16x32_bf16 v[92:95], v[244:247], v[60:63], v[92:95]
s_waitcnt lgkmcnt(4)
s_nop 0
v_mfma_f32_16x16x32_bf16 v[84:87], v[244:247], v[56:59], v[84:87]
ds_read_b64_tr_b16 v[240:241], v202 offset:20992
ds_read_b64_tr_b16 v[242:243], v202 offset:23040
v_mfma_f32_16x16x32_bf16 v[128:131], v[216:219], v[0:3], 0
v_cvt_pk_bf16_f32 v176, v64, v65
v_cvt_pk_bf16_f32 v177, v66, v67
v_mfma_f32_16x16x32_bf16 v[136:139], v[216:219], v[4:7], 0
ds_read_b64_tr_b16 v[244:245], v203 offset:20992
ds_read_b64_tr_b16 v[246:247], v203 offset:23040
v_mfma_f32_16x16x32_bf16 v[140:143], v[220:223], v[4:7], 0
v_cvt_pk_bf16_f32 v178, v68, v69
v_cvt_pk_bf16_f32 v179, v70, v71
v_mfma_f32_16x16x32_bf16 v[132:135], v[220:223], v[0:3], 0
ds_read_b64_tr_b16 v[216:217], v200 offset:25088
ds_read_b64_tr_b16 v[218:219], v200 offset:27136
v_mfma_f32_16x16x32_bf16 v[144:147], v[224:227], v[0:3], 0
s_mov_b32 s80, 1310720
buffer_store_dwordx4 v[176:179], v248, s[40:43], s80 offen sc1
v_mfma_f32_16x16x32_bf16 v[152:155], v[224:227], v[4:7], 0
ds_read_b64_tr_b16 v[220:221], v201 offset:25088
ds_read_b64_tr_b16 v[222:223], v201 offset:27136
v_mfma_f32_16x16x32_bf16 v[156:159], v[228:231], v[4:7], 0
s_waitcnt lgkmcnt(4)
s_nop 0
v_mfma_f32_16x16x32_bf16 v[148:151], v[228:231], v[0:3], 0
ds_read_b64_tr_b16 v[224:225], v202 offset:25088
ds_read_b64_tr_b16 v[226:227], v202 offset:27136
v_mfma_f32_16x16x32_bf16 v[128:131], v[232:235], v[8:11], v[128:131]
v_cvt_pk_bf16_f32 v180, v72, v73
v_cvt_pk_bf16_f32 v181, v74, v75
v_mfma_f32_16x16x32_bf16 v[136:139], v[232:235], v[12:15], v[136:139]
ds_read_b64_tr_b16 v[228:229], v203 offset:25088
ds_read_b64_tr_b16 v[230:231], v203 offset:27136
v_mfma_f32_16x16x32_bf16 v[140:143], v[236:239], v[12:15], v[140:143]
v_cvt_pk_bf16_f32 v182, v76, v77
v_cvt_pk_bf16_f32 v183, v78, v79
v_mfma_f32_16x16x32_bf16 v[132:135], v[236:239], v[8:11], v[132:135]
ds_read_b64_tr_b16 v[232:233], v200 offset:29184
ds_read_b64_tr_b16 v[234:235], v200 offset:31232
v_mfma_f32_16x16x32_bf16 v[144:147], v[240:243], v[8:11], v[144:147]
s_mov_b32 s80, 1327104
buffer_store_dwordx4 v[180:183], v248, s[40:43], s80 offen sc1
v_mfma_f32_16x16x32_bf16 v[152:155], v[240:243], v[12:15], v[152:155]
ds_read_b64_tr_b16 v[236:237], v201 offset:29184
ds_read_b64_tr_b16 v[238:239], v201 offset:31232
v_mfma_f32_16x16x32_bf16 v[156:159], v[244:247], v[12:15], v[156:159]
s_waitcnt lgkmcnt(4)
s_nop 0
v_mfma_f32_16x16x32_bf16 v[148:151], v[244:247], v[8:11], v[148:151]
ds_read_b64_tr_b16 v[240:241], v202 offset:29184
ds_read_b64_tr_b16 v[242:243], v202 offset:31232
v_mfma_f32_16x16x32_bf16 v[128:131], v[216:219], v[16:19], v[128:131]
v_cvt_pk_bf16_f32 v184, v80, v81
v_cvt_pk_bf16_f32 v185, v82, v83
v_mfma_f32_16x16x32_bf16 v[136:139], v[216:219], v[20:23], v[136:139]
ds_read_b64_tr_b16 v[244:245], v203 offset:29184
ds_read_b64_tr_b16 v[246:247], v203 offset:31232
v_mfma_f32_16x16x32_bf16 v[140:143], v[220:223], v[20:23], v[140:143]
v_cvt_pk_bf16_f32 v186, v84, v85
v_cvt_pk_bf16_f32 v187, v86, v87
v_mfma_f32_16x16x32_bf16 v[132:135], v[220:223], v[16:19], v[132:135]
ds_read_b64_tr_b16 v[216:217], v192 offset:33792
ds_read_b64_tr_b16 v[218:219], v192 offset:35840
v_mfma_f32_16x16x32_bf16 v[144:147], v[224:227], v[16:19], v[144:147]
s_mov_b32 s80, 1343488
buffer_store_dwordx4 v[184:187], v248, s[40:43], s80 offen sc1
v_mfma_f32_16x16x32_bf16 v[152:155], v[224:227], v[20:23], v[152:155]
ds_read_b64_tr_b16 v[220:221], v193 offset:33792
ds_read_b64_tr_b16 v[222:223], v193 offset:35840
v_mfma_f32_16x16x32_bf16 v[156:159], v[228:231], v[20:23], v[156:159]
s_waitcnt lgkmcnt(4)
s_nop 0
v_mfma_f32_16x16x32_bf16 v[148:151], v[228:231], v[16:19], v[148:151]
ds_read_b64_tr_b16 v[224:225], v194 offset:33792
ds_read_b64_tr_b16 v[226:227], v194 offset:35840
v_mfma_f32_16x16x32_bf16 v[128:131], v[232:235], v[24:27], v[128:131]
v_cvt_pk_bf16_f32 v188, v88, v89
v_cvt_pk_bf16_f32 v189, v90, v91
v_mfma_f32_16x16x32_bf16 v[136:139], v[232:235], v[28:31], v[136:139]
ds_read_b64_tr_b16 v[228:229], v195 offset:33792
ds_read_b64_tr_b16 v[230:231], v195 offset:35840
v_mfma_f32_16x16x32_bf16 v[140:143], v[236:239], v[28:31], v[140:143]
v_cvt_pk_bf16_f32 v190, v92, v93
v_cvt_pk_bf16_f32 v191, v94, v95
s_waitcnt vmcnt(3)
s_mov_b64 exec, 1
global_store_dword v249, v254, s[100:101] offset:512 sc1
s_mov_b64 exec, -1
v_mfma_f32_16x16x32_bf16 v[132:135], v[236:239], v[24:27], v[132:135]
ds_read_b64_tr_b16 v[232:233], v192 offset:37888
ds_read_b64_tr_b16 v[234:235], v192 offset:39936
v_mfma_f32_16x16x32_bf16 v[144:147], v[240:243], v[24:27], v[144:147]
s_mov_b32 s80, 1359872
buffer_store_dwordx4 v[188:191], v248, s[40:43], s80 offen sc1
v_mfma_f32_16x16x32_bf16 v[152:155], v[240:243], v[28:31], v[152:155]
ds_read_b64_tr_b16 v[236:237], v193 offset:37888
ds_read_b64_tr_b16 v[238:239], v193 offset:39936
v_mfma_f32_16x16x32_bf16 v[156:159], v[244:247], v[28:31], v[156:159]
s_waitcnt lgkmcnt(4)
v_mfma_f32_16x16x32_bf16 v[148:151], v[244:247], v[24:27], v[148:151]
ds_read_b64_tr_b16 v[240:241], v194 offset:37888
ds_read_b64_tr_b16 v[242:243], v194 offset:39936
v_mfma_f32_16x16x32_bf16 v[128:131], v[216:219], v[32:35], v[128:131]
v_mfma_f32_16x16x32_bf16 v[136:139], v[216:219], v[36:39], v[136:139]
ds_read_b64_tr_b16 v[244:245], v195 offset:37888
ds_read_b64_tr_b16 v[246:247], v195 offset:39936
v_mfma_f32_16x16x32_bf16 v[140:143], v[220:223], v[36:39], v[140:143]
v_mfma_f32_16x16x32_bf16 v[132:135], v[220:223], v[32:35], v[132:135]
ds_read_b64_tr_b16 v[216:217], v192 offset:41984
ds_read_b64_tr_b16 v[218:219], v192 offset:44032
v_mfma_f32_16x16x32_bf16 v[144:147], v[224:227], v[32:35], v[144:147]
v_mfma_f32_16x16x32_bf16 v[152:155], v[224:227], v[36:39], v[152:155]
ds_read_b64_tr_b16 v[220:221], v193 offset:41984
ds_read_b64_tr_b16 v[222:223], v193 offset:44032
v_mfma_f32_16x16x32_bf16 v[156:159], v[228:231], v[36:39], v[156:159]
s_waitcnt lgkmcnt(4)
s_nop 0
v_mfma_f32_16x16x32_bf16 v[148:151], v[228:231], v[32:35], v[148:151]
ds_read_b64_tr_b16 v[224:225], v194 offset:41984
ds_read_b64_tr_b16 v[226:227], v194 offset:44032
v_mfma_f32_16x16x32_bf16 v[128:131], v[232:235], v[40:43], v[128:131]
v_mfma_f32_16x16x32_bf16 v[136:139], v[232:235], v[44:47], v[136:139]
ds_read_b64_tr_b16 v[228:229], v195 offset:41984
ds_read_b64_tr_b16 v[230:231], v195 offset:44032
v_mfma_f32_16x16x32_bf16 v[140:143], v[236:239], v[44:47], v[140:143]
v_mfma_f32_16x16x32_bf16 v[132:135], v[236:239], v[40:43], v[132:135]
ds_read_b64_tr_b16 v[232:233], v192 offset:46080
ds_read_b64_tr_b16 v[234:235], v192 offset:48128
v_mfma_f32_16x16x32_bf16 v[144:147], v[240:243], v[40:43], v[144:147]
v_mfma_f32_16x16x32_bf16 v[152:155], v[240:243], v[44:47], v[152:155]
ds_read_b64_tr_b16 v[236:237], v193 offset:46080
ds_read_b64_tr_b16 v[238:239], v193 offset:48128
v_mfma_f32_16x16x32_bf16 v[156:159], v[244:247], v[44:47], v[156:159]
s_waitcnt lgkmcnt(4)
s_nop 0
v_mfma_f32_16x16x32_bf16 v[148:151], v[244:247], v[40:43], v[148:151]
ds_read_b64_tr_b16 v[240:241], v194 offset:46080
ds_read_b64_tr_b16 v[242:243], v194 offset:48128
v_mfma_f32_16x16x32_bf16 v[128:131], v[216:219], v[48:51], v[128:131]
v_mfma_f32_16x16x32_bf16 v[136:139], v[216:219], v[52:55], v[136:139]
ds_read_b64_tr_b16 v[244:245], v195 offset:46080
ds_read_b64_tr_b16 v[246:247], v195 offset:48128
v_mfma_f32_16x16x32_bf16 v[140:143], v[220:223], v[52:55], v[140:143]
v_mfma_f32_16x16x32_bf16 v[132:135], v[220:223], v[48:51], v[132:135]
v_mfma_f32_16x16x32_bf16 v[144:147], v[224:227], v[48:51], v[144:147]
v_mfma_f32_16x16x32_bf16 v[152:155], v[224:227], v[52:55], v[152:155]
v_mfma_f32_16x16x32_bf16 v[156:159], v[228:231], v[52:55], v[156:159]
s_waitcnt lgkmcnt(0)
s_nop 0
v_mfma_f32_16x16x32_bf16 v[148:151], v[228:231], v[48:51], v[148:151]
v_mfma_f32_16x16x32_bf16 v[128:131], v[232:235], v[56:59], v[128:131]
v_mfma_f32_16x16x32_bf16 v[136:139], v[232:235], v[60:63], v[136:139]
v_mfma_f32_16x16x32_bf16 v[140:143], v[236:239], v[60:63], v[140:143]
v_mfma_f32_16x16x32_bf16 v[132:135], v[236:239], v[56:59], v[132:135]
v_mfma_f32_16x16x32_bf16 v[144:147], v[240:243], v[56:59], v[144:147]
v_mfma_f32_16x16x32_bf16 v[152:155], v[240:243], v[60:63], v[152:155]
v_mfma_f32_16x16x32_bf16 v[156:159], v[244:247], v[60:63], v[156:159]
v_mfma_f32_16x16x32_bf16 v[148:151], v[244:247], v[56:59], v[148:151]
s_nop 0
v_cvt_pk_bf16_f32 v160, v128, v129
v_cvt_pk_bf16_f32 v161, v130, v131
s_nop 0
v_cvt_pk_bf16_f32 v162, v132, v133
v_cvt_pk_bf16_f32 v163, v134, v135
s_mov_b32 s80, 1572864
buffer_store_dwordx4 v[160:163], v248, s[40:43], s80 offen sc1
v_cvt_pk_bf16_f32 v164, v136, v137
v_cvt_pk_bf16_f32 v165, v138, v139
v_cvt_pk_bf16_f32 v166, v140, v141
v_cvt_pk_bf16_f32 v167, v142, v143
s_mov_b32 s80, 1589248
buffer_store_dwordx4 v[164:167], v248, s[40:43], s80 offen sc1
v_cvt_pk_bf16_f32 v168, v144, v145
v_cvt_pk_bf16_f32 v169, v146, v147
v_cvt_pk_bf16_f32 v170, v148, v149
v_cvt_pk_bf16_f32 v171, v150, v151
s_mov_b32 s80, 1605632
buffer_store_dwordx4 v[168:171], v248, s[40:43], s80 offen sc1
v_cvt_pk_bf16_f32 v172, v152, v153
v_cvt_pk_bf16_f32 v173, v154, v155
v_cvt_pk_bf16_f32 v174, v156, v157
v_cvt_pk_bf16_f32 v175, v158, v159
s_mov_b32 s80, 1622016
buffer_store_dwordx4 v[172:175], v248, s[40:43], s80 offen sc1
s_barrier
s_cmp_eq_u32 s6, 3
s_cbranch_scc1 L_cs1
ds_read_b128 v[192:195], v205 offset:0
ds_read_b128 v[196:199], v205 offset:1024
ds_read_b128 v[244:247], v205 offset:2048
ds_read_b128 v[250:253], v205 offset:3072
ds_read_b128 v[64:67], v204 offset:0
ds_read_b128 v[68:71], v204 offset:1024
ds_read_b128 v[72:75], v204 offset:2048
ds_read_b128 v[76:79], v204 offset:3072
ds_read_b128 v[80:83], v204 offset:4096
ds_read_b128 v[84:87], v204 offset:5120
ds_read_b128 v[88:91], v204 offset:6144
ds_read_b128 v[92:95], v204 offset:7168
ds_read_b128 v[96:99], v204 offset:8192
ds_read_b128 v[100:103], v204 offset:9216
ds_read_b128 v[104:107], v204 offset:10240
ds_read_b128 v[108:111], v204 offset:11264
ds_read_b128 v[112:115], v204 offset:12288
ds_read_b128 v[116:119], v204 offset:13312
ds_read_b128 v[120:123], v204 offset:14336
ds_read_b128 v[124:127], v204 offset:15360
L_cs1:
s_waitcnt vmcnt(4)
s_mov_b64 exec, 1
global_store_dword v249, v254, s[100:101] offset:640 sc1
s_mov_b64 exec, -1
s_cbranch_scc1 L_cs2
s_waitcnt lgkmcnt(15)
v_mfma_f32_16x16x32_bf16 v[200:203], v[192:195], v[64:67], 0
v_mfma_f32_16x16x32_bf16 v[204:207], v[196:199], v[64:67], 0
s_waitcnt lgkmcnt(14)
s_nop 0
v_mfma_f32_16x16x32_bf16 v[200:203], v[192:195], v[68:71], v[200:203]
v_mfma_f32_16x16x32_bf16 v[204:207], v[196:199], v[68:71], v[204:207]
s_waitcnt lgkmcnt(13)
s_nop 0
v_mfma_f32_16x16x32_bf16 v[200:203], v[192:195], v[72:75], v[200:203]
v_mfma_f32_16x16x32_bf16 v[204:207], v[196:199], v[72:75], v[204:207]
s_waitcnt lgkmcnt(12)
s_nop 0
v_mfma_f32_16x16x32_bf16 v[200:203], v[192:195], v[76:79], v[200:203]
v_mfma_f32_16x16x32_bf16 v[204:207], v[196:199], v[76:79], v[204:207]
s_waitcnt lgkmcnt(11)
s_nop 0
v_mfma_f32_16x16x32_bf16 v[200:203], v[192:195], v[80:83], v[200:203]
v_mfma_f32_16x16x32_bf16 v[204:207], v[196:199], v[80:83], v[204:207]
s_waitcnt lgkmcnt(10)
s_nop 0
v_mfma_f32_16x16x32_bf16 v[200:203], v[192:195], v[84:87], v[200:203]
v_mfma_f32_16x16x32_bf16 v[204:207], v[196:199], v[84:87], v[204:207]
s_waitcnt lgkmcnt(9)
s_nop 0
v_mfma_f32_16x16x32_bf16 v[200:203], v[192:195], v[88:91], v[200:203]
v_mfma_f32_16x16x32_bf16 v[204:207], v[196:199], v[88:91], v[204:207]
s_waitcnt lgkmcnt(8)
s_nop 0
v_mfma_f32_16x16x32_bf16 v[200:203], v[192:195], v[92:95], v[200:203]
v_mfma_f32_16x16x32_bf16 v[204:207], v[196:199], v[92:95], v[204:207]
s_waitcnt lgkmcnt(7)
s_nop 0
v_mfma_f32_16x16x32_bf16 v[200:203], v[192:195], v[96:99], v[200:203]
v_mfma_f32_16x16x32_bf16 v[204:207], v[196:199], v[96:99], v[204:207]
s_waitcnt lgkmcnt(6)
s_nop 0
v_mfma_f32_16x16x32_bf16 v[200:203], v[192:195], v[100:103], v[200:203]
v_mfma_f32_16x16x32_bf16 v[204:207], v[196:199], v[100:103], v[204:207]
s_waitcnt lgkmcnt(5)
s_nop 0
v_mfma_f32_16x16x32_bf16 v[200:203], v[192:195], v[104:107], v[200:203]
v_mfma_f32_16x16x32_bf16 v[204:207], v[196:199], v[104:107], v[204:207]
s_waitcnt lgkmcnt(4)
s_nop 0
v_mfma_f32_16x16x32_bf16 v[200:203], v[192:195], v[108:111], v[200:203]
v_mfma_f32_16x16x32_bf16 v[204:207], v[196:199], v[108:111], v[204:207]
s_waitcnt lgkmcnt(3)
s_nop 0
v_mfma_f32_16x16x32_bf16 v[200:203], v[192:195], v[112:115], v[200:203]
v_mfma_f32_16x16x32_bf16 v[204:207], v[196:199], v[112:115], v[204:207]
s_waitcnt lgkmcnt(2)
s_nop 0
v_mfma_f32_16x16x32_bf16 v[200:203], v[192:195], v[116:119], v[200:203]
v_mfma_f32_16x16x32_bf16 v[204:207], v[196:199], v[116:119], v[204:207]
s_waitcnt lgkmcnt(1)
s_nop 0
v_mfma_f32_16x16x32_bf16 v[200:203], v[192:195], v[120:123], v[200:203]
v_mfma_f32_16x16x32_bf16 v[204:207], v[196:199], v[120:123], v[204:207]
s_waitcnt lgkmcnt(0)
s_nop 0
v_mfma_f32_16x16x32_bf16 v[200:203], v[192:195], v[124:127], v[200:203]
v_mfma_f32_16x16x32_bf16 v[204:207], v[196:199], v[124:127], v[204:207]
L_cs2:
s_waitcnt vmcnt(1)
s_mov_b64 exec, 1
global_store_dword v249, v254, s[100:101] offset:768 sc1
s_mov_b64 exec, -1
s_cmp_eq_u32 s6, 3
s_cbranch_scc1 L_cdone
s_lshl_b32 s84, s6, 7
s_mov_b32 s81, 0
s_mov_b32 s75, 400000
buffer_load_dword v253, v252, s[32:35], s84 offen offset:512 sc1
s_waitcnt vmcnt(0)
v_cmp_le_u32_e64 vcc, 1, v253
s_andn2_b32 s82, vcc_lo, s81
s_or_b32 s81, s81, vcc_lo
s_bitcmp1_b32 s82, 0
s_cbranch_scc0 L_fa1_0
s_mov_b32 s83, 1048576
buffer_load_dwordx4 v[0:3], v248, s[20:23], s83 offen sc1
L_fa1_0:
s_bitcmp1_b32 s82, 1
s_cbranch_scc0 L_fa1_1
s_mov_b32 s83, 1049600
buffer_load_dwordx4 v[4:7], v248, s[20:23], s83 offen sc1
L_fa1_1:
s_bitcmp1_b32 s82, 2
s_cbranch_scc0 L_fa1_2
s_mov_b32 s83, 1050624
buffer_load_dwordx4 v[8:11], v248, s[20:23], s83 offen sc1
L_fa1_2:
s_bitcmp1_b32 s82, 3
s_cbranch_scc0 L_fa1_3
s_mov_b32 s83, 1051648
buffer_load_dwordx4 v[12:15], v248, s[20:23], s83 offen sc1
L_fa1_3:
s_bitcmp1_b32 s82, 4
s_cbranch_scc0 L_fa1_4
s_mov_b32 s83, 1052672
buffer_load_dwordx4 v[16:19], v248, s[20:23], s83 offen sc1
L_fa1_4:
s_bitcmp1_b32 s82, 5
s_cbranch_scc0 L_fa1_5
s_mov_b32 s83, 1053696
buffer_load_dwordx4 v[20:23], v248, s[20:23], s83 offen sc1
L_fa1_5:
s_bitcmp1_b32 s82, 6
s_cbranch_scc0 L_fa1_6
s_mov_b32 s83, 1054720
buffer_load_dwordx4 v[24:27], v248, s[20:23], s83 offen sc1
L_fa1_6:
s_bitcmp1_b32 s82, 7
s_cbranch_scc0 L_fa1_7
s_mov_b32 s83, 1055744
buffer_load_dwordx4 v[28:31], v248, s[20:23], s83 offen sc1
L_fa1_7:
s_bitcmp1_b32 s82, 8
s_cbranch_scc0 L_fa1_8
s_mov_b32 s83, 1056768
buffer_load_dwordx4 v[32:35], v248, s[20:23], s83 offen sc1
L_fa1_8:
s_bitcmp1_b32 s82, 9
s_cbranch_scc0 L_fa1_9
s_mov_b32 s83, 1057792
buffer_load_dwordx4 v[36:39], v248, s[20:23], s83 offen sc1
L_fa1_9:
s_bitcmp1_b32 s82, 10
s_cbranch_scc0 L_fa1_10
s_mov_b32 s83, 1058816
buffer_load_dwordx4 v[40:43], v248, s[20:23], s83 offen sc1
L_fa1_10:
s_bitcmp1_b32 s82, 11
s_cbranch_scc0 L_fa1_11
s_mov_b32 s83, 1059840
buffer_load_dwordx4 v[44:47], v248, s[20:23], s83 offen sc1
L_fa1_11:
s_bitcmp1_b32 s82, 12
s_cbranch_scc0 L_fa1_12
s_mov_b32 s83, 1060864
buffer_load_dwordx4 v[48:51], v248, s[20:23], s83 offen sc1
L_fa1_12:
s_bitcmp1_b32 s82, 13
s_cbranch_scc0 L_fa1_13
s_mov_b32 s83, 1061888
buffer_load_dwordx4 v[52:55], v248, s[20:23], s83 offen sc1
L_fa1_13:
s_bitcmp1_b32 s82, 14
s_cbranch_scc0 L_fa1_14
s_mov_b32 s83, 1062912
buffer_load_dwordx4 v[56:59], v248, s[20:23], s83 offen sc1
L_fa1_14:
s_bitcmp1_b32 s82, 15
s_cbranch_scc0 L_fa1_15
s_mov_b32 s83, 1063936
buffer_load_dwordx4 v[60:63], v248, s[20:23], s83 offen sc1
L_fa1_15:
v_cvt_pk_bf16_f32 v224, v200, v201
v_cvt_pk_bf16_f32 v225, v202, v203
v_cvt_pk_bf16_f32 v226, v204, v205
v_cvt_pk_bf16_f32 v227, v206, v207
v_lshlrev_b32 v200, 16, v224
v_and_b32 v201, s74, v224
v_lshlrev_b32 v202, 16, v225
v_and_b32 v203, s74, v225
v_lshlrev_b32 v204, 16, v226
v_and_b32 v205, s74, v226
v_lshlrev_b32 v206, 16, v227
v_and_b32 v207, s74, v227
v_mul_f32 v224, s73, v200
v_mul_f32 v225, s73, v201
v_mul_f32 v226, s73, v202
v_mul_f32 v227, s73, v203
v_mul_f32 v228, s73, v204
v_mul_f32 v229, s73, v205
v_mul_f32 v230, s73, v206
v_mul_f32 v231, s73, v207
v_exp_f32 v224, v224
v_exp_f32 v225, v225
v_exp_f32 v226, v226
v_exp_f32 v227, v227
v_exp_f32 v228, v228
v_exp_f32 v229, v229
v_exp_f32 v230, v230
v_exp_f32 v231, v231
v_add_f32 v224, 1.0, v224
v_add_f32 v225, 1.0, v225
v_add_f32 v226, 1.0, v226
v_add_f32 v227, 1.0, v227
v_add_f32 v228, 1.0, v228
v_add_f32 v229, 1.0, v229
v_add_f32 v230, 1.0, v230
v_add_f32 v231, 1.0, v231
v_rcp_f32 v224, v224
v_rcp_f32 v225, v225
v_rcp_f32 v226, v226
v_rcp_f32 v227, v227
v_rcp_f32 v228, v228
v_rcp_f32 v229, v229
v_rcp_f32 v230, v230
v_rcp_f32 v231, v231
v_mul_f32 v200, v200, v224
v_mul_f32 v201, v201, v225
v_mul_f32 v202, v202, v226
v_mul_f32 v203, v203, v227
v_mul_f32 v204, v204, v228
v_mul_f32 v205, v205, v229
v_mul_f32 v206, v206, v230
v_mul_f32 v207, v207, v231
v_cvt_pk_bf16_f32 v224, v200, v201
v_cvt_pk_bf16_f32 v225, v202, v203
v_cvt_pk_bf16_f32 v226, v204, v205
v_cvt_pk_bf16_f32 v227, v206, v207
v_lshlrev_b32 v200, 16, v224
v_and_b32 v201, s74, v224
v_lshlrev_b32 v202, 16, v225
v_and_b32 v203, s74, v225
v_lshlrev_b32 v204, 16, v226
v_and_b32 v205, s74, v226
v_lshlrev_b32 v206, 16, v227
v_and_b32 v207, s74, v227
s_cmp_eq_u32 s81, -1
s_cbranch_scc1 L_fd1
L_fl1:
buffer_load_dword v253, v252, s[32:35], s84 offen offset:512 sc1
s_waitcnt vmcnt(0)
v_cmp_le_u32 vcc, 1, v253
s_andn2_b32 s82, vcc_lo, s81
s_or_b32 s81, s81, vcc_lo
s_bitcmp1_b32 s82, 0
s_cbranch_scc0 L_fb1_0
s_mov_b32 s83, 1048576
buffer_load_dwordx4 v[0:3], v248, s[20:23], s83 offen sc1
L_fb1_0:
s_bitcmp1_b32 s82, 1
s_cbranch_scc0 L_fb1_1
s_mov_b32 s83, 1049600
buffer_load_dwordx4 v[4:7], v248, s[20:23], s83 offen sc1
L_fb1_1:
s_bitcmp1_b32 s82, 2
s_cbranch_scc0 L_fb1_2
s_mov_b32 s83, 1050624
buffer_load_dwordx4 v[8:11], v248, s[20:23], s83 offen sc1
L_fb1_2:
s_bitcmp1_b32 s82, 3
s_cbranch_scc0 L_fb1_3
s_mov_b32 s83, 1051648
buffer_load_dwordx4 v[12:15], v248, s[20:23], s83 offen sc1
L_fb1_3:
s_bitcmp1_b32 s82, 4
s_cbranch_scc0 L_fb1_4
s_mov_b32 s83, 1052672
buffer_load_dwordx4 v[16:19], v248, s[20:23], s83 offen sc1
L_fb1_4:
s_bitcmp1_b32 s82, 5
s_cbranch_scc0 L_fb1_5
s_mov_b32 s83, 1053696
buffer_load_dwordx4 v[20:23], v248, s[20:23], s83 offen sc1
L_fb1_5:
s_bitcmp1_b32 s82, 6
s_cbranch_scc0 L_fb1_6
s_mov_b32 s83, 1054720
buffer_load_dwordx4 v[24:27], v248, s[20:23], s83 offen sc1
L_fb1_6:
s_bitcmp1_b32 s82, 7
s_cbranch_scc0 L_fb1_7
s_mov_b32 s83, 1055744
buffer_load_dwordx4 v[28:31], v248, s[20:23], s83 offen sc1
L_fb1_7:
s_bitcmp1_b32 s82, 8
s_cbranch_scc0 L_fb1_8
s_mov_b32 s83, 1056768
buffer_load_dwordx4 v[32:35], v248, s[20:23], s83 offen sc1
L_fb1_8:
s_bitcmp1_b32 s82, 9
s_cbranch_scc0 L_fb1_9
s_mov_b32 s83, 1057792
buffer_load_dwordx4 v[36:39], v248, s[20:23], s83 offen sc1
L_fb1_9:
s_bitcmp1_b32 s82, 10
s_cbranch_scc0 L_fb1_10
s_mov_b32 s83, 1058816
buffer_load_dwordx4 v[40:43], v248, s[20:23], s83 offen sc1
L_fb1_10:
s_bitcmp1_b32 s82, 11
s_cbranch_scc0 L_fb1_11
s_mov_b32 s83, 1059840
buffer_load_dwordx4 v[44:47], v248, s[20:23], s83 offen sc1
L_fb1_11:
s_bitcmp1_b32 s82, 12
s_cbranch_scc0 L_fb1_12
s_mov_b32 s83, 1060864
buffer_load_dwordx4 v[48:51], v248, s[20:23], s83 offen sc1
L_fb1_12:
s_bitcmp1_b32 s82, 13
s_cbranch_scc0 L_fb1_13
s_mov_b32 s83, 1061888
buffer_load_dwordx4 v[52:55], v248, s[20:23], s83 offen sc1
L_fb1_13:
s_bitcmp1_b32 s82, 14
s_cbranch_scc0 L_fb1_14
s_mov_b32 s83, 1062912
buffer_load_dwordx4 v[56:59], v248, s[20:23], s83 offen sc1
L_fb1_14:
s_bitcmp1_b32 s82, 15
s_cbranch_scc0 L_fb1_15
s_mov_b32 s83, 1063936
buffer_load_dwordx4 v[60:63], v248, s[20:23], s83 offen sc1
L_fb1_15:
s_cmp_eq_u32 s81, -1
s_cbranch_scc1 L_fd1
s_sleep 8
s_sub_u32 s75, s75, 1
s_cbranch_scc0 L_fl1
L_fd1:
v_lshlrev_b32 v232, 16, v244
v_and_b32 v233, s74, v244
v_lshlrev_b32 v234, 16, v245
v_and_b32 v235, s74, v245
v_lshlrev_b32 v236, 16, v246
v_and_b32 v237, s74, v246
v_lshlrev_b32 v238, 16, v247
v_and_b32 v239, s74, v247
s_waitcnt vmcnt(0)
v_mfma_f32_16x16x32_bf16 v[208:211], v[192:195], v[0:3], 0
v_mfma_f32_16x16x32_bf16 v[212:215], v[196:199], v[0:3], 0
v_mfma_f32_16x16x32_bf16 v[208:211], v[192:195], v[4:7], v[208:211]
v_mfma_f32_16x16x32_bf16 v[212:215], v[196:199], v[4:7], v[212:215]
v_mfma_f32_16x16x32_bf16 v[208:211], v[192:195], v[8:11], v[208:211]
v_mfma_f32_16x16x32_bf16 v[212:215], v[196:199], v[8:11], v[212:215]
v_mfma_f32_16x16x32_bf16 v[208:211], v[192:195], v[12:15], v[208:211]
v_mfma_f32_16x16x32_bf16 v[212:215], v[196:199], v[12:15], v[212:215]
v_mfma_f32_16x16x32_bf16 v[208:211], v[192:195], v[16:19], v[208:211]
v_mfma_f32_16x16x32_bf16 v[212:215], v[196:199], v[16:19], v[212:215]
v_mfma_f32_16x16x32_bf16 v[208:211], v[192:195], v[20:23], v[208:211]
v_mfma_f32_16x16x32_bf16 v[212:215], v[196:199], v[20:23], v[212:215]
v_mfma_f32_16x16x32_bf16 v[208:211], v[192:195], v[24:27], v[208:211]
v_mfma_f32_16x16x32_bf16 v[212:215], v[196:199], v[24:27], v[212:215]
v_mfma_f32_16x16x32_bf16 v[208:211], v[192:195], v[28:31], v[208:211]
v_mfma_f32_16x16x32_bf16 v[212:215], v[196:199], v[28:31], v[212:215]
v_mfma_f32_16x16x32_bf16 v[208:211], v[192:195], v[32:35], v[208:211]
v_mfma_f32_16x16x32_bf16 v[212:215], v[196:199], v[32:35], v[212:215]
v_mfma_f32_16x16x32_bf16 v[208:211], v[192:195], v[36:39], v[208:211]
v_mfma_f32_16x16x32_bf16 v[212:215], v[196:199], v[36:39], v[212:215]
v_mfma_f32_16x16x32_bf16 v[208:211], v[192:195], v[40:43], v[208:211]
v_mfma_f32_16x16x32_bf16 v[212:215], v[196:199], v[40:43], v[212:215]
v_mfma_f32_16x16x32_bf16 v[208:211], v[192:195], v[44:47], v[208:211]
v_mfma_f32_16x16x32_bf16 v[212:215], v[196:199], v[44:47], v[212:215]
v_mfma_f32_16x16x32_bf16 v[208:211], v[192:195], v[48:51], v[208:211]
v_mfma_f32_16x16x32_bf16 v[212:215], v[196:199], v[48:51], v[212:215]
v_mfma_f32_16x16x32_bf16 v[208:211], v[192:195], v[52:55], v[208:211]
v_mfma_f32_16x16x32_bf16 v[212:215], v[196:199], v[52:55], v[212:215]
v_mfma_f32_16x16x32_bf16 v[208:211], v[192:195], v[56:59], v[208:211]
v_mfma_f32_16x16x32_bf16 v[212:215], v[196:199], v[56:59], v[212:215]
v_mfma_f32_16x16x32_bf16 v[208:211], v[192:195], v[60:63], v[208:211]
v_mfma_f32_16x16x32_bf16 v[212:215], v[196:199], v[60:63], v[212:215]
s_nop 6
v_cvt_pk_bf16_f32 v224, v208, v209
v_cvt_pk_bf16_f32 v225, v210, v211
v_cvt_pk_bf16_f32 v226, v212, v213
v_cvt_pk_bf16_f32 v227, v214, v215
v_lshlrev_b32 v208, 16, v224
v_and_b32 v209, s74, v224
v_lshlrev_b32 v210, 16, v225
v_and_b32 v211, s74, v225
v_lshlrev_b32 v212, 16, v226
v_and_b32 v213, s74, v226
v_lshlrev_b32 v214, 16, v227
v_and_b32 v215, s74, v227
v_mul_f32 v208, v208, v200
v_mul_f32 v209, v209, v201
v_mul_f32 v210, v210, v202
v_mul_f32 v211, v211, v203
v_mul_f32 v212, v212, v204
v_mul_f32 v213, v213, v205
v_mul_f32 v214, v214, v206
v_mul_f32_e64 v215, v215, v207
v_cvt_pk_bf16_f32 v224, v208, v209
v_cvt_pk_bf16_f32 v225, v210, v211
v_cvt_pk_bf16_f32 v226, v212, v213
v_cvt_pk_bf16_f32 v227, v214, v215
v_lshlrev_b32 v208, 16, v224
v_and_b32 v209, s74, v224
v_lshlrev_b32 v210, 16, v225
v_and_b32 v211, s74, v225
v_lshlrev_b32 v212, 16, v226
v_and_b32 v213, s74, v226
v_lshlrev_b32 v214, 16, v227
v_and_b32 v215, s74, v227
v_add_f32 v208, v208, v232
v_add_f32 v209, v209, v233
v_add_f32 v210, v210, v234
v_add_f32 v211, v211, v235
v_add_f32 v212, v212, v236
v_add_f32 v213, v213, v237
v_add_f32 v214, v214, v238
v_add_f32 v215, v215, v239
v_cvt_pk_bf16_f32 v240, v208, v209
v_cvt_pk_bf16_f32 v241, v210, v211
v_cvt_pk_bf16_f32 v242, v212, v213
v_cvt_pk_bf16_f32 v243, v214, v215
buffer_store_dwordx4 v[240:243], v251, s[28:31], s86 offen offset:512 sc1
L_cdone:
s_endpgm
L_maxpass:
s_waitcnt vmcnt(0) lgkmcnt(0)
v_and_b32 v0, 15, v210
v_lshlrev_b32 v0, 9, v0
v_and_b32_e64 v1, 1, v211
v_lshl_add_u32 v0, v1, 5, v0
v_lshrrev_b32_e64 v1, 1, v211
v_lshl_add_u32 v0, v1, 4, v0
v_mov_b32 v216, 0xff800000
v_mov_b32 v220, 0xff800000
s_mov_b32 s80, 0
L_mp_loop:
buffer_load_dwordx4 v[16:19], v0, s[12:15], s80 offen offset:0
buffer_load_dwordx4 v[20:23], v0, s[12:15], s80 offen offset:64
buffer_load_dwordx4 v[24:27], v0, s[12:15], s80 offen offset:128
buffer_load_dwordx4 v[28:31], v0, s[12:15], s80 offen offset:192
buffer_load_dwordx4 v[32:35], v0, s[12:15], s80 offen offset:256
buffer_load_dwordx4 v[36:39], v0, s[12:15], s80 offen offset:320
buffer_load_dwordx4 v[40:43], v0, s[12:15], s80 offen offset:384
buffer_load_dwordx4 v[44:47], v0, s[12:15], s80 offen offset:448
s_waitcnt vmcnt(0)
v_mfma_f32_16x16x32_bf16 v[8:11], v[16:19], v[128:131], 0
v_mfma_f32_16x16x32_bf16 v[12:15], v[16:19], v[132:135], 0
v_mfma_f32_16x16x32_bf16 v[8:11], v[20:23], v[136:139], v[8:11]
v_mfma_f32_16x16x32_bf16 v[12:15], v[20:23], v[140:143], v[12:15]
v_mfma_f32_16x16x32_bf16 v[8:11], v[24:27], v[144:147], v[8:11]
v_mfma_f32_16x16x32_bf16 v[12:15], v[24:27], v[148:151], v[12:15]
v_mfma_f32_16x16x32_bf16 v[8:11], v[28:31], v[152:155], v[8:11]
v_mfma_f32_16x16x32_bf16 v[12:15], v[28:31], v[156:159], v[12:15]
v_mfma_f32_16x16x32_bf16 v[8:11], v[32:35], v[160:163], v[8:11]
v_mfma_f32_16x16x32_bf16 v[12:15], v[32:35], v[164:167], v[12:15]
v_mfma_f32_16x16x32_bf16 v[8:11], v[36:39], v[168:171], v[8:11]
v_mfma_f32_16x16x32_bf16 v[12:15], v[36:39], v[172:175], v[12:15]
v_mfma_f32_16x16x32_bf16 v[8:11], v[40:43], v[176:179], v[8:11]
v_mfma_f32_16x16x32_bf16 v[12:15], v[40:43], v[180:183], v[12:15]
v_mfma_f32_16x16x32_bf16 v[8:11], v[44:47], v[184:187], v[8:11]
v_mfma_f32_16x16x32_bf16 v[12:15], v[44:47], v[188:191], v[12:15]
s_nop 15
v_max3_f32 v216, v216, v8, v9
v_max3_f32 v216, v216, v10, v11
v_max3_f32 v220, v220, v12, v13
v_max3_f32 v220, v220, v14, v15
s_add_u32 s80, s80, 8192
s_cmp_lt_u32 s80, 1048576
s_cbranch_scc1 L_mp_loop
v_mov_b32 v217, v216
s_nop 1
v_permlane16_swap_b32 v216, v217
v_max_f32 v216, v216, v217
v_mov_b32 v217, v216
s_nop 1
v_permlane32_swap_b32 v216, v217
v_max_f32 v216, v216, v217
v_mov_b32 v221, v220
s_nop 1
v_permlane16_swap_b32 v220, v221
v_max_f32 v220, v220, v221
v_mov_b32 v221, v220
s_nop 1
v_permlane32_swap_b32 v220, v221
v_max_f32 v220, v220, v221
v_sub_f32 v217, 0x0, v216
v_sub_f32 v218, 0x0, v216
v_sub_f32 v219, 0x0, v216
v_sub_f32 v216, 0x0, v216
v_sub_f32 v221, 0x0, v220
v_sub_f32 v222, 0x0, v220
v_sub_f32_e64 v223, 0x0, v220
v_sub_f32 v220, 0x0, v220
L_again:
s_waitcnt vmcnt(0) lgkmcnt(0)
v_mbcnt_lo_u32_b32 v0, -1, 0
v_mbcnt_hi_u32_b32 v0, -1, v0
s_lshl_b32 s7, s5, 6
v_add_u32_e64 v0, s7, v0
s_mov_b32 s79, 1
s_setprio 0
s_barrier
s_branch L_restart
L_helper:
s_setprio 2
ds_read_b64_tr_b16 v[192:193], v226 offset:16896
ds_read_b64_tr_b16 v[194:195], v226 offset:25344
ds_read_b64_tr_b16 v[196:197], v226 offset:16928
ds_read_b64_tr_b16 v[198:199], v226 offset:25376
ds_read_b64_tr_b16 v[200:201], v226 offset:16960
ds_read_b64_tr_b16 v[202:203], v226 offset:25408
ds_read_b64_tr_b16 v[204:205], v226 offset:16992
ds_read_b64_tr_b16 v[206:207], v226 offset:25440
ds_read_b64_tr_b16 v[208:209], v226 offset:17152
ds_read_b64_tr_b16 v[210:211], v226 offset:25600
ds_read_b64_tr_b16 v[212:213], v226 offset:17184
ds_read_b64_tr_b16 v[214:215], v226 offset:25632
s_waitcnt lgkmcnt(12)
s_barrier
s_add_u32 m0, s77, 84480
s_mov_b32 s80, 524288
buffer_load_dwordx4 v245, s[20:23], s80 offen lds
s_addk_i32 m0, 1056
s_addk_i32 s80, 16384
buffer_load_dwordx4 v245, s[20:23], s80 offen lds
s_addk_i32 m0, 7392
s_addk_i32 s80, 16384
buffer_load_dwordx4 v245, s[20:23], s80 offen lds
s_addk_i32 m0, 1056
s_addk_i32 s80, 16384
buffer_load_dwordx4 v245, s[20:23], s80 offen lds
s_waitcnt lgkmcnt(10)
v_mfma_f32_16x16x32_bf16 v[128:131], v[192:195], v[0:3], 0
ds_read_b128 v[64:67], v227 offset:40960
ds_read_b128 v[68:71], v227 offset:41984
s_add_u32 m0, s77, 50688
s_mov_b32 s80, 786432
buffer_load_dwordx4 v245, s[20:23], s80 offen lds
v_mfma_f32_16x16x32_bf16 v[136:139], v[192:195], v[4:7], 0
ds_read_b64_tr_b16 v[192:193], v226 offset:17216
ds_read_b64_tr_b16 v[194:195], v226 offset:25664
s_waitcnt lgkmcnt(12)
v_mfma_f32_16x16x32_bf16 v[140:143], v[196:199], v[4:7], 0
ds_read_b128 v[72:75], v229 offset:32768
ds_read_b128 v[76:79], v229 offset:33792
s_addk_i32 m0, 1056
s_addk_i32 s80, 16384
buffer_load_dwordx4 v245, s[20:23], s80 offen lds
v_mfma_f32_16x16x32_bf16 v[132:135], v[196:199], v[0:3], 0
ds_read_b64_tr_b16 v[196:197], v226 offset:17248
ds_read_b64_tr_b16 v[198:199], v226 offset:25696
s_waitcnt lgkmcnt(14)
v_mfma_f32_16x16x32_bf16 v[144:147], v[200:203], v[0:3], 0
ds_read_b128 v[80:83], v227 offset:24576
ds_read_b128 v[84:87], v227 offset:25600
s_addk_i32 m0, 7392
s_addk_i32 s80, 16384
buffer_load_dwordx4 v245, s[20:23], s80 offen lds
s_waitcnt lgkmcnt(10)
v_mfma_f32_16x16x32_bf16 v[152:155], v[200:203], v[4:7], 0
ds_read_b64_tr_b16 v[200:201], v226 offset:33792
ds_read_b64_tr_b16 v[202:203], v226 offset:42240
v_mfma_f32_16x16x32_bf16 v[156:159], v[204:207], v[4:7], 0
ds_read_b128 v[88:91], v229 offset:16384
ds_read_b128 v[92:95], v229 offset:17408
s_addk_i32 m0, 1056
s_addk_i32 s80, 16384
buffer_load_dwordx4 v245, s[20:23], s80 offen lds
v_mfma_f32_16x16x32_bf16 v[148:151], v[204:207], v[0:3], 0
ds_read_b64_tr_b16 v[204:205], v226 offset:33824
ds_read_b64_tr_b16 v[206:207], v226 offset:42272
v_mfma_f32_16x16x32_bf16 v[160:163], v[208:211], v[0:3], 0
ds_read_b128 v[96:99], v227 offset:8192
ds_read_b128 v[100:103], v227 offset:9216
s_add_u32 m0, s77, 101376
s_mov_b32 s80, 1048576
buffer_load_dwordx4 v245, s[20:23], s80 offen lds
v_mfma_f32_16x16x32_bf16 v[168:171], v[208:211], v[4:7], 0
ds_read_b64_tr_b16 v[208:209], v226 offset:33856
ds_read_b64_tr_b16 v[210:211], v226 offset:42304
v_mfma_f32_16x16x32_bf16 v[172:175], v[212:215], v[4:7], 0
ds_read_b128 v[104:107], v229 offset:0
ds_read_b128 v[108:111], v229 offset:1024
s_addk_i32 m0, 1056
s_addk_i32 s80, 16384
buffer_load_dwordx4 v245, s[20:23], s80 offen lds
s_waitcnt lgkmcnt(10)
v_mfma_f32_16x16x32_bf16 v[164:167], v[212:215], v[0:3], 0
ds_read_b64_tr_b16 v[212:213], v226 offset:33888
ds_read_b64_tr_b16 v[214:215], v226 offset:42336
v_mfma_f32_16x16x32_bf16 v[176:179], v[192:195], v[0:3], 0
s_addk_i32 m0, 7392
s_addk_i32 s80, 16384
buffer_load_dwordx4 v245, s[20:23], s80 offen lds
v_mfma_f32_16x16x32_bf16 v[184:187], v[192:195], v[4:7], 0
ds_read_b64_tr_b16 v[192:193], v226 offset:34048
ds_read_b64_tr_b16 v[194:195], v226 offset:42496
v_mfma_f32_16x16x32_bf16 v[188:191], v[196:199], v[4:7], 0
s_addk_i32 m0, 1056
s_addk_i32 s80, 16384
buffer_load_dwordx4 v245, s[20:23], s80 offen lds
v_mfma_f32_16x16x32_bf16 v[180:183], v[196:199], v[0:3], 0
ds_read_b64_tr_b16 v[196:197], v226 offset:34080
ds_read_b64_tr_b16 v[198:199], v226 offset:42528
v_mfma_f32_16x16x32_bf16 v[128:131], v[200:203], v[8:11], v[128:131]
s_add_u32 m0, s77, 67584
s_mov_b32 s80, 1310720
buffer_load_dwordx4 v245, s[20:23], s80 offen lds
s_waitcnt lgkmcnt(4)
v_mfma_f32_16x16x32_bf16 v[136:139], v[200:203], v[12:15], v[136:139]
ds_read_b64_tr_b16 v[200:201], v226 offset:34112
ds_read_b64_tr_b16 v[202:203], v226 offset:42560
v_mfma_f32_16x16x32_bf16 v[140:143], v[204:207], v[12:15], v[140:143]
s_addk_i32 m0, 1056
s_addk_i32 s80, 16384
buffer_load_dwordx4 v245, s[20:23], s80 offen lds
v_mfma_f32_16x16x32_bf16 v[132:135], v[204:207], v[8:11], v[132:135]
ds_read_b64_tr_b16 v[204:205], v226 offset:34144
ds_read_b64_tr_b16 v[206:207], v226 offset:42592
v_mfma_f32_16x16x32_bf16 v[144:147], v[208:211], v[8:11], v[144:147]
s_addk_i32 m0, 7392
s_addk_i32 s80, 16384
buffer_load_dwordx4 v245, s[20:23], s80 offen lds
v_mfma_f32_16x16x32_bf16 v[152:155], v[208:211], v[12:15], v[152:155]
s_waitcnt vmcnt(7)
s_barrier
ds_read_b64_tr_b16 v[208:209], v225 offset:33792
ds_read_b64_tr_b16 v[210:211], v225 offset:42240
v_mfma_f32_16x16x32_bf16 v[156:159], v[212:215], v[12:15], v[156:159]
s_addk_i32 m0, 1056
s_addk_i32 s80, 16384
buffer_load_dwordx4 v245, s[20:23], s80 offen lds
s_waitcnt lgkmcnt(4)
v_mfma_f32_16x16x32_bf16 v[148:151], v[212:215], v[8:11], v[148:151]
ds_read_b64_tr_b16 v[212:213], v225 offset:33824
ds_read_b64_tr_b16 v[214:215], v225 offset:42272
v_mfma_f32_16x16x32_bf16 v[160:163], v[192:195], v[8:11], v[160:163]
s_add_u32 m0, s77, 0
s_mov_b32 s80, 1572864
buffer_load_dwordx4 v245, s[20:23], s80 offen lds
v_mfma_f32_16x16x32_bf16 v[168:171], v[192:195], v[12:15], v[168:171]
ds_read_b64_tr_b16 v[192:193], v225 offset:33856
ds_read_b64_tr_b16 v[194:195], v225 offset:42304
v_mfma_f32_16x16x32_bf16 v[172:175], v[196:199], v[12:15], v[172:175]
s_addk_i32 m0, 1056
s_addk_i32 s80, 16384
buffer_load_dwordx4 v245, s[20:23], s80 offen lds
v_mfma_f32_16x16x32_bf16 v[164:167], v[196:199], v[8:11], v[164:167]
ds_read_b64_tr_b16 v[196:197], v225 offset:33888
ds_read_b64_tr_b16 v[198:199], v225 offset:42336
v_mfma_f32_16x16x32_bf16 v[176:179], v[200:203], v[8:11], v[176:179]
s_addk_i32 m0, 7392
s_addk_i32 s80, 16384
buffer_load_dwordx4 v245, s[20:23], s80 offen lds
s_waitcnt lgkmcnt(4)
v_mfma_f32_16x16x32_bf16 v[184:187], v[200:203], v[12:15], v[184:187]
ds_read_b64_tr_b16 v[200:201], v225 offset:34048
ds_read_b64_tr_b16 v[202:203], v225 offset:42496
v_mfma_f32_16x16x32_bf16 v[188:191], v[204:207], v[12:15], v[188:191]
s_addk_i32 m0, 1056
s_addk_i32 s80, 16384
buffer_load_dwordx4 v245, s[20:23], s80 offen lds
v_mfma_f32_16x16x32_bf16 v[180:183], v[204:207], v[8:11], v[180:183]
ds_read_b64_tr_b16 v[204:205], v225 offset:34080
ds_read_b64_tr_b16 v[206:207], v225 offset:42528
v_mfma_f32_16x16x32_bf16 v[128:131], v[208:211], v[16:19], v[128:131]
s_add_u32 m0, s77, 16896
s_mov_b32 s80, 1835008
buffer_load_dwordx4 v245, s[20:23], s80 offen lds
v_mfma_f32_16x16x32_bf16 v[136:139], v[208:211], v[20:23], v[136:139]
ds_read_b64_tr_b16 v[208:209], v225 offset:34112
ds_read_b64_tr_b16 v[210:211], v225 offset:42560
v_mfma_f32_16x16x32_bf16 v[140:143], v[212:215], v[20:23], v[140:143]
s_addk_i32 m0, 1056
s_addk_i32 s80, 16384
buffer_load_dwordx4 v245, s[20:23], s80 offen lds
s_waitcnt lgkmcnt(4)
v_mfma_f32_16x16x32_bf16 v[132:135], v[212:215], v[16:19], v[132:135]
ds_read_b64_tr_b16 v[212:213], v225 offset:34144
ds_read_b64_tr_b16 v[214:215], v225 offset:42592
v_mfma_f32_16x16x32_bf16 v[144:147], v[192:195], v[16:19], v[144:147]
s_addk_i32 m0, 7392
s_addk_i32 s80, 16384
buffer_load_dwordx4 v245, s[20:23], s80 offen lds
v_mfma_f32_16x16x32_bf16 v[152:155], v[192:195], v[20:23], v[152:155]
ds_read_b64_tr_b16 v[192:193], v225 offset:0
ds_read_b64_tr_b16 v[194:195], v225 offset:8448
v_mfma_f32_16x16x32_bf16 v[156:159], v[196:199], v[20:23], v[156:159]
s_addk_i32 m0, 1056
s_addk_i32 s80, 16384
buffer_load_dwordx4 v245, s[20:23], s80 offen lds
v_mfma_f32_16x16x32_bf16 v[148:151], v[196:199], v[16:19], v[148:151]
ds_read_b64_tr_b16 v[196:197], v225 offset:32
ds_read_b64_tr_b16 v[198:199], v225 offset:8480
v_mfma_f32_16x16x32_bf16 v[160:163], v[200:203], v[16:19], v[160:163]
s_add_u32 m0, s77, 33792
s_mov_b32 s80, 2097152
buffer_load_dwordx4 v245, s[20:23], s80 offen lds
s_waitcnt lgkmcnt(4)
v_mfma_f32_16x16x32_bf16 v[168:171], v[200:203], v[20:23], v[168:171]
ds_read_b64_tr_b16 v[200:201], v225 offset:64
ds_read_b64_tr_b16 v[202:203], v225 offset:8512
v_mfma_f32_16x16x32_bf16 v[172:175], v[204:207], v[20:23], v[172:175]
s_addk_i32 m0, 1056
s_addk_i32 s80, 16384
buffer_load_dwordx4 v245, s[20:23], s80 offen lds
v_mfma_f32_16x16x32_bf16 v[164:167], v[204:207], v[16:19], v[164:167]
ds_read_b64_tr_b16 v[204:205], v225 offset:96
ds_read_b64_tr_b16 v[206:207], v225 offset:8544
v_mfma_f32_16x16x32_bf16 v[176:179], v[208:211], v[16:19], v[176:179]
s_addk_i32 m0, 7392
s_addk_i32 s80, 16384
buffer_load_dwordx4 v245, s[20:23], s80 offen lds
v_mfma_f32_16x16x32_bf16 v[184:187], v[208:211], v[20:23], v[184:187]
ds_read_b64_tr_b16 v[208:209], v225 offset:256
ds_read_b64_tr_b16 v[210:211], v225 offset:8704
v_mfma_f32_16x16x32_bf16 v[188:191], v[212:215], v[20:23], v[188:191]
s_addk_i32 m0, 1056
s_addk_i32 s80, 16384
buffer_load_dwordx4 v245, s[20:23], s80 offen lds
s_waitcnt lgkmcnt(4)
v_mfma_f32_16x16x32_bf16 v[180:183], v[212:215], v[16:19], v[180:183]
ds_read_b64_tr_b16 v[212:213], v225 offset:288
ds_read_b64_tr_b16 v[214:215], v225 offset:8736
v_mfma_f32_16x16x32_bf16 v[128:131], v[192:195], v[24:27], v[128:131]
s_add_u32 m0, s77, 118272
s_mov_b32 s80, 2359296
buffer_load_dwordx4 v245, s[20:23], s80 offen lds
v_mfma_f32_16x16x32_bf16 v[136:139], v[192:195], v[28:31], v[136:139]
ds_read_b64_tr_b16 v[192:193], v225 offset:320
ds_read_b64_tr_b16 v[194:195], v225 offset:8768
v_mfma_f32_16x16x32_bf16 v[140:143], v[196:199], v[28:31], v[140:143]
s_addk_i32 m0, 1056
s_addk_i32 s80, 16384
buffer_load_dwordx4 v245, s[20:23], s80 offen lds
v_mfma_f32_16x16x32_bf16 v[132:135], v[196:199], v[24:27], v[132:135]
ds_read_b64_tr_b16 v[196:197], v225 offset:352
ds_read_b64_tr_b16 v[198:199], v225 offset:8800
v_mfma_f32_16x16x32_bf16 v[144:147], v[200:203], v[24:27], v[144:147]
s_addk_i32 m0, 7392
s_addk_i32 s80, 16384
buffer_load_dwordx4 v245, s[20:23], s80 offen lds
s_waitcnt lgkmcnt(4)
v_mfma_f32_16x16x32_bf16 v[152:155], v[200:203], v[28:31], v[152:155]
s_waitcnt vmcnt(15)
s_barrier
ds_read_b64_tr_b16 v[200:201], v226 offset:0
ds_read_b64_tr_b16 v[202:203], v226 offset:8448
v_mfma_f32_16x16x32_bf16 v[156:159], v[204:207], v[28:31], v[156:159]
s_addk_i32 m0, 1056
s_addk_i32 s80, 16384
buffer_load_dwordx4 v245, s[20:23], s80 offen lds
v_mfma_f32_16x16x32_bf16 v[148:151], v[204:207], v[24:27], v[148:151]
ds_read_b64_tr_b16 v[204:205], v226 offset:32
ds_read_b64_tr_b16 v[206:207], v226 offset:8480
v_mfma_f32_16x16x32_bf16 v[160:163], v[208:211], v[24:27], v[160:163]
s_add_u32 m0, s77, 135168
s_mov_b32 s80, 2621440
buffer_load_dwordx4 v245, s[20:23], s80 offen lds
v_mfma_f32_16x16x32_bf16 v[168:171], v[208:211], v[28:31], v[168:171]
ds_read_b64_tr_b16 v[208:209], v226 offset:64
ds_read_b64_tr_b16 v[210:211], v226 offset:8512
v_mfma_f32_16x16x32_bf16 v[172:175], v[212:215], v[28:31], v[172:175]
s_addk_i32 m0, 1056
s_addk_i32 s80, 16384
buffer_load_dwordx4 v245, s[20:23], s80 offen lds
s_waitcnt lgkmcnt(4)
v_mfma_f32_16x16x32_bf16 v[164:167], v[212:215], v[24:27], v[164:167]
ds_read_b64_tr_b16 v[212:213], v226 offset:96
ds_read_b64_tr_b16 v[214:215], v226 offset:8544
v_mfma_f32_16x16x32_bf16 v[176:179], v[192:195], v[24:27], v[176:179]
s_addk_i32 m0, 7392
s_addk_i32 s80, 16384
buffer_load_dwordx4 v245, s[20:23], s80 offen lds
v_mfma_f32_16x16x32_bf16 v[184:187], v[192:195], v[28:31], v[184:187]
ds_read_b64_tr_b16 v[192:193], v226 offset:256
ds_read_b64_tr_b16 v[194:195], v226 offset:8704
v_mfma_f32_16x16x32_bf16 v[188:191], v[196:199], v[28:31], v[188:191]
s_addk_i32 m0, 1056
s_addk_i32 s80, 16384
buffer_load_dwordx4 v245, s[20:23], s80 offen lds
v_mfma_f32_16x16x32_bf16 v[180:183], v[196:199], v[24:27], v[180:183]
ds_read_b64_tr_b16 v[196:197], v226 offset:288
ds_read_b64_tr_b16 v[198:199], v226 offset:8736
v_mfma_f32_16x16x32_bf16 v[128:131], v[200:203], v[32:35], v[128:131]
s_add_u32 m0, s77, 84480
s_mov_b32 s80, 2883584
buffer_load_dwordx4 v245, s[20:23], s80 offen lds
s_waitcnt lgkmcnt(4)
v_mfma_f32_16x16x32_bf16 v[136:139], v[200:203], v[36:39], v[136:139]
ds_read_b64_tr_b16 v[200:201], v226 offset:320
ds_read_b64_tr_b16 v[202:203], v226 offset:8768
v_mfma_f32_16x16x32_bf16 v[140:143], v[204:207], v[36:39], v[140:143]
s_addk_i32 m0, 1056
s_addk_i32 s80, 16384
buffer_load_dwordx4 v245, s[20:23], s80 offen lds
v_mfma_f32_16x16x32_bf16 v[132:135], v[204:207], v[32:35], v[132:135]
ds_read_b64_tr_b16 v[204:205], v226 offset:352
ds_read_b64_tr_b16 v[206:207], v226 offset:8800
v_mfma_f32_16x16x32_bf16 v[144:147], v[208:211], v[32:35], v[144:147]
s_addk_i32 m0, 7392
s_addk_i32 s80, 16384
buffer_load_dwordx4 v245, s[20:23], s80 offen lds
v_mfma_f32_16x16x32_bf16 v[152:155], v[208:211], v[36:39], v[152:155]
ds_read_b64_tr_b16 v[208:209], v225 offset:16896
ds_read_b64_tr_b16 v[210:211], v225 offset:25344
v_mfma_f32_16x16x32_bf16 v[156:159], v[212:215], v[36:39], v[156:159]
s_addk_i32 m0, 1056
s_addk_i32 s80, 16384
buffer_load_dwordx4 v245, s[20:23], s80 offen lds
s_waitcnt lgkmcnt(4)
v_mfma_f32_16x16x32_bf16 v[148:151], v[212:215], v[32:35], v[148:151]
ds_read_b64_tr_b16 v[212:213], v225 offset:16928
ds_read_b64_tr_b16 v[214:215], v225 offset:25376
v_mfma_f32_16x16x32_bf16 v[160:163], v[192:195], v[32:35], v[160:163]
v_mfma_f32_16x16x32_bf16 v[168:171], v[192:195], v[36:39], v[168:171]
ds_read_b64_tr_b16 v[192:193], v225 offset:16960
ds_read_b64_tr_b16 v[194:195], v225 offset:25408
v_mfma_f32_16x16x32_bf16 v[172:175], v[196:199], v[36:39], v[172:175]
v_mfma_f32_16x16x32_bf16 v[164:167], v[196:199], v[32:35], v[164:167]
ds_read_b64_tr_b16 v[196:197], v225 offset:16992
ds_read_b64_tr_b16 v[198:199], v225 offset:25440
v_mfma_f32_16x16x32_bf16 v[176:179], v[200:203], v[32:35], v[176:179]
s_waitcnt lgkmcnt(4)
s_nop 0
v_mfma_f32_16x16x32_bf16 v[184:187], v[200:203], v[36:39], v[184:187]
ds_read_b64_tr_b16 v[200:201], v225 offset:17152
ds_read_b64_tr_b16 v[202:203], v225 offset:25600
v_mfma_f32_16x16x32_bf16 v[188:191], v[204:207], v[36:39], v[188:191]
v_mfma_f32_16x16x32_bf16 v[180:183], v[204:207], v[32:35], v[180:183]
ds_read_b64_tr_b16 v[204:205], v225 offset:17184
ds_read_b64_tr_b16 v[206:207], v225 offset:25632
v_mfma_f32_16x16x32_bf16 v[128:131], v[208:211], v[40:43], v[128:131]
v_mfma_f32_16x16x32_bf16 v[136:139], v[208:211], v[44:47], v[136:139]
ds_read_b64_tr_b16 v[208:209], v225 offset:17216
ds_read_b64_tr_b16 v[210:211], v225 offset:25664
v_mfma_f32_16x16x32_bf16 v[140:143], v[212:215], v[44:47], v[140:143]
s_waitcnt lgkmcnt(4)
s_nop 0
v_mfma_f32_16x16x32_bf16 v[132:135], v[212:215], v[40:43], v[132:135]
ds_read_b64_tr_b16 v[212:213], v225 offset:17248
ds_read_b64_tr_b16 v[214:215], v225 offset:25696
v_mfma_f32_16x16x32_bf16 v[144:147], v[192:195], v[40:43], v[144:147]
v_mfma_f32_16x16x32_bf16 v[152:155], v[192:195], v[44:47], v[152:155]
s_waitcnt vmcnt(16)
s_barrier
ds_read_b64_tr_b16 v[192:193], v224 offset:0
ds_read_b64_tr_b16 v[194:195], v224 offset:8448
v_mfma_f32_16x16x32_bf16 v[156:159], v[196:199], v[44:47], v[156:159]
s_add_u32 m0, s77, 50688
s_mov_b32 s80, 3145728
buffer_load_dwordx4 v245, s[20:23], s80 offen lds
v_mfma_f32_16x16x32_bf16 v[148:151], v[196:199], v[40:43], v[148:151]
ds_read_b64_tr_b16 v[196:197], v224 offset:32
ds_read_b64_tr_b16 v[198:199], v224 offset:8480
v_mfma_f32_16x16x32_bf16 v[160:163], v[200:203], v[40:43], v[160:163]
s_addk_i32 m0, 1056
s_addk_i32 s80, 16384
buffer_load_dwordx4 v245, s[20:23], s80 offen lds
s_waitcnt lgkmcnt(4)
v_mfma_f32_16x16x32_bf16 v[168:171], v[200:203], v[44:47], v[168:171]
ds_read_b64_tr_b16 v[200:201], v224 offset:64
ds_read_b64_tr_b16 v[202:203], v224 offset:8512
v_mfma_f32_16x16x32_bf16 v[172:175], v[204:207], v[44:47], v[172:175]
s_addk_i32 m0, 7392
s_addk_i32 s80, 16384
buffer_load_dwordx4 v245, s[20:23], s80 offen lds
v_mfma_f32_16x16x32_bf16 v[164:167], v[204:207], v[40:43], v[164:167]
ds_read_b64_tr_b16 v[204:205], v224 offset:96
ds_read_b64_tr_b16 v[206:207], v224 offset:8544
v_mfma_f32_16x16x32_bf16 v[176:179], v[208:211], v[40:43], v[176:179]
s_addk_i32 m0, 1056
s_addk_i32 s80, 16384
buffer_load_dwordx4 v245, s[20:23], s80 offen lds
v_mfma_f32_16x16x32_bf16 v[184:187], v[208:211], v[44:47], v[184:187]
ds_read_b64_tr_b16 v[208:209], v224 offset:256
ds_read_b64_tr_b16 v[210:211], v224 offset:8704
v_mfma_f32_16x16x32_bf16 v[188:191], v[212:215], v[44:47], v[188:191]
s_add_u32 m0, s77, 101376
s_mov_b32 s80, 3407872
buffer_load_dwordx4 v245, s[20:23], s80 offen lds
s_waitcnt lgkmcnt(4)
v_mfma_f32_16x16x32_bf16 v[180:183], v[212:215], v[40:43], v[180:183]
ds_read_b64_tr_b16 v[212:213], v224 offset:288
ds_read_b64_tr_b16 v[214:215], v224 offset:8736
v_mfma_f32_16x16x32_bf16 v[128:131], v[192:195], v[48:51], v[128:131]
s_addk_i32 m0, 1056
s_addk_i32 s80, 16384
buffer_load_dwordx4 v245, s[20:23], s80 offen lds
v_mfma_f32_16x16x32_bf16 v[136:139], v[192:195], v[52:55], v[136:139]
ds_read_b64_tr_b16 v[192:193], v224 offset:320
ds_read_b64_tr_b16 v[194:195], v224 offset:8768
v_mfma_f32_16x16x32_bf16 v[140:143], v[196:199], v[52:55], v[140:143]
s_addk_i32 m0, 7392
s_addk_i32 s80, 16384
buffer_load_dwordx4 v245, s[20:23], s80 offen lds
v_mfma_f32_16x16x32_bf16 v[132:135], v[196:199], v[48:51], v[132:135]
ds_read_b64_tr_b16 v[196:197], v224 offset:352
ds_read_b64_tr_b16 v[198:199], v224 offset:8800
v_mfma_f32_16x16x32_bf16 v[144:147], v[200:203], v[48:51], v[144:147]
s_addk_i32 m0, 1056
s_addk_i32 s80, 16384
buffer_load_dwordx4 v245, s[20:23], s80 offen lds
s_waitcnt lgkmcnt(4)
v_mfma_f32_16x16x32_bf16 v[152:155], v[200:203], v[52:55], v[152:155]
ds_read_b64_tr_b16 v[200:201], v224 offset:16896
ds_read_b64_tr_b16 v[202:203], v224 offset:25344
v_mfma_f32_16x16x32_bf16 v[156:159], v[204:207], v[52:55], v[156:159]
s_nop 0
v_mfma_f32_16x16x32_bf16 v[148:151], v[204:207], v[48:51], v[148:151]
ds_read_b64_tr_b16 v[204:205], v224 offset:16928
ds_read_b64_tr_b16 v[206:207], v224 offset:25376
v_mfma_f32_16x16x32_bf16 v[160:163], v[208:211], v[48:51], v[160:163]
v_mfma_f32_16x16x32_bf16 v[168:171], v[208:211], v[52:55], v[168:171]
ds_read_b64_tr_b16 v[208:209], v224 offset:16960
ds_read_b64_tr_b16 v[210:211], v224 offset:25408
v_mfma_f32_16x16x32_bf16 v[172:175], v[212:215], v[52:55], v[172:175]
s_waitcnt lgkmcnt(4)
s_nop 0
v_mfma_f32_16x16x32_bf16 v[164:167], v[212:215], v[48:51], v[164:167]
ds_read_b64_tr_b16 v[212:213], v224 offset:16992
ds_read_b64_tr_b16 v[214:215], v224 offset:25440
v_mfma_f32_16x16x32_bf16 v[176:179], v[192:195], v[48:51], v[176:179]
v_mfma_f32_16x16x32_bf16 v[184:187], v[192:195], v[52:55], v[184:187]
ds_read_b64_tr_b16 v[192:193], v224 offset:17152
ds_read_b64_tr_b16 v[194:195], v224 offset:25600
v_mfma_f32_16x16x32_bf16 v[188:191], v[196:199], v[52:55], v[188:191]
v_mfma_f32_16x16x32_bf16 v[180:183], v[196:199], v[48:51], v[180:183]
ds_read_b64_tr_b16 v[196:197], v224 offset:17184
ds_read_b64_tr_b16 v[198:199], v224 offset:25632
v_mfma_f32_16x16x32_bf16 v[128:131], v[200:203], v[56:59], v[128:131]
s_waitcnt lgkmcnt(4)
s_nop 0
v_mfma_f32_16x16x32_bf16 v[136:139], v[200:203], v[60:63], v[136:139]
ds_read_b64_tr_b16 v[200:201], v224 offset:17216
ds_read_b64_tr_b16 v[202:203], v224 offset:25664
v_mfma_f32_16x16x32_bf16 v[140:143], v[204:207], v[60:63], v[140:143]
v_mfma_f32_16x16x32_bf16 v[132:135], v[204:207], v[56:59], v[132:135]
ds_read_b64_tr_b16 v[204:205], v224 offset:17248
ds_read_b64_tr_b16 v[206:207], v224 offset:25696
v_mfma_f32_16x16x32_bf16 v[144:147], v[208:211], v[56:59], v[144:147]
v_mfma_f32_16x16x32_bf16 v[152:155], v[208:211], v[60:63], v[152:155]
s_waitcnt vmcnt(16)
s_barrier
ds_read_b64_tr_b16 v[208:209], v224 offset:33792
ds_read_b64_tr_b16 v[210:211], v224 offset:42240
v_mfma_f32_16x16x32_bf16 v[156:159], v[212:215], v[60:63], v[156:159]
s_add_u32 m0, s76, 0
s_addk_i32 s96, 8192
buffer_load_dwordx4 v240, s[12:15], s96 offen lds
s_waitcnt lgkmcnt(4)
v_mfma_f32_16x16x32_bf16 v[148:151], v[212:215], v[56:59], v[148:151]
ds_read_b64_tr_b16 v[212:213], v224 offset:33824
ds_read_b64_tr_b16 v[214:215], v224 offset:42272
v_mfma_f32_16x16x32_bf16 v[160:163], v[192:195], v[56:59], v[160:163]
s_addk_i32 m0, 32
s_nop 0
buffer_load_dwordx4 v240, s[12:15], s96 offen offset:1024 lds
v_mfma_f32_16x16x32_bf16 v[168:171], v[192:195], v[60:63], v[168:171]
ds_read_b64_tr_b16 v[192:193], v224 offset:33856
ds_read_b64_tr_b16 v[194:195], v224 offset:42304
v_mfma_f32_16x16x32_bf16 v[172:175], v[196:199], v[60:63], v[172:175]
s_addk_i32 m0, 8416
s_addk_i32 s96, 8192
buffer_load_dwordx4 v240, s[12:15], s96 offen lds
v_mfma_f32_16x16x32_bf16 v[164:167], v[196:199], v[56:59], v[164:167]
ds_read_b64_tr_b16 v[196:197], v224 offset:33888
ds_read_b64_tr_b16 v[198:199], v224 offset:42336
v_mfma_f32_16x16x32_bf16 v[176:179], v[200:203], v[56:59], v[176:179]
s_addk_i32 m0, 32
s_nop 0
buffer_load_dwordx4 v240, s[12:15], s96 offen offset:1024 lds
s_waitcnt lgkmcnt(4)
v_mfma_f32_16x16x32_bf16 v[184:187], v[200:203], v[60:63], v[184:187]
ds_read_b64_tr_b16 v[200:201], v224 offset:34048
ds_read_b64_tr_b16 v[202:203], v224 offset:42496
v_mfma_f32_16x16x32_bf16 v[188:191], v[204:207], v[60:63], v[188:191]
s_add_u32 m0, s77, 67584
s_addk_i32 s97, 8192
buffer_load_dwordx4 v240, s[16:19], s97 offen lds
v_mfma_f32_16x16x32_bf16 v[180:183], v[204:207], v[56:59], v[180:183]
ds_read_b64_tr_b16 v[204:205], v224 offset:34080
ds_read_b64_tr_b16 v[206:207], v224 offset:42528
v_mfma_f32_16x16x32_bf16 v[128:131], v[208:211], v[64:67], v[128:131]
s_addk_i32 m0, 32
s_nop 0
buffer_load_dwordx4 v240, s[16:19], s97 offen offset:1024 lds
v_mfma_f32_16x16x32_bf16 v[136:139], v[208:211], v[68:71], v[136:139]
ds_read_b64_tr_b16 v[208:209], v224 offset:34112
ds_read_b64_tr_b16 v[210:211], v224 offset:42560
v_mfma_f32_16x16x32_bf16 v[140:143], v[212:215], v[68:71], v[140:143]
s_addk_i32 m0, 8416
s_addk_i32 s97, 8192
buffer_load_dwordx4 v240, s[16:19], s97 offen lds
s_waitcnt lgkmcnt(4)
v_mfma_f32_16x16x32_bf16 v[132:135], v[212:215], v[64:67], v[132:135]
ds_read_b64_tr_b16 v[212:213], v224 offset:34144
ds_read_b64_tr_b16 v[214:215], v224 offset:42592
v_mfma_f32_16x16x32_bf16 v[144:147], v[192:195], v[64:67], v[144:147]
s_addk_i32 m0, 32
s_nop 0
buffer_load_dwordx4 v240, s[16:19], s97 offen offset:1024 lds
v_mfma_f32_16x16x32_bf16 v[152:155], v[192:195], v[68:71], v[152:155]
ds_read_b64_tr_b16 v[192:193], v226 offset:16896
ds_read_b64_tr_b16 v[194:195], v226 offset:25344
v_mfma_f32_16x16x32_bf16 v[156:159], v[196:199], v[68:71], v[156:159]
v_mfma_f32_16x16x32_bf16 v[148:151], v[196:199], v[64:67], v[148:151]
ds_read_b64_tr_b16 v[196:197], v226 offset:16928
ds_read_b64_tr_b16 v[198:199], v226 offset:25376
v_mfma_f32_16x16x32_bf16 v[160:163], v[200:203], v[64:67], v[160:163]
s_waitcnt lgkmcnt(4)
s_nop 0
v_mfma_f32_16x16x32_bf16 v[168:171], v[200:203], v[68:71], v[168:171]
ds_read_b64_tr_b16 v[200:201], v226 offset:16960
ds_read_b64_tr_b16 v[202:203], v226 offset:25408
v_mfma_f32_16x16x32_bf16 v[172:175], v[204:207], v[68:71], v[172:175]
v_mfma_f32_16x16x32_bf16 v[164:167], v[204:207], v[64:67], v[164:167]
ds_read_b64_tr_b16 v[204:205], v226 offset:16992
ds_read_b64_tr_b16 v[206:207], v226 offset:25440
v_mfma_f32_16x16x32_bf16 v[176:179], v[208:211], v[64:67], v[176:179]
v_mfma_f32_16x16x32_bf16 v[184:187], v[208:211], v[68:71], v[184:187]
ds_read_b64_tr_b16 v[208:209], v226 offset:17152
ds_read_b64_tr_b16 v[210:211], v226 offset:25600
v_mfma_f32_16x16x32_bf16 v[188:191], v[212:215], v[68:71], v[188:191]
s_waitcnt lgkmcnt(4)
s_nop 0
v_mfma_f32_16x16x32_bf16 v[180:183], v[212:215], v[64:67], v[180:183]
ds_read_b64_tr_b16 v[212:213], v226 offset:17184
ds_read_b64_tr_b16 v[214:215], v226 offset:25632
v_mfma_f32_16x16x32_bf16 v[128:131], v[192:195], v[72:75], v[128:131]
v_mfma_f32_16x16x32_bf16 v[136:139], v[192:195], v[76:79], v[136:139]
ds_read_b64_tr_b16 v[192:193], v226 offset:17216
ds_read_b64_tr_b16 v[194:195], v226 offset:25664
v_mfma_f32_16x16x32_bf16 v[140:143], v[196:199], v[76:79], v[140:143]
v_mfma_f32_16x16x32_bf16 v[132:135], v[196:199], v[72:75], v[132:135]
ds_read_b64_tr_b16 v[196:197], v226 offset:17248
ds_read_b64_tr_b16 v[198:199], v226 offset:25696
v_mfma_f32_16x16x32_bf16 v[144:147], v[200:203], v[72:75], v[144:147]
s_waitcnt lgkmcnt(4)
s_nop 0
v_mfma_f32_16x16x32_bf16 v[152:155], v[200:203], v[76:79], v[152:155]
s_waitcnt vmcnt(16)
s_barrier
ds_read_b64_tr_b16 v[200:201], v226 offset:33792
ds_read_b64_tr_b16 v[202:203], v226 offset:42240
v_mfma_f32_16x16x32_bf16 v[156:159], v[204:207], v[76:79], v[156:159]
s_add_u32 m0, s76, 16896
s_addk_i32 s96, 8192
buffer_load_dwordx4 v240, s[12:15], s96 offen lds
v_mfma_f32_16x16x32_bf16 v[148:151], v[204:207], v[72:75], v[148:151]
ds_read_b64_tr_b16 v[204:205], v226 offset:33824
ds_read_b64_tr_b16 v[206:207], v226 offset:42272
v_mfma_f32_16x16x32_bf16 v[160:163], v[208:211], v[72:75], v[160:163]
s_addk_i32 m0, 32
s_nop 0
buffer_load_dwordx4 v240, s[12:15], s96 offen offset:1024 lds
v_mfma_f32_16x16x32_bf16 v[168:171], v[208:211], v[76:79], v[168:171]
ds_read_b64_tr_b16 v[208:209], v226 offset:33856
ds_read_b64_tr_b16 v[210:211], v226 offset:42304
v_mfma_f32_16x16x32_bf16 v[172:175], v[212:215], v[76:79], v[172:175]
s_addk_i32 m0, 8416
s_addk_i32 s96, 8192
buffer_load_dwordx4 v240, s[12:15], s96 offen lds
s_waitcnt lgkmcnt(4)
v_mfma_f32_16x16x32_bf16 v[164:167], v[212:215], v[72:75], v[164:167]
ds_read_b64_tr_b16 v[212:213], v226 offset:33888
ds_read_b64_tr_b16 v[214:215], v226 offset:42336
v_mfma_f32_16x16x32_bf16 v[176:179], v[192:195], v[72:75], v[176:179]
s_addk_i32 m0, 32
s_nop 0
buffer_load_dwordx4 v240, s[12:15], s96 offen offset:1024 lds
v_mfma_f32_16x16x32_bf16 v[184:187], v[192:195], v[76:79], v[184:187]
ds_read_b64_tr_b16 v[192:193], v226 offset:34048
ds_read_b64_tr_b16 v[194:195], v226 offset:42496
v_mfma_f32_16x16x32_bf16 v[188:191], v[196:199], v[76:79], v[188:191]
s_add_u32 m0, s76, 33792
s_addk_i32 s96, 8192
buffer_load_dwordx4 v240, s[12:15], s96 offen lds
v_mfma_f32_16x16x32_bf16 v[180:183], v[196:199], v[72:75], v[180:183]
ds_read_b64_tr_b16 v[196:197], v226 offset:34080
ds_read_b64_tr_b16 v[198:199], v226 offset:42528
v_mfma_f32_16x16x32_bf16 v[128:131], v[200:203], v[80:83], v[128:131]
s_addk_i32 m0, 32
s_nop 0
buffer_load_dwordx4 v240, s[12:15], s96 offen offset:1024 lds
s_waitcnt lgkmcnt(4)
v_mfma_f32_16x16x32_bf16 v[136:139], v[200:203], v[84:87], v[136:139]
ds_read_b64_tr_b16 v[200:201], v226 offset:34112
ds_read_b64_tr_b16 v[202:203], v226 offset:42560
v_mfma_f32_16x16x32_bf16 v[140:143], v[204:207], v[84:87], v[140:143]
s_addk_i32 m0, 8416
s_addk_i32 s96, 8192
buffer_load_dwordx4 v240, s[12:15], s96 offen lds
v_mfma_f32_16x16x32_bf16 v[132:135], v[204:207], v[80:83], v[132:135]
ds_read_b64_tr_b16 v[204:205], v226 offset:34144
ds_read_b64_tr_b16 v[206:207], v226 offset:42592
v_mfma_f32_16x16x32_bf16 v[144:147], v[208:211], v[80:83], v[144:147]
s_addk_i32 m0, 32
s_nop 0
buffer_load_dwordx4 v240, s[12:15], s96 offen offset:1024 lds
v_mfma_f32_16x16x32_bf16 v[152:155], v[208:211], v[84:87], v[152:155]
ds_read_b64_tr_b16 v[208:209], v225 offset:33792
ds_read_b64_tr_b16 v[210:211], v225 offset:42240
v_mfma_f32_16x16x32_bf16 v[156:159], v[212:215], v[84:87], v[156:159]
s_waitcnt lgkmcnt(4)
s_nop 0
v_mfma_f32_16x16x32_bf16 v[148:151], v[212:215], v[80:83], v[148:151]
ds_read_b64_tr_b16 v[212:213], v225 offset:33824
ds_read_b64_tr_b16 v[214:215], v225 offset:42272
v_mfma_f32_16x16x32_bf16 v[160:163], v[192:195], v[80:83], v[160:163]
v_mfma_f32_16x16x32_bf16 v[168:171], v[192:195], v[84:87], v[168:171]
ds_read_b64_tr_b16 v[192:193], v225 offset:33856
ds_read_b64_tr_b16 v[194:195], v225 offset:42304
v_mfma_f32_16x16x32_bf16 v[172:175], v[196:199], v[84:87], v[172:175]
v_mfma_f32_16x16x32_bf16 v[164:167], v[196:199], v[80:83], v[164:167]
ds_read_b64_tr_b16 v[196:197], v225 offset:33888
ds_read_b64_tr_b16 v[198:199], v225 offset:42336
v_mfma_f32_16x16x32_bf16 v[176:179], v[200:203], v[80:83], v[176:179]
s_waitcnt lgkmcnt(4)
s_nop 0
v_mfma_f32_16x16x32_bf16 v[184:187], v[200:203], v[84:87], v[184:187]
ds_read_b64_tr_b16 v[200:201], v225 offset:34048
ds_read_b64_tr_b16 v[202:203], v225 offset:42496
v_mfma_f32_16x16x32_bf16 v[188:191], v[204:207], v[84:87], v[188:191]
v_mfma_f32_16x16x32_bf16 v[180:183], v[204:207], v[80:83], v[180:183]
ds_read_b64_tr_b16 v[204:205], v225 offset:34080
ds_read_b64_tr_b16 v[206:207], v225 offset:42528
v_mfma_f32_16x16x32_bf16 v[128:131], v[208:211], v[88:91], v[128:131]
v_mfma_f32_16x16x32_bf16 v[136:139], v[208:211], v[92:95], v[136:139]
ds_read_b64_tr_b16 v[208:209], v225 offset:34112
ds_read_b64_tr_b16 v[210:211], v225 offset:42560
v_mfma_f32_16x16x32_bf16 v[140:143], v[212:215], v[92:95], v[140:143]
s_waitcnt lgkmcnt(4)
s_nop 0
v_mfma_f32_16x16x32_bf16 v[132:135], v[212:215], v[88:91], v[132:135]
ds_read_b64_tr_b16 v[212:213], v225 offset:34144
ds_read_b64_tr_b16 v[214:215], v225 offset:42592
v_mfma_f32_16x16x32_bf16 v[144:147], v[192:195], v[88:91], v[144:147]
v_mfma_f32_16x16x32_bf16 v[152:155], v[192:195], v[92:95], v[152:155]
s_waitcnt vmcnt(12)
s_barrier
ds_read_b64_tr_b16 v[192:193], v225 offset:0
ds_read_b64_tr_b16 v[194:195], v225 offset:8448
v_mfma_f32_16x16x32_bf16 v[156:159], v[196:199], v[92:95], v[156:159]
v_mfma_f32_16x16x32_bf16 v[148:151], v[196:199], v[88:91], v[148:151]
ds_read_b64_tr_b16 v[196:197], v225 offset:32
ds_read_b64_tr_b16 v[198:199], v225 offset:8480
v_mfma_f32_16x16x32_bf16 v[160:163], v[200:203], v[88:91], v[160:163]
s_waitcnt lgkmcnt(4)
s_nop 0
v_mfma_f32_16x16x32_bf16 v[168:171], v[200:203], v[92:95], v[168:171]
ds_read_b64_tr_b16 v[200:201], v225 offset:64
ds_read_b64_tr_b16 v[202:203], v225 offset:8512
v_mfma_f32_16x16x32_bf16 v[172:175], v[204:207], v[92:95], v[172:175]
v_mfma_f32_16x16x32_bf16 v[164:167], v[204:207], v[88:91], v[164:167]
ds_read_b64_tr_b16 v[204:205], v225 offset:96
ds_read_b64_tr_b16 v[206:207], v225 offset:8544
v_mfma_f32_16x16x32_bf16 v[176:179], v[208:211], v[88:91], v[176:179]
v_mfma_f32_16x16x32_bf16 v[184:187], v[208:211], v[92:95], v[184:187]
ds_read_b64_tr_b16 v[208:209], v225 offset:256
ds_read_b64_tr_b16 v[210:211], v225 offset:8704
v_mfma_f32_16x16x32_bf16 v[188:191], v[212:215], v[92:95], v[188:191]
s_waitcnt lgkmcnt(4)
s_nop 0
v_mfma_f32_16x16x32_bf16 v[180:183], v[212:215], v[88:91], v[180:183]
ds_read_b64_tr_b16 v[212:213], v225 offset:288
ds_read_b64_tr_b16 v[214:215], v225 offset:8736
v_mfma_f32_16x16x32_bf16 v[128:131], v[192:195], v[96:99], v[128:131]
v_mfma_f32_16x16x32_bf16 v[136:139], v[192:195], v[100:103], v[136:139]
ds_read_b64_tr_b16 v[192:193], v225 offset:320
ds_read_b64_tr_b16 v[194:195], v225 offset:8768
v_mfma_f32_16x16x32_bf16 v[140:143], v[196:199], v[100:103], v[140:143]
v_mfma_f32_16x16x32_bf16 v[132:135], v[196:199], v[96:99], v[132:135]
ds_read_b64_tr_b16 v[196:197], v225 offset:352
ds_read_b64_tr_b16 v[198:199], v225 offset:8800
v_mfma_f32_16x16x32_bf16 v[144:147], v[200:203], v[96:99], v[144:147]
s_waitcnt lgkmcnt(4)
s_nop 0
v_mfma_f32_16x16x32_bf16 v[152:155], v[200:203], v[100:103], v[152:155]
ds_read_b64_tr_b16 v[200:201], v226 offset:0
ds_read_b64_tr_b16 v[202:203], v226 offset:8448
v_mfma_f32_16x16x32_bf16 v[156:159], v[204:207], v[100:103], v[156:159]
v_mfma_f32_16x16x32_bf16 v[148:151], v[204:207], v[96:99], v[148:151]
ds_read_b64_tr_b16 v[204:205], v226 offset:32
ds_read_b64_tr_b16 v[206:207], v226 offset:8480
v_mfma_f32_16x16x32_bf16 v[160:163], v[208:211], v[96:99], v[160:163]
v_mfma_f32_16x16x32_bf16 v[168:171], v[208:211], v[100:103], v[168:171]
ds_read_b64_tr_b16 v[208:209], v226 offset:64
ds_read_b64_tr_b16 v[210:211], v226 offset:8512
v_mfma_f32_16x16x32_bf16 v[172:175], v[212:215], v[100:103], v[172:175]
s_waitcnt lgkmcnt(4)
s_nop 0
v_mfma_f32_16x16x32_bf16 v[164:167], v[212:215], v[96:99], v[164:167]
ds_read_b64_tr_b16 v[212:213], v226 offset:96
ds_read_b64_tr_b16 v[214:215], v226 offset:8544
v_mfma_f32_16x16x32_bf16 v[176:179], v[192:195], v[96:99], v[176:179]
v_mfma_f32_16x16x32_bf16 v[184:187], v[192:195], v[100:103], v[184:187]
ds_read_b64_tr_b16 v[192:193], v226 offset:256
ds_read_b64_tr_b16 v[194:195], v226 offset:8704
v_mfma_f32_16x16x32_bf16 v[188:191], v[196:199], v[100:103], v[188:191]
v_mfma_f32_16x16x32_bf16 v[180:183], v[196:199], v[96:99], v[180:183]
ds_read_b64_tr_b16 v[196:197], v226 offset:288
ds_read_b64_tr_b16 v[198:199], v226 offset:8736
v_mfma_f32_16x16x32_bf16 v[128:131], v[200:203], v[104:107], v[128:131]
s_waitcnt lgkmcnt(4)
s_nop 0
v_mfma_f32_16x16x32_bf16 v[136:139], v[200:203], v[108:111], v[136:139]
ds_read_b64_tr_b16 v[200:201], v226 offset:320
ds_read_b64_tr_b16 v[202:203], v226 offset:8768
v_mfma_f32_16x16x32_bf16 v[140:143], v[204:207], v[108:111], v[140:143]
v_mfma_f32_16x16x32_bf16 v[132:135], v[204:207], v[104:107], v[132:135]
ds_read_b64_tr_b16 v[204:205], v226 offset:352
ds_read_b64_tr_b16 v[206:207], v226 offset:8800
v_mfma_f32_16x16x32_bf16 v[144:147], v[208:211], v[104:107], v[144:147]
v_mfma_f32_16x16x32_bf16 v[152:155], v[208:211], v[108:111], v[152:155]
v_mfma_f32_16x16x32_bf16 v[156:159], v[212:215], v[108:111], v[156:159]
s_waitcnt lgkmcnt(2)
s_nop 0
v_mfma_f32_16x16x32_bf16 v[148:151], v[212:215], v[104:107], v[148:151]
v_mfma_f32_16x16x32_bf16 v[160:163], v[192:195], v[104:107], v[160:163]
v_mfma_f32_16x16x32_bf16 v[168:171], v[192:195], v[108:111], v[168:171]
v_mfma_f32_16x16x32_bf16 v[172:175], v[196:199], v[108:111], v[172:175]
v_mfma_f32_16x16x32_bf16 v[164:167], v[196:199], v[104:107], v[164:167]
v_mfma_f32_16x16x32_bf16 v[176:179], v[200:203], v[104:107], v[176:179]
s_waitcnt lgkmcnt(0)
s_nop 0
v_mfma_f32_16x16x32_bf16 v[184:187], v[200:203], v[108:111], v[184:187]
v_mfma_f32_16x16x32_bf16 v[188:191], v[204:207], v[108:111], v[188:191]
v_mfma_f32_16x16x32_bf16 v[180:183], v[204:207], v[104:107], v[180:183]
s_lshr_b32 s7, s6, 1
s_mul_i32 s7, s7, 16896
s_and_b32 s83, s6, 1
s_lshl_b32 s83, s83, 13
s_add_u32 s7, s7, s83
s_add_u32 s7, s7, 118272
v_lshlrev_b32 v254, 4, v255
v_add_u32 v254, s7, v254
v_mul_f32 v128, s72, v128
v_mul_f32 v129, s72, v129
v_mul_f32 v130, s72, v130
v_mul_f32 v131, s72, v131
v_mul_f32 v132, s72, v132
v_mul_f32 v133, s72, v133
v_mul_f32 v134, s72, v134
v_mul_f32 v135, s72, v135
v_cvt_pk_bf16_f32 v128, v128, v129
v_cvt_pk_bf16_f32 v129, v130, v131
v_cvt_pk_bf16_f32 v130, v132, v133
v_cvt_pk_bf16_f32 v131, v134, v135
s_nop 0
v_permlane16_swap_b32 v128, v130
v_permlane16_swap_b32 v129, v131
v_mul_f32 v136, s72, v136
v_mul_f32 v137, s72, v137
v_mul_f32 v138, s72, v138
v_mul_f32 v139, s72, v139
v_mul_f32 v140, s72, v140
v_mul_f32 v141, s72, v141
v_mul_f32 v142, s72, v142
v_mul_f32_e64 v143, s72, v143
v_cvt_pk_bf16_f32 v132, v136, v137
v_cvt_pk_bf16_f32 v134, v140, v141
v_cvt_pk_bf16_f32 v133, v138, v139
v_cvt_pk_bf16_f32 v135, v142, v143
v_permlane16_swap_b32 v132, v134
s_nop 0
v_permlane16_swap_b32 v133, v135
ds_write_b128 v254, v[128:131] offset:0
v_mul_f32 v144, s72, v144
v_mul_f32 v145, s72, v145
v_mul_f32 v146, s72, v146
v_mul_f32 v147, s72, v147
v_mul_f32 v148, s72, v148
v_mul_f32 v149, s72, v149
v_mul_f32 v150, s72, v150
v_mul_f32_e64 v151, s72, v151
v_cvt_pk_bf16_f32 v136, v144, v145
v_cvt_pk_bf16_f32 v138, v148, v149
v_cvt_pk_bf16_f32 v137, v146, v147
v_cvt_pk_bf16_f32 v139, v150, v151
v_permlane16_swap_b32 v136, v138
s_nop 0
v_permlane16_swap_b32 v137, v139
ds_write_b128 v254, v[132:135] offset:1024
v_mul_f32 v152, s72, v152
v_mul_f32 v153, s72, v153
v_mul_f32 v154, s72, v154
v_mul_f32 v155, s72, v155
v_mul_f32 v156, s72, v156
v_mul_f32 v157, s72, v157
v_mul_f32 v158, s72, v158
v_mul_f32_e64 v159, s72, v159
v_cvt_pk_bf16_f32 v140, v152, v153
v_cvt_pk_bf16_f32 v142, v156, v157
v_cvt_pk_bf16_f32 v141, v154, v155
v_cvt_pk_bf16_f32 v143, v158, v159
v_permlane16_swap_b32 v140, v142
s_nop 0
v_permlane16_swap_b32 v141, v143
ds_write_b128 v254, v[136:139] offset:2048
v_mul_f32 v160, s72, v160
v_mul_f32 v161, s72, v161
v_mul_f32 v162, s72, v162
v_mul_f32 v163, s72, v163
v_mul_f32 v164, s72, v164
v_mul_f32 v165, s72, v165
v_mul_f32 v166, s72, v166
v_mul_f32_e64 v167, s72, v167
v_cvt_pk_bf16_f32 v144, v160, v161
v_cvt_pk_bf16_f32 v146, v164, v165
v_cvt_pk_bf16_f32 v145, v162, v163
v_cvt_pk_bf16_f32 v147, v166, v167
v_permlane16_swap_b32 v144, v146
s_nop 0
v_permlane16_swap_b32 v145, v147
ds_write_b128 v254, v[140:143] offset:3072
v_mul_f32 v168, s72, v168
v_mul_f32 v169, s72, v169
v_mul_f32 v170, s72, v170
v_mul_f32 v171, s72, v171
v_mul_f32 v172, s72, v172
v_mul_f32 v173, s72, v173
v_mul_f32 v174, s72, v174
v_mul_f32_e64 v175, s72, v175
v_cvt_pk_bf16_f32 v148, v168, v169
v_cvt_pk_bf16_f32 v150, v172, v173
v_cvt_pk_bf16_f32 v149, v170, v171
v_cvt_pk_bf16_f32 v151, v174, v175
v_permlane16_swap_b32 v148, v150
s_nop 0
v_permlane16_swap_b32 v149, v151
ds_write_b128 v254, v[144:147] offset:4096
v_mul_f32 v176, s72, v176
v_mul_f32 v177, s72, v177
v_mul_f32 v178, s72, v178
v_mul_f32 v179, s72, v179
v_mul_f32 v180, s72, v180
v_mul_f32 v181, s72, v181
v_mul_f32 v182, s72, v182
v_mul_f32_e64 v183, s72, v183
v_cvt_pk_bf16_f32 v152, v176, v177
v_cvt_pk_bf16_f32 v154, v180, v181
v_cvt_pk_bf16_f32 v153, v178, v179
v_cvt_pk_bf16_f32 v155, v182, v183
v_permlane16_swap_b32 v152, v154
s_nop 0
v_permlane16_swap_b32 v153, v155
ds_write_b128 v254, v[148:151] offset:5120
v_mul_f32 v184, s72, v184
v_mul_f32 v185, s72, v185
v_mul_f32 v186, s72, v186
v_mul_f32 v187, s72, v187
v_mul_f32 v188, s72, v188
v_mul_f32 v189, s72, v189
v_mul_f32 v190, s72, v190
v_mul_f32_e64 v191, s72, v191
v_cvt_pk_bf16_f32 v156, v184, v185
v_cvt_pk_bf16_f32 v158, v188, v189
v_cvt_pk_bf16_f32 v157, v186, v187
v_cvt_pk_bf16_f32 v159, v190, v191
v_permlane16_swap_b32 v156, v158
s_nop 0
v_permlane16_swap_b32 v157, v159
ds_write_b128 v254, v[152:155] offset:6144
ds_write_b128 v254, v[156:159] offset:7168
s_waitcnt vmcnt(4)
s_waitcnt lgkmcnt(0)
s_barrier
s_add_u32 m0, s77, 84480
s_addk_i32 s97, 8192
buffer_load_dwordx4 v240, s[16:19], s97 offen lds
s_addk_i32 m0, 32
s_nop 0
buffer_load_dwordx4 v240, s[16:19], s97 offen offset:1024 lds
s_addk_i32 m0, 8416
s_addk_i32 s97, 8192
buffer_load_dwordx4 v240, s[16:19], s97 offen lds
s_addk_i32 m0, 32
s_nop 0
buffer_load_dwordx4 v240, s[16:19], s97 offen offset:1024 lds
s_add_u32 m0, s76, 50688
s_addk_i32 s96, 8192
buffer_load_dwordx4 v240, s[12:15], s96 offen lds
s_addk_i32 m0, 32
s_nop 0
buffer_load_dwordx4 v240, s[12:15], s96 offen offset:1024 lds
s_addk_i32 m0, 8416
s_addk_i32 s96, 8192
buffer_load_dwordx4 v240, s[12:15], s96 offen lds
s_addk_i32 m0, 32
s_nop 0
buffer_load_dwordx4 v240, s[12:15], s96 offen offset:1024 lds
s_add_u32 m0, s77, 101376
s_addk_i32 s97, 8192
buffer_load_dwordx4 v240, s[16:19], s97 offen lds
s_addk_i32 m0, 32
s_nop 0
buffer_load_dwordx4 v240, s[16:19], s97 offen offset:1024 lds
s_addk_i32 m0, 8416
s_addk_i32 s97, 8192
buffer_load_dwordx4 v240, s[16:19], s97 offen lds
s_addk_i32 m0, 32
s_nop 0
buffer_load_dwordx4 v240, s[16:19], s97 offen offset:1024 lds
s_mov_b32 s73, 0xbfb8aa3b
s_setprio 0
s_waitcnt vmcnt(12)
s_barrier
s_add_u32 m0, s76, 0
s_addk_i32 s96, 8192
buffer_load_dwordx4 v240, s[12:15], s96 offen lds
s_addk_i32 m0, 32
s_nop 0
buffer_load_dwordx4 v240, s[12:15], s96 offen offset:1024 lds
s_addk_i32 m0, 8416
s_addk_i32 s96, 8192
buffer_load_dwordx4 v240, s[12:15], s96 offen lds
s_addk_i32 m0, 32
s_nop 0
buffer_load_dwordx4 v240, s[12:15], s96 offen offset:1024 lds
s_add_u32 m0, s88, 135168
s_mov_b32 s82, 0
buffer_load_dwordx4 v241, s[28:31], s82 offen lds
s_addk_i32 m0, 1024
s_addk_i32 s82, 14336
buffer_load_dwordx4 v241, s[28:31], s82 offen lds
s_add_u32 m0, s77, 118272
s_addk_i32 s97, 8192
buffer_load_dwordx4 v240, s[16:19], s97 offen lds
s_addk_i32 m0, 32
s_nop 0
buffer_load_dwordx4 v240, s[16:19], s97 offen offset:1024 lds
s_addk_i32 m0, 8416
s_addk_i32 s97, 8192
buffer_load_dwordx4 v240, s[16:19], s97 offen lds
s_addk_i32 m0, 32
s_nop 0
buffer_load_dwordx4 v240, s[16:19], s97 offen offset:1024 lds
s_add_u32 s83, s89, 196608
buffer_load_dword v244, v243, s[44:47], s83 offen
s_waitcnt vmcnt(15)
s_barrier
s_add_u32 m0, s76, 16896
s_addk_i32 s96, 8192
buffer_load_dwordx4 v240, s[12:15], s96 offen lds
s_addk_i32 m0, 32
s_nop 0
buffer_load_dwordx4 v240, s[12:15], s96 offen offset:1024 lds
s_addk_i32 m0, 8416
s_addk_i32 s96, 8192
buffer_load_dwordx4 v240, s[12:15], s96 offen lds
s_addk_i32 m0, 32
s_nop 0
buffer_load_dwordx4 v240, s[12:15], s96 offen offset:1024 lds
s_add_u32 m0, s88, 143360
s_mov_b32 s82, 229376
buffer_load_dwordx4 v241, s[28:31], s82 offen lds
s_addk_i32 m0, 1024
s_addk_i32 s82, 14336
buffer_load_dwordx4 v241, s[28:31], s82 offen lds
s_add_u32 m0, s77, 67584
s_addk_i32 s97, 8192
buffer_load_dwordx4 v240, s[16:19], s97 offen lds
s_addk_i32 m0, 32
s_nop 0
buffer_load_dwordx4 v240, s[16:19], s97 offen offset:1024 lds
s_addk_i32 m0, 8416
s_addk_i32 s97, 8192
buffer_load_dwordx4 v240, s[16:19], s97 offen lds
s_addk_i32 m0, 32
s_nop 0
buffer_load_dwordx4 v240, s[16:19], s97 offen offset:1024 lds
s_waitcnt vmcnt(15)
s_barrier
ds_read_b64_tr_b16 v[176:177], v246 offset:0
ds_read_b64_tr_b16 v[178:179], v246 offset:1024
ds_read_b64_tr_b16 v[180:181], v247 offset:0
ds_read_b64_tr_b16 v[182:183], v247 offset:1024
ds_read_b64_tr_b16 v[184:185], v246 offset:2048
ds_read_b64_tr_b16 v[186:187], v246 offset:3072
ds_read_b64_tr_b16 v[188:189], v247 offset:2048
ds_read_b64_tr_b16 v[190:191], v247 offset:3072
ds_read_b64_tr_b16 v[192:193], v246 offset:4096
ds_read_b64_tr_b16 v[194:195], v246 offset:5120
ds_read_b64_tr_b16 v[196:197], v247 offset:4096
ds_read_b64_tr_b16 v[198:199], v247 offset:5120
ds_read_b64_tr_b16 v[200:201], v246 offset:6144
ds_read_b64_tr_b16 v[202:203], v246 offset:7168
ds_read_b64_tr_b16 v[204:205], v247 offset:6144
ds_read_b64_tr_b16 v[206:207], v247 offset:7168
s_add_u32 m0, s76, 33792
s_addk_i32 s96, 8192
buffer_load_dwordx4 v240, s[12:15], s96 offen lds
s_addk_i32 m0, 32
s_nop 0
buffer_load_dwordx4 v240, s[12:15], s96 offen offset:1024 lds
s_addk_i32 m0, 8416
s_addk_i32 s96, 8192
buffer_load_dwordx4 v240, s[12:15], s96 offen lds
s_addk_i32 m0, 32
s_nop 0
buffer_load_dwordx4 v240, s[12:15], s96 offen offset:1024 lds
s_add_u32 m0, s88, 151552
s_mov_b32 s82, 458752
buffer_load_dwordx4 v241, s[28:31], s82 offen lds
s_addk_i32 m0, 1024
s_addk_i32 s82, 14336
buffer_load_dwordx4 v241, s[28:31], s82 offen lds
s_add_u32 m0, s77, 84480
s_addk_i32 s97, 8192
buffer_load_dwordx4 v240, s[16:19], s97 offen lds
s_addk_i32 m0, 32
s_nop 0
buffer_load_dwordx4 v240, s[16:19], s97 offen offset:1024 lds
s_addk_i32 m0, 8416
s_addk_i32 s97, 8192
buffer_load_dwordx4 v240, s[16:19], s97 offen lds
s_addk_i32 m0, 32
s_nop 0
buffer_load_dwordx4 v240, s[16:19], s97 offen offset:1024 lds
s_add_u32 s83, s89, 262144
buffer_load_dword v244, v243, s[44:47], s83 offen
s_waitcnt vmcnt(15)
s_waitcnt lgkmcnt(0)
s_barrier
s_setprio 2
v_mfma_f32_16x16x32_bf16 v[112:115], v[176:179], v[0:3], 0
v_mfma_f32_16x16x32_bf16 v[120:123], v[176:179], v[4:7], 0
ds_read_b64_tr_b16 v[176:177], v246 offset:8192
ds_read_b64_tr_b16 v[178:179], v246 offset:9216
v_mfma_f32_16x16x32_bf16 v[136:139], v[180:183], v[4:7], 0
v_mfma_f32_16x16x32_bf16 v[128:131], v[180:183], v[0:3], 0
ds_read_b64_tr_b16 v[180:181], v247 offset:8192
ds_read_b64_tr_b16 v[182:183], v247 offset:9216
v_mfma_f32_16x16x32_bf16 v[116:119], v[184:187], v[0:3], 0
v_mfma_f32_16x16x32_bf16 v[124:127], v[184:187], v[4:7], 0
ds_read_b64_tr_b16 v[184:185], v246 offset:10240
ds_read_b64_tr_b16 v[186:187], v246 offset:11264
v_mfma_f32_16x16x32_bf16 v[140:143], v[188:191], v[4:7], 0
v_mfma_f32_16x16x32_bf16 v[132:135], v[188:191], v[0:3], 0
ds_read_b64_tr_b16 v[188:189], v247 offset:10240
ds_read_b64_tr_b16 v[190:191], v247 offset:11264
v_mfma_f32_16x16x32_bf16 v[112:115], v[192:195], v[8:11], v[112:115]
v_mfma_f32_16x16x32_bf16 v[120:123], v[192:195], v[12:15], v[120:123]
ds_read_b64_tr_b16 v[192:193], v246 offset:12288
ds_read_b64_tr_b16 v[194:195], v246 offset:13312
v_mfma_f32_16x16x32_bf16 v[136:139], v[196:199], v[12:15], v[136:139]
v_mfma_f32_16x16x32_bf16 v[128:131], v[196:199], v[8:11], v[128:131]
ds_read_b64_tr_b16 v[196:197], v247 offset:12288
ds_read_b64_tr_b16 v[198:199], v247 offset:13312
v_mfma_f32_16x16x32_bf16 v[116:119], v[200:203], v[8:11], v[116:119]
v_mfma_f32_16x16x32_bf16 v[124:127], v[200:203], v[12:15], v[124:127]
ds_read_b64_tr_b16 v[200:201], v246 offset:14336
ds_read_b64_tr_b16 v[202:203], v246 offset:15360
v_mfma_f32_16x16x32_bf16 v[140:143], v[204:207], v[12:15], v[140:143]
v_mfma_f32_16x16x32_bf16 v[132:135], v[204:207], v[8:11], v[132:135]
ds_read_b64_tr_b16 v[204:205], v247 offset:14336
ds_read_b64_tr_b16 v[206:207], v247 offset:15360
s_setprio 0
s_add_u32 m0, s76, 50688
s_addk_i32 s96, 8192
buffer_load_dwordx4 v240, s[12:15], s96 offen lds
s_addk_i32 m0, 32
s_nop 0
buffer_load_dwordx4 v240, s[12:15], s96 offen offset:1024 lds
s_addk_i32 m0, 8416
s_addk_i32 s96, 8192
buffer_load_dwordx4 v240, s[12:15], s96 offen lds
s_addk_i32 m0, 32
s_nop 0
buffer_load_dwordx4 v240, s[12:15], s96 offen offset:1024 lds
s_add_u32 m0, s88, 135168
s_mov_b32 s82, 688128
buffer_load_dwordx4 v241, s[28:31], s82 offen lds
s_addk_i32 m0, 1024
s_addk_i32 s82, 14336
buffer_load_dwordx4 v241, s[28:31], s82 offen lds
s_add_u32 m0, s77, 101376
s_addk_i32 s97, 8192
buffer_load_dwordx4 v240, s[16:19], s97 offen lds
s_addk_i32 m0, 32
s_nop 0
buffer_load_dwordx4 v240, s[16:19], s97 offen offset:1024 lds
s_addk_i32 m0, 8416
s_addk_i32 s97, 8192
buffer_load_dwordx4 v240, s[16:19], s97 offen lds
s_addk_i32 m0, 32
s_nop 0
buffer_load_dwordx4 v240, s[16:19], s97 offen offset:1024 lds
s_waitcnt vmcnt(15)
s_waitcnt lgkmcnt(0)
s_barrier
s_setprio 2
v_mfma_f32_16x16x32_bf16 v[112:115], v[176:179], v[16:19], v[112:115]
s_nop 0
v_mfma_f32_16x16x32_bf16 v[120:123], v[176:179], v[20:23], v[120:123]
ds_read_b64_tr_b16 v[176:177], v246 offset:16384
ds_read_b64_tr_b16 v[178:179], v246 offset:17408
v_mfma_f32_16x16x32_bf16 v[136:139], v[180:183], v[20:23], v[136:139]
v_mfma_f32_16x16x32_bf16 v[128:131], v[180:183], v[16:19], v[128:131]
ds_read_b64_tr_b16 v[180:181], v247 offset:16384
ds_read_b64_tr_b16 v[182:183], v247 offset:17408
v_mfma_f32_16x16x32_bf16 v[116:119], v[184:187], v[16:19], v[116:119]
v_mfma_f32_16x16x32_bf16 v[124:127], v[184:187], v[20:23], v[124:127]
ds_read_b64_tr_b16 v[184:185], v246 offset:18432
ds_read_b64_tr_b16 v[186:187], v246 offset:19456
v_mfma_f32_16x16x32_bf16 v[140:143], v[188:191], v[20:23], v[140:143]
v_mfma_f32_16x16x32_bf16 v[132:135], v[188:191], v[16:19], v[132:135]
ds_read_b64_tr_b16 v[188:189], v247 offset:18432
ds_read_b64_tr_b16 v[190:191], v247 offset:19456
v_mfma_f32_16x16x32_bf16 v[112:115], v[192:195], v[24:27], v[112:115]
v_mfma_f32_16x16x32_bf16 v[120:123], v[192:195], v[28:31], v[120:123]
ds_read_b64_tr_b16 v[192:193], v246 offset:20480
ds_read_b64_tr_b16 v[194:195], v246 offset:21504
v_mfma_f32_16x16x32_bf16 v[136:139], v[196:199], v[28:31], v[136:139]
v_mfma_f32_16x16x32_bf16 v[128:131], v[196:199], v[24:27], v[128:131]
ds_read_b64_tr_b16 v[196:197], v247 offset:20480
ds_read_b64_tr_b16 v[198:199], v247 offset:21504
v_mfma_f32_16x16x32_bf16 v[116:119], v[200:203], v[24:27], v[116:119]
v_mfma_f32_16x16x32_bf16 v[124:127], v[200:203], v[28:31], v[124:127]
ds_read_b64_tr_b16 v[200:201], v246 offset:22528
ds_read_b64_tr_b16 v[202:203], v246 offset:23552
v_mfma_f32_16x16x32_bf16 v[140:143], v[204:207], v[28:31], v[140:143]
v_mfma_f32_16x16x32_bf16 v[132:135], v[204:207], v[24:27], v[132:135]
ds_read_b64_tr_b16 v[204:205], v247 offset:22528
ds_read_b64_tr_b16 v[206:207], v247 offset:23552
s_setprio 0
s_add_u32 m0, s76, 0
s_addk_i32 s96, 8192
buffer_load_dwordx4 v240, s[12:15], s96 offen lds
s_addk_i32 m0, 32
s_nop 0
buffer_load_dwordx4 v240, s[12:15], s96 offen offset:1024 lds
s_addk_i32 m0, 8416
s_addk_i32 s96, 8192
buffer_load_dwordx4 v240, s[12:15], s96 offen lds
s_addk_i32 m0, 32
s_nop 0
buffer_load_dwordx4 v240, s[12:15], s96 offen offset:1024 lds
s_add_u32 m0, s88, 143360
s_mov_b32 s82, 917504
buffer_load_dwordx4 v241, s[28:31], s82 offen lds
s_addk_i32 m0, 1024
s_addk_i32 s82, 14336
buffer_load_dwordx4 v241, s[28:31], s82 offen lds
s_add_u32 m0, s77, 118272
s_addk_i32 s97, 8192
buffer_load_dwordx4 v240, s[16:19], s97 offen lds
s_addk_i32 m0, 32
s_nop 0
buffer_load_dwordx4 v240, s[16:19], s97 offen offset:1024 lds
s_addk_i32 m0, 8416
s_addk_i32 s97, 8192
buffer_load_dwordx4 v240, s[16:19], s97 offen lds
s_addk_i32 m0, 32
s_nop 0
buffer_load_dwordx4 v240, s[16:19], s97 offen offset:1024 lds
s_add_u32 s83, s89, 327680
buffer_load_dword v244, v243, s[44:47], s83 offen
s_waitcnt vmcnt(15)
s_waitcnt lgkmcnt(0)
s_barrier
s_setprio 2
v_mfma_f32_16x16x32_bf16 v[112:115], v[176:179], v[32:35], v[112:115]
v_mfma_f32_16x16x32_bf16 v[120:123], v[176:179], v[36:39], v[120:123]
ds_read_b64_tr_b16 v[176:177], v246 offset:0
ds_read_b64_tr_b16 v[178:179], v246 offset:1024
v_mfma_f32_16x16x32_bf16 v[136:139], v[180:183], v[36:39], v[136:139]
v_mfma_f32_16x16x32_bf16 v[128:131], v[180:183], v[32:35], v[128:131]
ds_read_b64_tr_b16 v[180:181], v247 offset:0
ds_read_b64_tr_b16 v[182:183], v247 offset:1024
v_mfma_f32_16x16x32_bf16 v[116:119], v[184:187], v[32:35], v[116:119]
v_mfma_f32_16x16x32_bf16 v[124:127], v[184:187], v[36:39], v[124:127]
ds_read_b64_tr_b16 v[184:185], v246 offset:2048
ds_read_b64_tr_b16 v[186:187], v246 offset:3072
v_mfma_f32_16x16x32_bf16 v[140:143], v[188:191], v[36:39], v[140:143]
v_mfma_f32_16x16x32_bf16 v[132:135], v[188:191], v[32:35], v[132:135]
ds_read_b64_tr_b16 v[188:189], v247 offset:2048
ds_read_b64_tr_b16 v[190:191], v247 offset:3072
v_mfma_f32_16x16x32_bf16 v[112:115], v[192:195], v[40:43], v[112:115]
v_mfma_f32_16x16x32_bf16 v[120:123], v[192:195], v[44:47], v[120:123]
ds_read_b64_tr_b16 v[192:193], v246 offset:4096
ds_read_b64_tr_b16 v[194:195], v246 offset:5120
v_mfma_f32_16x16x32_bf16 v[136:139], v[196:199], v[44:47], v[136:139]
v_mfma_f32_16x16x32_bf16 v[128:131], v[196:199], v[40:43], v[128:131]
ds_read_b64_tr_b16 v[196:197], v247 offset:4096
ds_read_b64_tr_b16 v[198:199], v247 offset:5120
v_mfma_f32_16x16x32_bf16 v[116:119], v[200:203], v[40:43], v[116:119]
v_mfma_f32_16x16x32_bf16 v[124:127], v[200:203], v[44:47], v[124:127]
ds_read_b64_tr_b16 v[200:201], v246 offset:6144
ds_read_b64_tr_b16 v[202:203], v246 offset:7168
v_mfma_f32_16x16x32_bf16 v[140:143], v[204:207], v[44:47], v[140:143]
v_mfma_f32_16x16x32_bf16 v[132:135], v[204:207], v[40:43], v[132:135]
ds_read_b64_tr_b16 v[204:205], v247 offset:6144
ds_read_b64_tr_b16 v[206:207], v247 offset:7168
s_setprio 0
s_add_u32 m0, s76, 16896
s_addk_i32 s96, 8192
buffer_load_dwordx4 v240, s[12:15], s96 offen lds
s_addk_i32 m0, 32
s_nop 0
buffer_load_dwordx4 v240, s[12:15], s96 offen offset:1024 lds
s_addk_i32 m0, 8416
s_addk_i32 s96, 8192
buffer_load_dwordx4 v240, s[12:15], s96 offen lds
s_addk_i32 m0, 32
s_nop 0
buffer_load_dwordx4 v240, s[12:15], s96 offen offset:1024 lds
s_add_u32 m0, s88, 151552
s_mov_b32 s82, 1146880
buffer_load_dwordx4 v241, s[28:31], s82 offen lds
s_addk_i32 m0, 1024
s_addk_i32 s82, 14336
buffer_load_dwordx4 v241, s[28:31], s82 offen lds
s_add_u32 m0, s77, 67584
s_addk_i32 s97, 8192
buffer_load_dwordx4 v240, s[16:19], s97 offen lds
s_addk_i32 m0, 32
s_nop 0
buffer_load_dwordx4 v240, s[16:19], s97 offen offset:1024 lds
s_addk_i32 m0, 8416
s_addk_i32 s97, 8192
buffer_load_dwordx4 v240, s[16:19], s97 offen lds
s_addk_i32 m0, 32
s_nop 0
buffer_load_dwordx4 v240, s[16:19], s97 offen offset:1024 lds
s_waitcnt vmcnt(15)
s_waitcnt lgkmcnt(0)
s_barrier
s_setprio 2
v_mfma_f32_16x16x32_bf16 v[112:115], v[176:179], v[48:51], v[112:115]
s_nop 0
v_mfma_f32_16x16x32_bf16 v[120:123], v[176:179], v[52:55], v[120:123]
ds_read_b64_tr_b16 v[176:177], v246 offset:8192
ds_read_b64_tr_b16 v[178:179], v246 offset:9216
v_mfma_f32_16x16x32_bf16 v[136:139], v[180:183], v[52:55], v[136:139]
v_mfma_f32_16x16x32_bf16 v[128:131], v[180:183], v[48:51], v[128:131]
ds_read_b64_tr_b16 v[180:181], v247 offset:8192
ds_read_b64_tr_b16 v[182:183], v247 offset:9216
v_mfma_f32_16x16x32_bf16 v[116:119], v[184:187], v[48:51], v[116:119]
v_mfma_f32_16x16x32_bf16 v[124:127], v[184:187], v[52:55], v[124:127]
ds_read_b64_tr_b16 v[184:185], v246 offset:10240
ds_read_b64_tr_b16 v[186:187], v246 offset:11264
v_mfma_f32_16x16x32_bf16 v[140:143], v[188:191], v[52:55], v[140:143]
v_mfma_f32_16x16x32_bf16 v[132:135], v[188:191], v[48:51], v[132:135]
ds_read_b64_tr_b16 v[188:189], v247 offset:10240
ds_read_b64_tr_b16 v[190:191], v247 offset:11264
v_mfma_f32_16x16x32_bf16 v[112:115], v[192:195], v[56:59], v[112:115]
v_mfma_f32_16x16x32_bf16 v[120:123], v[192:195], v[60:63], v[120:123]
ds_read_b64_tr_b16 v[192:193], v246 offset:12288
ds_read_b64_tr_b16 v[194:195], v246 offset:13312
v_mfma_f32_16x16x32_bf16 v[136:139], v[196:199], v[60:63], v[136:139]
v_mfma_f32_16x16x32_bf16 v[128:131], v[196:199], v[56:59], v[128:131]
ds_read_b64_tr_b16 v[196:197], v247 offset:12288
ds_read_b64_tr_b16 v[198:199], v247 offset:13312
v_mfma_f32_16x16x32_bf16 v[116:119], v[200:203], v[56:59], v[116:119]
v_mfma_f32_16x16x32_bf16 v[124:127], v[200:203], v[60:63], v[124:127]
ds_read_b64_tr_b16 v[200:201], v246 offset:14336
ds_read_b64_tr_b16 v[202:203], v246 offset:15360
v_mfma_f32_16x16x32_bf16 v[140:143], v[204:207], v[60:63], v[140:143]
v_mfma_f32_16x16x32_bf16 v[132:135], v[204:207], v[56:59], v[132:135]
ds_read_b64_tr_b16 v[204:205], v247 offset:14336
ds_read_b64_tr_b16 v[206:207], v247 offset:15360
s_setprio 0
s_add_u32 m0, s76, 33792
s_addk_i32 s96, 8192
buffer_load_dwordx4 v240, s[12:15], s96 offen lds
s_addk_i32 m0, 32
s_nop 0
buffer_load_dwordx4 v240, s[12:15], s96 offen offset:1024 lds
s_addk_i32 m0, 8416
s_addk_i32 s96, 8192
buffer_load_dwordx4 v240, s[12:15], s96 offen lds
s_addk_i32 m0, 32
s_nop 0
buffer_load_dwordx4 v240, s[12:15], s96 offen offset:1024 lds
s_add_u32 m0, s88, 135168
s_mov_b32 s82, 1376256
buffer_load_dwordx4 v241, s[28:31], s82 offen lds
s_addk_i32 m0, 1024
s_addk_i32 s82, 14336
buffer_load_dwordx4 v241, s[28:31], s82 offen lds
s_add_u32 m0, s77, 84480
s_addk_i32 s97, 8192
buffer_load_dwordx4 v240, s[16:19], s97 offen lds
s_addk_i32 m0, 32
s_nop 0
buffer_load_dwordx4 v240, s[16:19], s97 offen offset:1024 lds
s_addk_i32 m0, 8416
s_addk_i32 s97, 8192
buffer_load_dwordx4 v240, s[16:19], s97 offen lds
s_addk_i32 m0, 32
s_nop 0
buffer_load_dwordx4 v240, s[16:19], s97 offen offset:1024 lds
s_add_u32 s83, s89, 393216
buffer_load_dword v244, v243, s[44:47], s83 offen
s_waitcnt vmcnt(15)
s_waitcnt lgkmcnt(0)
s_barrier
s_setprio 2
v_mfma_f32_16x16x32_bf16 v[112:115], v[176:179], v[64:67], v[112:115]
s_nop 0
v_mfma_f32_16x16x32_bf16 v[120:123], v[176:179], v[68:71], v[120:123]
ds_read_b64_tr_b16 v[176:177], v246 offset:16384
ds_read_b64_tr_b16 v[178:179], v246 offset:17408
v_mfma_f32_16x16x32_bf16 v[136:139], v[180:183], v[68:71], v[136:139]
v_mfma_f32_16x16x32_bf16 v[128:131], v[180:183], v[64:67], v[128:131]
ds_read_b64_tr_b16 v[180:181], v247 offset:16384
ds_read_b64_tr_b16 v[182:183], v247 offset:17408
v_mfma_f32_16x16x32_bf16 v[116:119], v[184:187], v[64:67], v[116:119]
v_mfma_f32_16x16x32_bf16 v[124:127], v[184:187], v[68:71], v[124:127]
ds_read_b64_tr_b16 v[184:185], v246 offset:18432
ds_read_b64_tr_b16 v[186:187], v246 offset:19456
v_mfma_f32_16x16x32_bf16 v[140:143], v[188:191], v[68:71], v[140:143]
v_mfma_f32_16x16x32_bf16 v[132:135], v[188:191], v[64:67], v[132:135]
ds_read_b64_tr_b16 v[188:189], v247 offset:18432
ds_read_b64_tr_b16 v[190:191], v247 offset:19456
v_mfma_f32_16x16x32_bf16 v[112:115], v[192:195], v[72:75], v[112:115]
v_mfma_f32_16x16x32_bf16 v[120:123], v[192:195], v[76:79], v[120:123]
ds_read_b64_tr_b16 v[192:193], v246 offset:20480
ds_read_b64_tr_b16 v[194:195], v246 offset:21504
v_mfma_f32_16x16x32_bf16 v[136:139], v[196:199], v[76:79], v[136:139]
v_mfma_f32_16x16x32_bf16 v[128:131], v[196:199], v[72:75], v[128:131]
ds_read_b64_tr_b16 v[196:197], v247 offset:20480
ds_read_b64_tr_b16 v[198:199], v247 offset:21504
v_mfma_f32_16x16x32_bf16 v[116:119], v[200:203], v[72:75], v[116:119]
v_mfma_f32_16x16x32_bf16 v[124:127], v[200:203], v[76:79], v[124:127]
ds_read_b64_tr_b16 v[200:201], v246 offset:22528
ds_read_b64_tr_b16 v[202:203], v246 offset:23552
v_mfma_f32_16x16x32_bf16 v[140:143], v[204:207], v[76:79], v[140:143]
v_mfma_f32_16x16x32_bf16 v[132:135], v[204:207], v[72:75], v[132:135]
ds_read_b64_tr_b16 v[204:205], v247 offset:22528
ds_read_b64_tr_b16 v[206:207], v247 offset:23552
s_setprio 0
s_add_u32 m0, s76, 50688
s_addk_i32 s96, 8192
buffer_load_dwordx4 v240, s[12:15], s96 offen lds
s_addk_i32 m0, 32
s_nop 0
buffer_load_dwordx4 v240, s[12:15], s96 offen offset:1024 lds
s_addk_i32 m0, 8416
s_addk_i32 s96, 8192
buffer_load_dwordx4 v240, s[12:15], s96 offen lds
s_addk_i32 m0, 32
s_nop 0
buffer_load_dwordx4 v240, s[12:15], s96 offen offset:1024 lds
s_add_u32 m0, s88, 143360
s_mov_b32 s82, 64
buffer_load_dwordx4 v241, s[28:31], s82 offen lds
s_addk_i32 m0, 1024
s_addk_i32 s82, 14336
buffer_load_dwordx4 v241, s[28:31], s82 offen lds
s_add_u32 m0, s77, 101376
s_addk_i32 s97, 8192
buffer_load_dwordx4 v240, s[16:19], s97 offen lds
s_addk_i32 m0, 32
s_nop 0
buffer_load_dwordx4 v240, s[16:19], s97 offen offset:1024 lds
s_addk_i32 m0, 8416
s_addk_i32 s97, 8192
buffer_load_dwordx4 v240, s[16:19], s97 offen lds
s_addk_i32 m0, 32
s_nop 0
buffer_load_dwordx4 v240, s[16:19], s97 offen offset:1024 lds
s_waitcnt vmcnt(15)
s_waitcnt lgkmcnt(0)
s_barrier
s_setprio 2
v_mfma_f32_16x16x32_bf16 v[112:115], v[176:179], v[80:83], v[112:115]
v_mfma_f32_16x16x32_bf16 v[120:123], v[176:179], v[84:87], v[120:123]
ds_read_b64_tr_b16 v[176:177], v246 offset:0
ds_read_b64_tr_b16 v[178:179], v246 offset:1024
v_mfma_f32_16x16x32_bf16 v[136:139], v[180:183], v[84:87], v[136:139]
v_mfma_f32_16x16x32_bf16 v[128:131], v[180:183], v[80:83], v[128:131]
ds_read_b64_tr_b16 v[180:181], v247 offset:0
ds_read_b64_tr_b16 v[182:183], v247 offset:1024
v_mfma_f32_16x16x32_bf16 v[116:119], v[184:187], v[80:83], v[116:119]
v_mfma_f32_16x16x32_bf16 v[124:127], v[184:187], v[84:87], v[124:127]
ds_read_b64_tr_b16 v[184:185], v246 offset:2048
ds_read_b64_tr_b16 v[186:187], v246 offset:3072
v_mfma_f32_16x16x32_bf16 v[140:143], v[188:191], v[84:87], v[140:143]
v_mfma_f32_16x16x32_bf16 v[132:135], v[188:191], v[80:83], v[132:135]
ds_read_b64_tr_b16 v[188:189], v247 offset:2048
ds_read_b64_tr_b16 v[190:191], v247 offset:3072
v_mfma_f32_16x16x32_bf16 v[112:115], v[192:195], v[88:91], v[112:115]
v_mfma_f32_16x16x32_bf16 v[120:123], v[192:195], v[92:95], v[120:123]
ds_read_b64_tr_b16 v[192:193], v246 offset:4096
ds_read_b64_tr_b16 v[194:195], v246 offset:5120
v_mfma_f32_16x16x32_bf16 v[136:139], v[196:199], v[92:95], v[136:139]
v_mfma_f32_16x16x32_bf16 v[128:131], v[196:199], v[88:91], v[128:131]
ds_read_b64_tr_b16 v[196:197], v247 offset:4096
ds_read_b64_tr_b16 v[198:199], v247 offset:5120
v_mfma_f32_16x16x32_bf16 v[116:119], v[200:203], v[88:91], v[116:119]
v_mfma_f32_16x16x32_bf16 v[124:127], v[200:203], v[92:95], v[124:127]
ds_read_b64_tr_b16 v[200:201], v246 offset:6144
ds_read_b64_tr_b16 v[202:203], v246 offset:7168
v_mfma_f32_16x16x32_bf16 v[140:143], v[204:207], v[92:95], v[140:143]
v_mfma_f32_16x16x32_bf16 v[132:135], v[204:207], v[88:91], v[132:135]
ds_read_b64_tr_b16 v[204:205], v247 offset:6144
ds_read_b64_tr_b16 v[206:207], v247 offset:7168
s_setprio 0
s_add_u32 m0, s76, 0
s_addk_i32 s96, 8192
buffer_load_dwordx4 v240, s[12:15], s96 offen lds
s_addk_i32 m0, 32
s_nop 0
buffer_load_dwordx4 v240, s[12:15], s96 offen offset:1024 lds
s_addk_i32 m0, 8416
s_addk_i32 s96, 8192
buffer_load_dwordx4 v240, s[12:15], s96 offen lds
s_addk_i32 m0, 32
s_nop 0
buffer_load_dwordx4 v240, s[12:15], s96 offen offset:1024 lds
s_add_u32 m0, s88, 151552
s_mov_b32 s82, 229440
buffer_load_dwordx4 v241, s[28:31], s82 offen lds
s_addk_i32 m0, 1024
s_addk_i32 s82, 14336
buffer_load_dwordx4 v241, s[28:31], s82 offen lds
s_add_u32 m0, s77, 118272
s_addk_i32 s97, 8192
buffer_load_dwordx4 v240, s[16:19], s97 offen lds
s_addk_i32 m0, 32
s_nop 0
buffer_load_dwordx4 v240, s[16:19], s97 offen offset:1024 lds
s_addk_i32 m0, 8416
s_addk_i32 s97, 8192
buffer_load_dwordx4 v240, s[16:19], s97 offen lds
s_addk_i32 m0, 32
s_nop 0
buffer_load_dwordx4 v240, s[16:19], s97 offen offset:1024 lds
s_add_u32 s83, s89, 458752
buffer_load_dword v244, v243, s[44:47], s83 offen
s_waitcnt vmcnt(15)
s_waitcnt lgkmcnt(0)
s_barrier
s_setprio 2
v_mfma_f32_16x16x32_bf16 v[112:115], v[176:179], v[96:99], v[112:115]
v_mfma_f32_16x16x32_bf16 v[120:123], v[176:179], v[100:103], v[120:123]
ds_read_b64_tr_b16 v[176:177], v246 offset:8192
ds_read_b64_tr_b16 v[178:179], v246 offset:9216
v_mfma_f32_16x16x32_bf16 v[136:139], v[180:183], v[100:103], v[136:139]
v_mfma_f32_16x16x32_bf16 v[128:131], v[180:183], v[96:99], v[128:131]
ds_read_b64_tr_b16 v[180:181], v247 offset:8192
ds_read_b64_tr_b16 v[182:183], v247 offset:9216
v_mfma_f32_16x16x32_bf16 v[116:119], v[184:187], v[96:99], v[116:119]
v_mfma_f32_16x16x32_bf16 v[124:127], v[184:187], v[100:103], v[124:127]
ds_read_b64_tr_b16 v[184:185], v246 offset:10240
ds_read_b64_tr_b16 v[186:187], v246 offset:11264
v_mfma_f32_16x16x32_bf16 v[140:143], v[188:191], v[100:103], v[140:143]
v_mfma_f32_16x16x32_bf16 v[132:135], v[188:191], v[96:99], v[132:135]
ds_read_b64_tr_b16 v[188:189], v247 offset:10240
ds_read_b64_tr_b16 v[190:191], v247 offset:11264
v_mfma_f32_16x16x32_bf16 v[112:115], v[192:195], v[104:107], v[112:115]
v_mfma_f32_16x16x32_bf16 v[120:123], v[192:195], v[108:111], v[120:123]
ds_read_b64_tr_b16 v[192:193], v246 offset:12288
ds_read_b64_tr_b16 v[194:195], v246 offset:13312
v_mfma_f32_16x16x32_bf16 v[136:139], v[196:199], v[108:111], v[136:139]
v_mfma_f32_16x16x32_bf16 v[128:131], v[196:199], v[104:107], v[128:131]
ds_read_b64_tr_b16 v[196:197], v247 offset:12288
ds_read_b64_tr_b16 v[198:199], v247 offset:13312
v_mfma_f32_16x16x32_bf16 v[116:119], v[200:203], v[104:107], v[116:119]
v_mfma_f32_16x16x32_bf16 v[124:127], v[200:203], v[108:111], v[124:127]
ds_read_b64_tr_b16 v[200:201], v246 offset:14336
ds_read_b64_tr_b16 v[202:203], v246 offset:15360
v_mfma_f32_16x16x32_bf16 v[140:143], v[204:207], v[108:111], v[140:143]
v_mfma_f32_16x16x32_bf16 v[132:135], v[204:207], v[104:107], v[132:135]
ds_read_b64_tr_b16 v[204:205], v247 offset:14336
ds_read_b64_tr_b16 v[206:207], v247 offset:15360
s_setprio 0
s_add_u32 m0, s76, 16896
s_addk_i32 s96, 8192
buffer_load_dwordx4 v240, s[12:15], s96 offen lds
s_addk_i32 m0, 32
s_nop 0
buffer_load_dwordx4 v240, s[12:15], s96 offen offset:1024 lds
s_addk_i32 m0, 8416
s_addk_i32 s96, 8192
buffer_load_dwordx4 v240, s[12:15], s96 offen lds
s_addk_i32 m0, 32
s_nop 0
buffer_load_dwordx4 v240, s[12:15], s96 offen offset:1024 lds
s_add_u32 m0, s88, 135168
s_mov_b32 s82, 458816
buffer_load_dwordx4 v241, s[28:31], s82 offen lds
s_addk_i32 m0, 1024
s_addk_i32 s82, 14336
buffer_load_dwordx4 v241, s[28:31], s82 offen lds
s_add_u32 m0, s77, 67584
s_addk_i32 s97, 8192
buffer_load_dwordx4 v240, s[16:19], s97 offen lds
s_addk_i32 m0, 32
s_nop 0
buffer_load_dwordx4 v240, s[16:19], s97 offen offset:1024 lds
s_addk_i32 m0, 8416
s_addk_i32 s97, 8192
buffer_load_dwordx4 v240, s[16:19], s97 offen lds
s_addk_i32 m0, 32
s_nop 0
buffer_load_dwordx4 v240, s[16:19], s97 offen offset:1024 lds
s_waitcnt vmcnt(15)
s_waitcnt lgkmcnt(0)
s_barrier
s_setprio 2
v_mfma_f32_16x16x32_bf16 v[144:147], v[176:179], v[0:3], 0
v_mul_f32 v112, s73, v112
v_mul_f32_e64 v113, s73, v113
v_mfma_f32_16x16x32_bf16 v[152:155], v[176:179], v[4:7], 0
ds_read_b64_tr_b16 v[176:177], v246 offset:16384
ds_read_b64_tr_b16 v[178:179], v246 offset:17408
v_mfma_f32_16x16x32_bf16 v[168:171], v[180:183], v[4:7], 0
v_mul_f32 v114, s73, v114
v_mul_f32 v115, s73, v115
v_mfma_f32_16x16x32_bf16 v[160:163], v[180:183], v[0:3], 0
ds_read_b64_tr_b16 v[180:181], v247 offset:16384
ds_read_b64_tr_b16 v[182:183], v247 offset:17408
v_mfma_f32_16x16x32_bf16 v[148:151], v[184:187], v[0:3], 0
v_mul_f32 v120, s73, v120
v_mul_f32 v121, s73, v121
v_mfma_f32_16x16x32_bf16 v[156:159], v[184:187], v[4:7], 0
ds_read_b64_tr_b16 v[184:185], v246 offset:18432
ds_read_b64_tr_b16 v[186:187], v246 offset:19456
v_mfma_f32_16x16x32_bf16 v[172:175], v[188:191], v[4:7], 0
v_mul_f32 v122, s73, v122
v_mul_f32 v123, s73, v123
v_mfma_f32_16x16x32_bf16 v[164:167], v[188:191], v[0:3], 0
ds_read_b64_tr_b16 v[188:189], v247 offset:18432
ds_read_b64_tr_b16 v[190:191], v247 offset:19456
v_mfma_f32_16x16x32_bf16 v[144:147], v[192:195], v[8:11], v[144:147]
v_exp_f32_e64 v112, v112
v_mfma_f32_16x16x32_bf16 v[152:155], v[192:195], v[12:15], v[152:155]
ds_read_b64_tr_b16 v[192:193], v246 offset:20480
ds_read_b64_tr_b16 v[194:195], v246 offset:21504
v_mfma_f32_16x16x32_bf16 v[168:171], v[196:199], v[12:15], v[168:171]
v_exp_f32_e64 v113, v113
v_mfma_f32_16x16x32_bf16 v[160:163], v[196:199], v[8:11], v[160:163]
ds_read_b64_tr_b16 v[196:197], v247 offset:20480
ds_read_b64_tr_b16 v[198:199], v247 offset:21504
v_mfma_f32_16x16x32_bf16 v[148:151], v[200:203], v[8:11], v[148:151]
v_exp_f32_e64 v114, v114
v_mfma_f32_16x16x32_bf16 v[156:159], v[200:203], v[12:15], v[156:159]
ds_read_b64_tr_b16 v[200:201], v246 offset:22528
ds_read_b64_tr_b16 v[202:203], v246 offset:23552
v_mfma_f32_16x16x32_bf16 v[172:175], v[204:207], v[12:15], v[172:175]
v_exp_f32_e64 v115, v115
v_mfma_f32_16x16x32_bf16 v[164:167], v[204:207], v[8:11], v[164:167]
ds_read_b64_tr_b16 v[204:205], v247 offset:22528
ds_read_b64_tr_b16 v[206:207], v247 offset:23552
s_setprio 0
v_exp_f32 v120, v120
s_add_u32 m0, s76, 33792
s_addk_i32 s96, 8192
buffer_load_dwordx4 v240, s[12:15], s96 offen lds
s_addk_i32 m0, 32
s_nop 0
buffer_load_dwordx4 v240, s[12:15], s96 offen offset:1024 lds
s_addk_i32 m0, 8416
s_addk_i32 s96, 8192
buffer_load_dwordx4 v240, s[12:15], s96 offen lds
s_addk_i32 m0, 32
s_nop 0
buffer_load_dwordx4 v240, s[12:15], s96 offen offset:1024 lds
s_add_u32 m0, s88, 143360
s_mov_b32 s82, 688192
buffer_load_dwordx4 v241, s[28:31], s82 offen lds
s_addk_i32 m0, 1024
s_addk_i32 s82, 14336
buffer_load_dwordx4 v241, s[28:31], s82 offen lds
s_add_u32 m0, s77, 84480
s_addk_i32 s97, 8192
buffer_load_dwordx4 v240, s[16:19], s97 offen lds
s_addk_i32 m0, 32
s_nop 0
buffer_load_dwordx4 v240, s[16:19], s97 offen offset:1024 lds
s_addk_i32 m0, 8416
s_addk_i32 s97, 8192
buffer_load_dwordx4 v240, s[16:19], s97 offen lds
s_addk_i32 m0, 32
s_nop 0
buffer_load_dwordx4 v240, s[16:19], s97 offen offset:1024 lds
s_add_u32 s83, s89, 524288
buffer_load_dword v244, v243, s[44:47], s83 offen
s_mul_i32 s83, s91, 7168
s_add_u32 s83, s83, s88
s_lshl_b32 s83, s83, 0
buffer_load_dword v244, v243, s[36:39], s83 offen
s_waitcnt vmcnt(16)
s_waitcnt lgkmcnt(0)
s_barrier
s_setprio 2
v_mfma_f32_16x16x32_bf16 v[144:147], v[176:179], v[16:19], v[144:147]
v_exp_f32_e64 v121, v121
v_mfma_f32_16x16x32_bf16 v[152:155], v[176:179], v[20:23], v[152:155]
ds_read_b64_tr_b16 v[176:177], v246 offset:0
ds_read_b64_tr_b16 v[178:179], v246 offset:1024
v_mfma_f32_16x16x32_bf16 v[168:171], v[180:183], v[20:23], v[168:171]
v_exp_f32_e64 v122, v122
v_mfma_f32_16x16x32_bf16 v[160:163], v[180:183], v[16:19], v[160:163]
ds_read_b64_tr_b16 v[180:181], v247 offset:0
ds_read_b64_tr_b16 v[182:183], v247 offset:1024
v_mfma_f32_16x16x32_bf16 v[148:151], v[184:187], v[16:19], v[148:151]
v_exp_f32_e64 v123, v123
v_mfma_f32_16x16x32_bf16 v[156:159], v[184:187], v[20:23], v[156:159]
ds_read_b64_tr_b16 v[184:185], v246 offset:2048
ds_read_b64_tr_b16 v[186:187], v246 offset:3072
v_mfma_f32_16x16x32_bf16 v[172:175], v[188:191], v[20:23], v[172:175]
v_add_f32 v112, 1.0, v112
v_add_f32 v113, 1.0, v113
v_mfma_f32_16x16x32_bf16 v[164:167], v[188:191], v[16:19], v[164:167]
ds_read_b64_tr_b16 v[188:189], v247 offset:2048
ds_read_b64_tr_b16 v[190:191], v247 offset:3072
v_mfma_f32_16x16x32_bf16 v[144:147], v[192:195], v[24:27], v[144:147]
v_add_f32 v114, 1.0, v114
v_add_f32 v115, 1.0, v115
v_mfma_f32_16x16x32_bf16 v[152:155], v[192:195], v[28:31], v[152:155]
ds_read_b64_tr_b16 v[192:193], v246 offset:4096
ds_read_b64_tr_b16 v[194:195], v246 offset:5120
v_mfma_f32_16x16x32_bf16 v[168:171], v[196:199], v[28:31], v[168:171]
v_add_f32 v120, 1.0, v120
v_add_f32 v121, 1.0, v121
v_mfma_f32_16x16x32_bf16 v[160:163], v[196:199], v[24:27], v[160:163]
ds_read_b64_tr_b16 v[196:197], v247 offset:4096
ds_read_b64_tr_b16 v[198:199], v247 offset:5120
v_mfma_f32_16x16x32_bf16 v[148:151], v[200:203], v[24:27], v[148:151]
v_add_f32 v122, 1.0, v122
v_add_f32 v123, 1.0, v123
v_mfma_f32_16x16x32_bf16 v[156:159], v[200:203], v[28:31], v[156:159]
ds_read_b64_tr_b16 v[200:201], v246 offset:6144
ds_read_b64_tr_b16 v[202:203], v246 offset:7168
v_mfma_f32_16x16x32_bf16 v[172:175], v[204:207], v[28:31], v[172:175]
v_rcp_f32_e64 v112, v112
v_mfma_f32_16x16x32_bf16 v[164:167], v[204:207], v[24:27], v[164:167]
ds_read_b64_tr_b16 v[204:205], v247 offset:6144
ds_read_b64_tr_b16 v[206:207], v247 offset:7168
s_setprio 0
v_rcp_f32 v113, v113
s_add_u32 m0, s76, 50688
s_addk_i32 s96, 8192
buffer_load_dwordx4 v240, s[12:15], s96 offen lds
s_addk_i32 m0, 32
s_nop 0
buffer_load_dwordx4 v240, s[12:15], s96 offen offset:1024 lds
s_addk_i32 m0, 8416
s_addk_i32 s96, 8192
buffer_load_dwordx4 v240, s[12:15], s96 offen lds
s_addk_i32 m0, 32
s_nop 0
buffer_load_dwordx4 v240, s[12:15], s96 offen offset:1024 lds
s_add_u32 m0, s88, 151552
s_mov_b32 s82, 917568
buffer_load_dwordx4 v241, s[28:31], s82 offen lds
s_addk_i32 m0, 1024
s_addk_i32 s82, 14336
buffer_load_dwordx4 v241, s[28:31], s82 offen lds
s_add_u32 m0, s77, 101376
s_addk_i32 s97, 8192
buffer_load_dwordx4 v240, s[16:19], s97 offen lds
s_addk_i32 m0, 32
s_nop 0
buffer_load_dwordx4 v240, s[16:19], s97 offen offset:1024 lds
s_addk_i32 m0, 8416
s_addk_i32 s97, 8192
buffer_load_dwordx4 v240, s[16:19], s97 offen lds
s_addk_i32 m0, 32
s_nop 0
buffer_load_dwordx4 v240, s[16:19], s97 offen offset:1024 lds
s_waitcnt vmcnt(16)
s_waitcnt lgkmcnt(0)
s_barrier
s_setprio 2
v_mfma_f32_16x16x32_bf16 v[144:147], v[176:179], v[32:35], v[144:147]
v_rcp_f32_e64 v114, v114
v_mfma_f32_16x16x32_bf16 v[152:155], v[176:179], v[36:39], v[152:155]
ds_read_b64_tr_b16 v[176:177], v246 offset:8192
ds_read_b64_tr_b16 v[178:179], v246 offset:9216
v_mfma_f32_16x16x32_bf16 v[168:171], v[180:183], v[36:39], v[168:171]
v_rcp_f32_e64 v115, v115
v_mfma_f32_16x16x32_bf16 v[160:163], v[180:183], v[32:35], v[160:163]
ds_read_b64_tr_b16 v[180:181], v247 offset:8192
ds_read_b64_tr_b16 v[182:183], v247 offset:9216
v_mfma_f32_16x16x32_bf16 v[148:151], v[184:187], v[32:35], v[148:151]
v_rcp_f32_e64 v120, v120
v_mfma_f32_16x16x32_bf16 v[156:159], v[184:187], v[36:39], v[156:159]
ds_read_b64_tr_b16 v[184:185], v246 offset:10240
ds_read_b64_tr_b16 v[186:187], v246 offset:11264
v_mfma_f32_16x16x32_bf16 v[172:175], v[188:191], v[36:39], v[172:175]
v_rcp_f32_e64 v121, v121
v_mfma_f32_16x16x32_bf16 v[164:167], v[188:191], v[32:35], v[164:167]
ds_read_b64_tr_b16 v[188:189], v247 offset:10240
ds_read_b64_tr_b16 v[190:191], v247 offset:11264
v_mfma_f32_16x16x32_bf16 v[144:147], v[192:195], v[40:43], v[144:147]
v_rcp_f32_e64 v122, v122
v_mfma_f32_16x16x32_bf16 v[152:155], v[192:195], v[44:47], v[152:155]
ds_read_b64_tr_b16 v[192:193], v246 offset:12288
ds_read_b64_tr_b16 v[194:195], v246 offset:13312
v_mfma_f32_16x16x32_bf16 v[168:171], v[196:199], v[44:47], v[168:171]
v_rcp_f32_e64 v123, v123
v_mfma_f32_16x16x32_bf16 v[160:163], v[196:199], v[40:43], v[160:163]
ds_read_b64_tr_b16 v[196:197], v247 offset:12288
ds_read_b64_tr_b16 v[198:199], v247 offset:13312
v_mfma_f32_16x16x32_bf16 v[148:151], v[200:203], v[40:43], v[148:151]
v_mul_f32 v112, v112, v116
v_mul_f32 v113, v113, v117
v_mfma_f32_16x16x32_bf16 v[156:159], v[200:203], v[44:47], v[156:159]
ds_read_b64_tr_b16 v[200:201], v246 offset:14336
ds_read_b64_tr_b16 v[202:203], v246 offset:15360
v_mfma_f32_16x16x32_bf16 v[172:175], v[204:207], v[44:47], v[172:175]
v_mul_f32 v114, v114, v118
v_mul_f32 v115, v115, v119
v_mfma_f32_16x16x32_bf16 v[164:167], v[204:207], v[40:43], v[164:167]
ds_read_b64_tr_b16 v[204:205], v247 offset:14336
ds_read_b64_tr_b16 v[206:207], v247 offset:15360
s_setprio 0
s_add_u32 m0, s76, 0
s_addk_i32 s96, 8192
buffer_load_dwordx4 v240, s[12:15], s96 offen lds
s_addk_i32 m0, 32
s_nop 0
buffer_load_dwordx4 v240, s[12:15], s96 offen offset:1024 lds
s_addk_i32 m0, 8416
s_addk_i32 s96, 8192
buffer_load_dwordx4 v240, s[12:15], s96 offen lds
s_addk_i32 m0, 32
s_nop 0
buffer_load_dwordx4 v240, s[12:15], s96 offen offset:1024 lds
s_add_u32 m0, s88, 135168
s_mov_b32 s82, 1146944
buffer_load_dwordx4 v241, s[28:31], s82 offen lds
s_addk_i32 m0, 1024
s_addk_i32 s82, 14336
buffer_load_dwordx4 v241, s[28:31], s82 offen lds
s_add_u32 m0, s77, 118272
s_addk_i32 s97, 8192
buffer_load_dwordx4 v240, s[16:19], s97 offen lds
s_addk_i32 m0, 32
s_nop 0
buffer_load_dwordx4 v240, s[16:19], s97 offen offset:1024 lds
s_addk_i32 m0, 8416
s_addk_i32 s97, 8192
buffer_load_dwordx4 v240, s[16:19], s97 offen lds
s_addk_i32 m0, 32
s_nop 0
buffer_load_dwordx4 v240, s[16:19], s97 offen offset:1024 lds
s_add_u32 s83, s89, 589824
buffer_load_dword v244, v243, s[44:47], s83 offen
s_waitcnt vmcnt(15)
s_waitcnt lgkmcnt(0)
s_barrier
s_setprio 2
v_mfma_f32_16x16x32_bf16 v[144:147], v[176:179], v[48:51], v[144:147]
v_mul_f32 v120, v120, v124
v_mul_f32 v121, v121, v125
v_mfma_f32_16x16x32_bf16 v[152:155], v[176:179], v[52:55], v[152:155]
ds_read_b64_tr_b16 v[176:177], v246 offset:16384
ds_read_b64_tr_b16 v[178:179], v246 offset:17408
v_mfma_f32_16x16x32_bf16 v[168:171], v[180:183], v[52:55], v[168:171]
v_mul_f32 v122, v122, v126
v_mul_f32 v123, v123, v127
v_mfma_f32_16x16x32_bf16 v[160:163], v[180:183], v[48:51], v[160:163]
ds_read_b64_tr_b16 v[180:181], v247 offset:16384
ds_read_b64_tr_b16 v[182:183], v247 offset:17408
v_mfma_f32_16x16x32_bf16 v[148:151], v[184:187], v[48:51], v[148:151]
v_cvt_pk_bf16_f32 v208, v112, v113
v_cvt_pk_bf16_f32 v209, v114, v115
v_mfma_f32_16x16x32_bf16 v[156:159], v[184:187], v[52:55], v[156:159]
ds_read_b64_tr_b16 v[184:185], v246 offset:18432
ds_read_b64_tr_b16 v[186:187], v246 offset:19456
v_mfma_f32_16x16x32_bf16 v[172:175], v[188:191], v[52:55], v[172:175]
v_cvt_pk_bf16_f32 v212, v120, v121
v_cvt_pk_bf16_f32 v213, v122, v123
v_mfma_f32_16x16x32_bf16 v[164:167], v[188:191], v[48:51], v[164:167]
ds_read_b64_tr_b16 v[188:189], v247 offset:18432
ds_read_b64_tr_b16 v[190:191], v247 offset:19456
v_mfma_f32_16x16x32_bf16 v[144:147], v[192:195], v[56:59], v[144:147]
v_mul_f32 v128, s73, v128
v_mul_f32 v129, s73, v129
v_mfma_f32_16x16x32_bf16 v[152:155], v[192:195], v[60:63], v[152:155]
ds_read_b64_tr_b16 v[192:193], v246 offset:20480
ds_read_b64_tr_b16 v[194:195], v246 offset:21504
v_mfma_f32_16x16x32_bf16 v[168:171], v[196:199], v[60:63], v[168:171]
v_mul_f32 v130, s73, v130
v_mul_f32 v131, s73, v131
v_mfma_f32_16x16x32_bf16 v[160:163], v[196:199], v[56:59], v[160:163]
ds_read_b64_tr_b16 v[196:197], v247 offset:20480
ds_read_b64_tr_b16 v[198:199], v247 offset:21504
v_mfma_f32_16x16x32_bf16 v[148:151], v[200:203], v[56:59], v[148:151]
v_mul_f32 v136, s73, v136
v_mul_f32 v137, s73, v137
v_mfma_f32_16x16x32_bf16 v[156:159], v[200:203], v[60:63], v[156:159]
ds_read_b64_tr_b16 v[200:201], v246 offset:22528
ds_read_b64_tr_b16 v[202:203], v246 offset:23552
v_mfma_f32_16x16x32_bf16 v[172:175], v[204:207], v[60:63], v[172:175]
v_mul_f32 v138, s73, v138
v_mul_f32 v139, s73, v139
v_mfma_f32_16x16x32_bf16 v[164:167], v[204:207], v[56:59], v[164:167]
ds_read_b64_tr_b16 v[204:205], v247 offset:22528
ds_read_b64_tr_b16 v[206:207], v247 offset:23552
s_setprio 0
v_exp_f32 v128, v128
s_add_u32 m0, s76, 16896
s_addk_i32 s96, 8192
buffer_load_dwordx4 v240, s[12:15], s96 offen lds
s_addk_i32 m0, 32
s_nop 0
buffer_load_dwordx4 v240, s[12:15], s96 offen offset:1024 lds
s_addk_i32 m0, 8416
s_addk_i32 s96, 8192
buffer_load_dwordx4 v240, s[12:15], s96 offen lds
s_addk_i32 m0, 32
s_nop 0
buffer_load_dwordx4 v240, s[12:15], s96 offen offset:1024 lds
s_add_u32 m0, s88, 143360
s_mov_b32 s82, 1376320
buffer_load_dwordx4 v241, s[28:31], s82 offen lds
s_addk_i32 m0, 1024
s_addk_i32 s82, 14336
buffer_load_dwordx4 v241, s[28:31], s82 offen lds
s_add_u32 m0, s77, 67584
s_addk_i32 s97, 8192
buffer_load_dwordx4 v240, s[16:19], s97 offen lds
s_addk_i32 m0, 32
s_nop 0
buffer_load_dwordx4 v240, s[16:19], s97 offen offset:1024 lds
s_addk_i32 m0, 8416
s_addk_i32 s97, 8192
buffer_load_dwordx4 v240, s[16:19], s97 offen lds
s_addk_i32 m0, 32
s_nop 0
buffer_load_dwordx4 v240, s[16:19], s97 offen offset:1024 lds
s_waitcnt vmcnt(15)
s_waitcnt lgkmcnt(0)
s_barrier
s_setprio 2
v_mfma_f32_16x16x32_bf16 v[144:147], v[176:179], v[64:67], v[144:147]
v_exp_f32_e64 v129, v129
v_mfma_f32_16x16x32_bf16 v[152:155], v[176:179], v[68:71], v[152:155]
ds_read_b64_tr_b16 v[176:177], v246 offset:0
ds_read_b64_tr_b16 v[178:179], v246 offset:1024
v_mfma_f32_16x16x32_bf16 v[168:171], v[180:183], v[68:71], v[168:171]
v_exp_f32_e64 v130, v130
v_mfma_f32_16x16x32_bf16 v[160:163], v[180:183], v[64:67], v[160:163]
ds_read_b64_tr_b16 v[180:181], v247 offset:0
ds_read_b64_tr_b16 v[182:183], v247 offset:1024
v_mfma_f32_16x16x32_bf16 v[148:151], v[184:187], v[64:67], v[148:151]
v_exp_f32_e64 v131, v131
v_mfma_f32_16x16x32_bf16 v[156:159], v[184:187], v[68:71], v[156:159]
ds_read_b64_tr_b16 v[184:185], v246 offset:2048
ds_read_b64_tr_b16 v[186:187], v246 offset:3072
v_mfma_f32_16x16x32_bf16 v[172:175], v[188:191], v[68:71], v[172:175]
v_exp_f32_e64 v136, v136
v_mfma_f32_16x16x32_bf16 v[164:167], v[188:191], v[64:67], v[164:167]
ds_read_b64_tr_b16 v[188:189], v247 offset:2048
ds_read_b64_tr_b16 v[190:191], v247 offset:3072
v_mfma_f32_16x16x32_bf16 v[144:147], v[192:195], v[72:75], v[144:147]
v_exp_f32_e64 v137, v137
v_mfma_f32_16x16x32_bf16 v[152:155], v[192:195], v[76:79], v[152:155]
ds_read_b64_tr_b16 v[192:193], v246 offset:4096
ds_read_b64_tr_b16 v[194:195], v246 offset:5120
v_mfma_f32_16x16x32_bf16 v[168:171], v[196:199], v[76:79], v[168:171]
v_exp_f32_e64 v138, v138
v_mfma_f32_16x16x32_bf16 v[160:163], v[196:199], v[72:75], v[160:163]
ds_read_b64_tr_b16 v[196:197], v247 offset:4096
ds_read_b64_tr_b16 v[198:199], v247 offset:5120
v_mfma_f32_16x16x32_bf16 v[148:151], v[200:203], v[72:75], v[148:151]
v_exp_f32_e64 v139, v139
v_mfma_f32_16x16x32_bf16 v[156:159], v[200:203], v[76:79], v[156:159]
ds_read_b64_tr_b16 v[200:201], v246 offset:6144
ds_read_b64_tr_b16 v[202:203], v246 offset:7168
v_mfma_f32_16x16x32_bf16 v[172:175], v[204:207], v[76:79], v[172:175]
v_add_f32 v128, 1.0, v128
v_add_f32 v129, 1.0, v129
v_mfma_f32_16x16x32_bf16 v[164:167], v[204:207], v[72:75], v[164:167]
ds_read_b64_tr_b16 v[204:205], v247 offset:6144
ds_read_b64_tr_b16 v[206:207], v247 offset:7168
s_setprio 0
s_add_u32 m0, s76, 33792
s_addk_i32 s96, 8192
buffer_load_dwordx4 v240, s[12:15], s96 offen lds
s_addk_i32 m0, 32
s_nop 0
buffer_load_dwordx4 v240, s[12:15], s96 offen offset:1024 lds
s_addk_i32 m0, 8416
s_addk_i32 s96, 8192
buffer_load_dwordx4 v240, s[12:15], s96 offen lds
s_addk_i32 m0, 32
s_nop 0
buffer_load_dwordx4 v240, s[12:15], s96 offen offset:1024 lds
s_add_u32 m0, s88, 151552
s_mov_b32 s82, 128
buffer_load_dwordx4 v241, s[28:31], s82 offen lds
s_addk_i32 m0, 1024
s_addk_i32 s82, 14336
buffer_load_dwordx4 v241, s[28:31], s82 offen lds
s_add_u32 m0, s77, 84480
s_addk_i32 s97, 8192
buffer_load_dwordx4 v240, s[16:19], s97 offen lds
s_addk_i32 m0, 32
s_nop 0
buffer_load_dwordx4 v240, s[16:19], s97 offen offset:1024 lds
s_addk_i32 m0, 8416
s_addk_i32 s97, 8192
buffer_load_dwordx4 v240, s[16:19], s97 offen lds
s_addk_i32 m0, 32
s_nop 0
buffer_load_dwordx4 v240, s[16:19], s97 offen offset:1024 lds
s_add_u32 s83, s89, 655360
buffer_load_dword v244, v243, s[44:47], s83 offen
s_waitcnt vmcnt(15)
s_waitcnt lgkmcnt(0)
s_barrier
s_setprio 2
v_mfma_f32_16x16x32_bf16 v[144:147], v[176:179], v[80:83], v[144:147]
v_add_f32 v130, 1.0, v130
v_add_f32_e64 v131, 1.0, v131
v_mfma_f32_16x16x32_bf16 v[152:155], v[176:179], v[84:87], v[152:155]
ds_read_b64_tr_b16 v[176:177], v246 offset:8192
ds_read_b64_tr_b16 v[178:179], v246 offset:9216
v_mfma_f32_16x16x32_bf16 v[168:171], v[180:183], v[84:87], v[168:171]
v_add_f32 v136, 1.0, v136
v_add_f32 v137, 1.0, v137
v_mfma_f32_16x16x32_bf16 v[160:163], v[180:183], v[80:83], v[160:163]
ds_read_b64_tr_b16 v[180:181], v247 offset:8192
ds_read_b64_tr_b16 v[182:183], v247 offset:9216
v_mfma_f32_16x16x32_bf16 v[148:151], v[184:187], v[80:83], v[148:151]
v_add_f32 v138, 1.0, v138
v_add_f32 v139, 1.0, v139
v_mfma_f32_16x16x32_bf16 v[156:159], v[184:187], v[84:87], v[156:159]
ds_read_b64_tr_b16 v[184:185], v246 offset:10240
ds_read_b64_tr_b16 v[186:187], v246 offset:11264
v_mfma_f32_16x16x32_bf16 v[172:175], v[188:191], v[84:87], v[172:175]
v_rcp_f32_e64 v128, v128
v_mfma_f32_16x16x32_bf16 v[164:167], v[188:191], v[80:83], v[164:167]
ds_read_b64_tr_b16 v[188:189], v247 offset:10240
ds_read_b64_tr_b16 v[190:191], v247 offset:11264
v_mfma_f32_16x16x32_bf16 v[144:147], v[192:195], v[88:91], v[144:147]
v_rcp_f32_e64 v129, v129
v_mfma_f32_16x16x32_bf16 v[152:155], v[192:195], v[92:95], v[152:155]
ds_read_b64_tr_b16 v[192:193], v246 offset:12288
ds_read_b64_tr_b16 v[194:195], v246 offset:13312
v_mfma_f32_16x16x32_bf16 v[168:171], v[196:199], v[92:95], v[168:171]
v_rcp_f32_e64 v130, v130
v_mfma_f32_16x16x32_bf16 v[160:163], v[196:199], v[88:91], v[160:163]
ds_read_b64_tr_b16 v[196:197], v247 offset:12288
ds_read_b64_tr_b16 v[198:199], v247 offset:13312
v_mfma_f32_16x16x32_bf16 v[148:151], v[200:203], v[88:91], v[148:151]
v_rcp_f32_e64 v131, v131
v_mfma_f32_16x16x32_bf16 v[156:159], v[200:203], v[92:95], v[156:159]
ds_read_b64_tr_b16 v[200:201], v246 offset:14336
ds_read_b64_tr_b16 v[202:203], v246 offset:15360
v_mfma_f32_16x16x32_bf16 v[172:175], v[204:207], v[92:95], v[172:175]
v_rcp_f32_e64 v136, v136
v_mfma_f32_16x16x32_bf16 v[164:167], v[204:207], v[88:91], v[164:167]
ds_read_b64_tr_b16 v[204:205], v247 offset:14336
ds_read_b64_tr_b16 v[206:207], v247 offset:15360
s_setprio 0
v_rcp_f32 v137, v137
s_add_u32 m0, s76, 50688
s_addk_i32 s96, 8192
buffer_load_dwordx4 v240, s[12:15], s96 offen lds
s_addk_i32 m0, 32
s_nop 0
buffer_load_dwordx4 v240, s[12:15], s96 offen offset:1024 lds
s_addk_i32 m0, 8416
s_addk_i32 s96, 8192
buffer_load_dwordx4 v240, s[12:15], s96 offen lds
s_addk_i32 m0, 32
s_nop 0
buffer_load_dwordx4 v240, s[12:15], s96 offen offset:1024 lds
s_add_u32 m0, s88, 135168
s_mov_b32 s82, 229504
buffer_load_dwordx4 v241, s[28:31], s82 offen lds
s_addk_i32 m0, 1024
s_addk_i32 s82, 14336
buffer_load_dwordx4 v241, s[28:31], s82 offen lds
s_add_u32 m0, s77, 101376
s_addk_i32 s97, 8192
buffer_load_dwordx4 v240, s[16:19], s97 offen lds
s_addk_i32 m0, 32
s_nop 0
buffer_load_dwordx4 v240, s[16:19], s97 offen offset:1024 lds
s_addk_i32 m0, 8416
s_addk_i32 s97, 8192
buffer_load_dwordx4 v240, s[16:19], s97 offen lds
s_addk_i32 m0, 32
s_nop 0
buffer_load_dwordx4 v240, s[16:19], s97 offen offset:1024 lds
s_waitcnt vmcnt(15)
s_waitcnt lgkmcnt(0)
s_barrier
s_setprio 2
v_mfma_f32_16x16x32_bf16 v[144:147], v[176:179], v[96:99], v[144:147]
v_rcp_f32_e64 v138, v138
v_mfma_f32_16x16x32_bf16 v[152:155], v[176:179], v[100:103], v[152:155]
ds_read_b64_tr_b16 v[176:177], v246 offset:16384
ds_read_b64_tr_b16 v[178:179], v246 offset:17408
v_mfma_f32_16x16x32_bf16 v[168:171], v[180:183], v[100:103], v[168:171]
v_rcp_f32_e64 v139, v139
v_mfma_f32_16x16x32_bf16 v[160:163], v[180:183], v[96:99], v[160:163]
ds_read_b64_tr_b16 v[180:181], v247 offset:16384
ds_read_b64_tr_b16 v[182:183], v247 offset:17408
v_mfma_f32_16x16x32_bf16 v[148:151], v[184:187], v[96:99], v[148:151]
v_mul_f32 v128, v128, v132
v_mul_f32 v129, v129, v133
v_mfma_f32_16x16x32_bf16 v[156:159], v[184:187], v[100:103], v[156:159]
ds_read_b64_tr_b16 v[184:185], v246 offset:18432
ds_read_b64_tr_b16 v[186:187], v246 offset:19456
v_mfma_f32_16x16x32_bf16 v[172:175], v[188:191], v[100:103], v[172:175]
v_mul_f32 v130, v130, v134
v_mul_f32 v131, v131, v135
v_mfma_f32_16x16x32_bf16 v[164:167], v[188:191], v[96:99], v[164:167]
ds_read_b64_tr_b16 v[188:189], v247 offset:18432
ds_read_b64_tr_b16 v[190:191], v247 offset:19456
v_mfma_f32_16x16x32_bf16 v[144:147], v[192:195], v[104:107], v[144:147]
v_mul_f32 v136, v136, v140
v_mul_f32 v137, v137, v141
v_mfma_f32_16x16x32_bf16 v[152:155], v[192:195], v[108:111], v[152:155]
ds_read_b64_tr_b16 v[192:193], v246 offset:20480
ds_read_b64_tr_b16 v[194:195], v246 offset:21504
v_mfma_f32_16x16x32_bf16 v[168:171], v[196:199], v[108:111], v[168:171]
v_mul_f32 v138, v138, v142
v_mul_f32 v139, v139, v143
v_mfma_f32_16x16x32_bf16 v[160:163], v[196:199], v[104:107], v[160:163]
ds_read_b64_tr_b16 v[196:197], v247 offset:20480
ds_read_b64_tr_b16 v[198:199], v247 offset:21504
v_mfma_f32_16x16x32_bf16 v[148:151], v[200:203], v[104:107], v[148:151]
v_cvt_pk_bf16_f32 v210, v128, v129
v_cvt_pk_bf16_f32 v211, v130, v131
v_mfma_f32_16x16x32_bf16 v[156:159], v[200:203], v[108:111], v[156:159]
ds_read_b64_tr_b16 v[200:201], v246 offset:22528
ds_read_b64_tr_b16 v[202:203], v246 offset:23552
v_mfma_f32_16x16x32_bf16 v[172:175], v[204:207], v[108:111], v[172:175]
v_cvt_pk_bf16_f32 v214, v136, v137
v_cvt_pk_bf16_f32 v215, v138, v139
v_mfma_f32_16x16x32_bf16 v[164:167], v[204:207], v[104:107], v[164:167]
ds_read_b64_tr_b16 v[204:205], v247 offset:22528
ds_read_b64_tr_b16 v[206:207], v247 offset:23552
s_setprio 0
s_add_u32 m0, s76, 0
s_addk_i32 s96, 8192
buffer_load_dwordx4 v240, s[12:15], s96 offen lds
s_addk_i32 m0, 32
s_nop 0
buffer_load_dwordx4 v240, s[12:15], s96 offen offset:1024 lds
s_addk_i32 m0, 8416
s_addk_i32 s96, 8192
buffer_load_dwordx4 v240, s[12:15], s96 offen lds
s_addk_i32 m0, 32
s_nop 0
buffer_load_dwordx4 v240, s[12:15], s96 offen offset:1024 lds
s_add_u32 m0, s88, 143360
s_mov_b32 s82, 458880
buffer_load_dwordx4 v241, s[28:31], s82 offen lds
s_addk_i32 m0, 1024
s_addk_i32 s82, 14336
buffer_load_dwordx4 v241, s[28:31], s82 offen lds
s_add_u32 m0, s77, 118272
s_addk_i32 s97, 8192
buffer_load_dwordx4 v240, s[16:19], s97 offen lds
s_addk_i32 m0, 32
s_nop 0
buffer_load_dwordx4 v240, s[16:19], s97 offen offset:1024 lds
s_addk_i32 m0, 8416
s_addk_i32 s97, 8192
buffer_load_dwordx4 v240, s[16:19], s97 offen lds
s_addk_i32 m0, 32
s_nop 0
buffer_load_dwordx4 v240, s[16:19], s97 offen offset:1024 lds
s_add_u32 s83, s89, 720896
buffer_load_dword v244, v243, s[44:47], s83 offen
s_waitcnt vmcnt(15)
s_waitcnt lgkmcnt(0)
s_barrier
s_setprio 2
v_mfma_f32_16x16x32_bf16 v[112:115], v[176:179], v[0:3], 0
v_mul_f32 v144, s73, v144
v_mul_f32 v145, s73, v145
v_mfma_f32_16x16x32_bf16 v[120:123], v[176:179], v[4:7], 0
ds_read_b64_tr_b16 v[176:177], v246 offset:0
ds_read_b64_tr_b16 v[178:179], v246 offset:1024
v_mfma_f32_16x16x32_bf16 v[136:139], v[180:183], v[4:7], 0
v_mul_f32 v146, s73, v146
v_mul_f32 v147, s73, v147
v_mfma_f32_16x16x32_bf16 v[128:131], v[180:183], v[0:3], 0
ds_read_b64_tr_b16 v[180:181], v247 offset:0
ds_read_b64_tr_b16 v[182:183], v247 offset:1024
v_mfma_f32_16x16x32_bf16 v[116:119], v[184:187], v[0:3], 0
v_mul_f32 v152, s73, v152
v_mul_f32 v153, s73, v153
v_mfma_f32_16x16x32_bf16 v[124:127], v[184:187], v[4:7], 0
ds_read_b64_tr_b16 v[184:185], v246 offset:2048
ds_read_b64_tr_b16 v[186:187], v246 offset:3072
v_mfma_f32_16x16x32_bf16 v[140:143], v[188:191], v[4:7], 0
v_mul_f32 v154, s73, v154
v_mul_f32 v155, s73, v155
v_mfma_f32_16x16x32_bf16 v[132:135], v[188:191], v[0:3], 0
ds_read_b64_tr_b16 v[188:189], v247 offset:2048
ds_read_b64_tr_b16 v[190:191], v247 offset:3072
v_mfma_f32_16x16x32_bf16 v[112:115], v[192:195], v[8:11], v[112:115]
v_exp_f32_e64 v144, v144
v_mfma_f32_16x16x32_bf16 v[120:123], v[192:195], v[12:15], v[120:123]
ds_read_b64_tr_b16 v[192:193], v246 offset:4096
ds_read_b64_tr_b16 v[194:195], v246 offset:5120
v_mfma_f32_16x16x32_bf16 v[136:139], v[196:199], v[12:15], v[136:139]
v_exp_f32_e64 v145, v145
v_mfma_f32_16x16x32_bf16 v[128:131], v[196:199], v[8:11], v[128:131]
ds_read_b64_tr_b16 v[196:197], v247 offset:4096
ds_read_b64_tr_b16 v[198:199], v247 offset:5120
v_mfma_f32_16x16x32_bf16 v[116:119], v[200:203], v[8:11], v[116:119]
v_exp_f32_e64 v146, v146
v_mfma_f32_16x16x32_bf16 v[124:127], v[200:203], v[12:15], v[124:127]
ds_read_b64_tr_b16 v[200:201], v246 offset:6144
ds_read_b64_tr_b16 v[202:203], v246 offset:7168
v_mfma_f32_16x16x32_bf16 v[140:143], v[204:207], v[12:15], v[140:143]
v_exp_f32_e64 v147, v147
v_mfma_f32_16x16x32_bf16 v[132:135], v[204:207], v[8:11], v[132:135]
ds_read_b64_tr_b16 v[204:205], v247 offset:6144
ds_read_b64_tr_b16 v[206:207], v247 offset:7168
s_setprio 0
v_exp_f32 v152, v152
s_add_u32 m0, s76, 16896
s_addk_i32 s96, 8192
buffer_load_dwordx4 v240, s[12:15], s96 offen lds
s_addk_i32 m0, 32
s_nop 0
buffer_load_dwordx4 v240, s[12:15], s96 offen offset:1024 lds
s_addk_i32 m0, 8416
s_addk_i32 s96, 8192
buffer_load_dwordx4 v240, s[12:15], s96 offen lds
s_addk_i32 m0, 32
s_nop 0
buffer_load_dwordx4 v240, s[12:15], s96 offen offset:1024 lds
s_add_u32 m0, s88, 151552
s_mov_b32 s82, 688256
buffer_load_dwordx4 v241, s[28:31], s82 offen lds
s_addk_i32 m0, 1024
s_addk_i32 s82, 14336
buffer_load_dwordx4 v241, s[28:31], s82 offen lds
s_add_u32 m0, s77, 67584
s_addk_i32 s97, 8192
buffer_load_dwordx4 v240, s[16:19], s97 offen lds
s_addk_i32 m0, 32
s_nop 0
buffer_load_dwordx4 v240, s[16:19], s97 offen offset:1024 lds
s_addk_i32 m0, 8416
s_addk_i32 s97, 8192
buffer_load_dwordx4 v240, s[16:19], s97 offen lds
s_addk_i32 m0, 32
s_nop 0
buffer_load_dwordx4 v240, s[16:19], s97 offen offset:1024 lds
s_waitcnt vmcnt(15)
s_waitcnt lgkmcnt(0)
s_barrier
s_setprio 2
v_mfma_f32_16x16x32_bf16 v[112:115], v[176:179], v[16:19], v[112:115]
v_exp_f32_e64 v153, v153
v_mfma_f32_16x16x32_bf16 v[120:123], v[176:179], v[20:23], v[120:123]
ds_read_b64_tr_b16 v[176:177], v246 offset:8192
ds_read_b64_tr_b16 v[178:179], v246 offset:9216
v_mfma_f32_16x16x32_bf16 v[136:139], v[180:183], v[20:23], v[136:139]
v_exp_f32_e64 v154, v154
v_mfma_f32_16x16x32_bf16 v[128:131], v[180:183], v[16:19], v[128:131]
ds_read_b64_tr_b16 v[180:181], v247 offset:8192
ds_read_b64_tr_b16 v[182:183], v247 offset:9216
v_mfma_f32_16x16x32_bf16 v[116:119], v[184:187], v[16:19], v[116:119]
v_exp_f32_e64 v155, v155
v_mfma_f32_16x16x32_bf16 v[124:127], v[184:187], v[20:23], v[124:127]
ds_read_b64_tr_b16 v[184:185], v246 offset:10240
ds_read_b64_tr_b16 v[186:187], v246 offset:11264
v_mfma_f32_16x16x32_bf16 v[140:143], v[188:191], v[20:23], v[140:143]
v_add_f32 v144, 1.0, v144
v_add_f32 v145, 1.0, v145
v_mfma_f32_16x16x32_bf16 v[132:135], v[188:191], v[16:19], v[132:135]
ds_read_b64_tr_b16 v[188:189], v247 offset:10240
ds_read_b64_tr_b16 v[190:191], v247 offset:11264
v_mfma_f32_16x16x32_bf16 v[112:115], v[192:195], v[24:27], v[112:115]
v_add_f32 v146, 1.0, v146
v_add_f32 v147, 1.0, v147
v_mfma_f32_16x16x32_bf16 v[120:123], v[192:195], v[28:31], v[120:123]
ds_read_b64_tr_b16 v[192:193], v246 offset:12288
ds_read_b64_tr_b16 v[194:195], v246 offset:13312
v_mfma_f32_16x16x32_bf16 v[136:139], v[196:199], v[28:31], v[136:139]
v_add_f32 v152, 1.0, v152
v_add_f32 v153, 1.0, v153
v_mfma_f32_16x16x32_bf16 v[128:131], v[196:199], v[24:27], v[128:131]
ds_read_b64_tr_b16 v[196:197], v247 offset:12288
ds_read_b64_tr_b16 v[198:199], v247 offset:13312
v_mfma_f32_16x16x32_bf16 v[116:119], v[200:203], v[24:27], v[116:119]
v_add_f32 v154, 1.0, v154
v_add_f32 v155, 1.0, v155
v_mfma_f32_16x16x32_bf16 v[124:127], v[200:203], v[28:31], v[124:127]
ds_read_b64_tr_b16 v[200:201], v246 offset:14336
ds_read_b64_tr_b16 v[202:203], v246 offset:15360
v_mfma_f32_16x16x32_bf16 v[140:143], v[204:207], v[28:31], v[140:143]
v_rcp_f32_e64 v144, v144
v_mfma_f32_16x16x32_bf16 v[132:135], v[204:207], v[24:27], v[132:135]
ds_read_b64_tr_b16 v[204:205], v247 offset:14336
ds_read_b64_tr_b16 v[206:207], v247 offset:15360
s_setprio 0
v_rcp_f32 v145, v145
s_add_u32 m0, s76, 33792
s_addk_i32 s96, 8192
buffer_load_dwordx4 v240, s[12:15], s96 offen lds
s_addk_i32 m0, 32
s_nop 0
buffer_load_dwordx4 v240, s[12:15], s96 offen offset:1024 lds
s_addk_i32 m0, 8416
s_addk_i32 s96, 8192
buffer_load_dwordx4 v240, s[12:15], s96 offen lds
s_addk_i32 m0, 32
s_nop 0
buffer_load_dwordx4 v240, s[12:15], s96 offen offset:1024 lds
s_add_u32 m0, s88, 135168
s_mov_b32 s82, 917632
buffer_load_dwordx4 v241, s[28:31], s82 offen lds
s_addk_i32 m0, 1024
s_addk_i32 s82, 14336
buffer_load_dwordx4 v241, s[28:31], s82 offen lds
s_add_u32 m0, s77, 84480
s_addk_i32 s97, 8192
buffer_load_dwordx4 v240, s[16:19], s97 offen lds
s_addk_i32 m0, 32
s_nop 0
buffer_load_dwordx4 v240, s[16:19], s97 offen offset:1024 lds
s_addk_i32 m0, 8416
s_addk_i32 s97, 8192
buffer_load_dwordx4 v240, s[16:19], s97 offen lds
s_addk_i32 m0, 32
s_nop 0
buffer_load_dwordx4 v240, s[16:19], s97 offen offset:1024 lds
s_add_u32 s83, s89, 786432
buffer_load_dword v244, v243, s[44:47], s83 offen
s_waitcnt vmcnt(15)
s_waitcnt lgkmcnt(0)
s_barrier
s_setprio 2
v_mfma_f32_16x16x32_bf16 v[112:115], v[176:179], v[32:35], v[112:115]
v_rcp_f32_e64 v146, v146
v_mfma_f32_16x16x32_bf16 v[120:123], v[176:179], v[36:39], v[120:123]
ds_read_b64_tr_b16 v[176:177], v246 offset:16384
ds_read_b64_tr_b16 v[178:179], v246 offset:17408
v_mfma_f32_16x16x32_bf16 v[136:139], v[180:183], v[36:39], v[136:139]
v_rcp_f32_e64 v147, v147
v_mfma_f32_16x16x32_bf16 v[128:131], v[180:183], v[32:35], v[128:131]
ds_read_b64_tr_b16 v[180:181], v247 offset:16384
ds_read_b64_tr_b16 v[182:183], v247 offset:17408
v_mfma_f32_16x16x32_bf16 v[116:119], v[184:187], v[32:35], v[116:119]
v_rcp_f32_e64 v152, v152
v_mfma_f32_16x16x32_bf16 v[124:127], v[184:187], v[36:39], v[124:127]
ds_read_b64_tr_b16 v[184:185], v246 offset:18432
ds_read_b64_tr_b16 v[186:187], v246 offset:19456
v_mfma_f32_16x16x32_bf16 v[140:143], v[188:191], v[36:39], v[140:143]
v_rcp_f32_e64 v153, v153
v_mfma_f32_16x16x32_bf16 v[132:135], v[188:191], v[32:35], v[132:135]
ds_read_b64_tr_b16 v[188:189], v247 offset:18432
ds_read_b64_tr_b16 v[190:191], v247 offset:19456
v_mfma_f32_16x16x32_bf16 v[112:115], v[192:195], v[40:43], v[112:115]
v_rcp_f32_e64 v154, v154
v_mfma_f32_16x16x32_bf16 v[120:123], v[192:195], v[44:47], v[120:123]
ds_read_b64_tr_b16 v[192:193], v246 offset:20480
ds_read_b64_tr_b16 v[194:195], v246 offset:21504
v_mfma_f32_16x16x32_bf16 v[136:139], v[196:199], v[44:47], v[136:139]
v_rcp_f32_e64 v155, v155
v_mfma_f32_16x16x32_bf16 v[128:131], v[196:199], v[40:43], v[128:131]
ds_read_b64_tr_b16 v[196:197], v247 offset:20480
ds_read_b64_tr_b16 v[198:199], v247 offset:21504
v_mfma_f32_16x16x32_bf16 v[116:119], v[200:203], v[40:43], v[116:119]
v_mul_f32 v144, v144, v148
v_mul_f32 v145, v145, v149
v_mfma_f32_16x16x32_bf16 v[124:127], v[200:203], v[44:47], v[124:127]
ds_read_b64_tr_b16 v[200:201], v246 offset:22528
ds_read_b64_tr_b16 v[202:203], v246 offset:23552
v_mfma_f32_16x16x32_bf16 v[140:143], v[204:207], v[44:47], v[140:143]
v_mul_f32 v146, v146, v150
v_mul_f32 v147, v147, v151
v_mfma_f32_16x16x32_bf16 v[132:135], v[204:207], v[40:43], v[132:135]
ds_read_b64_tr_b16 v[204:205], v247 offset:22528
ds_read_b64_tr_b16 v[206:207], v247 offset:23552
s_setprio 0
s_add_u32 m0, s76, 50688
s_addk_i32 s96, 8192
buffer_load_dwordx4 v240, s[12:15], s96 offen lds
s_addk_i32 m0, 32
s_nop 0
buffer_load_dwordx4 v240, s[12:15], s96 offen offset:1024 lds
s_addk_i32 m0, 8416
s_addk_i32 s96, 8192
buffer_load_dwordx4 v240, s[12:15], s96 offen lds
s_addk_i32 m0, 32
s_nop 0
buffer_load_dwordx4 v240, s[12:15], s96 offen offset:1024 lds
s_add_u32 m0, s88, 143360
s_mov_b32 s82, 1147008
buffer_load_dwordx4 v241, s[28:31], s82 offen lds
s_addk_i32 m0, 1024
s_addk_i32 s82, 14336
buffer_load_dwordx4 v241, s[28:31], s82 offen lds
s_add_u32 m0, s77, 101376
s_addk_i32 s97, 8192
buffer_load_dwordx4 v240, s[16:19], s97 offen lds
s_addk_i32 m0, 32
s_nop 0
buffer_load_dwordx4 v240, s[16:19], s97 offen offset:1024 lds
s_addk_i32 m0, 8416
s_addk_i32 s97, 8192
buffer_load_dwordx4 v240, s[16:19], s97 offen lds
s_addk_i32 m0, 32
s_nop 0
buffer_load_dwordx4 v240, s[16:19], s97 offen offset:1024 lds
s_waitcnt vmcnt(15)
s_waitcnt lgkmcnt(0)
s_barrier
s_setprio 2
v_mfma_f32_16x16x32_bf16 v[112:115], v[176:179], v[48:51], v[112:115]
v_mul_f32 v152, v152, v156
v_mul_f32_e64 v153, v153, v157
v_mfma_f32_16x16x32_bf16 v[120:123], v[176:179], v[52:55], v[120:123]
ds_read_b64_tr_b16 v[176:177], v246 offset:0
ds_read_b64_tr_b16 v[178:179], v246 offset:1024
v_mfma_f32_16x16x32_bf16 v[136:139], v[180:183], v[52:55], v[136:139]
v_mul_f32 v154, v154, v158
v_mul_f32 v155, v155, v159
v_mfma_f32_16x16x32_bf16 v[128:131], v[180:183], v[48:51], v[128:131]
ds_read_b64_tr_b16 v[180:181], v247 offset:0
ds_read_b64_tr_b16 v[182:183], v247 offset:1024
v_mfma_f32_16x16x32_bf16 v[116:119], v[184:187], v[48:51], v[116:119]
v_cvt_pk_bf16_f32 v216, v144, v145
v_cvt_pk_bf16_f32 v217, v146, v147
v_mfma_f32_16x16x32_bf16 v[124:127], v[184:187], v[52:55], v[124:127]
ds_read_b64_tr_b16 v[184:185], v246 offset:2048
ds_read_b64_tr_b16 v[186:187], v246 offset:3072
v_mfma_f32_16x16x32_bf16 v[140:143], v[188:191], v[52:55], v[140:143]
v_cvt_pk_bf16_f32 v220, v152, v153
v_cvt_pk_bf16_f32 v221, v154, v155
v_mfma_f32_16x16x32_bf16 v[132:135], v[188:191], v[48:51], v[132:135]
ds_read_b64_tr_b16 v[188:189], v247 offset:2048
ds_read_b64_tr_b16 v[190:191], v247 offset:3072
v_mfma_f32_16x16x32_bf16 v[112:115], v[192:195], v[56:59], v[112:115]
v_mul_f32 v160, s73, v160
v_mul_f32 v161, s73, v161
v_mfma_f32_16x16x32_bf16 v[120:123], v[192:195], v[60:63], v[120:123]
ds_read_b64_tr_b16 v[192:193], v246 offset:4096
ds_read_b64_tr_b16 v[194:195], v246 offset:5120
v_mfma_f32_16x16x32_bf16 v[136:139], v[196:199], v[60:63], v[136:139]
v_mul_f32 v162, s73, v162
v_mul_f32 v163, s73, v163
v_mfma_f32_16x16x32_bf16 v[128:131], v[196:199], v[56:59], v[128:131]
ds_read_b64_tr_b16 v[196:197], v247 offset:4096
ds_read_b64_tr_b16 v[198:199], v247 offset:5120
v_mfma_f32_16x16x32_bf16 v[116:119], v[200:203], v[56:59], v[116:119]
v_mul_f32 v168, s73, v168
v_mul_f32 v169, s73, v169
v_mfma_f32_16x16x32_bf16 v[124:127], v[200:203], v[60:63], v[124:127]
ds_read_b64_tr_b16 v[200:201], v246 offset:6144
ds_read_b64_tr_b16 v[202:203], v246 offset:7168
v_mfma_f32_16x16x32_bf16 v[140:143], v[204:207], v[60:63], v[140:143]
v_mul_f32 v170, s73, v170
v_mul_f32 v171, s73, v171
v_mfma_f32_16x16x32_bf16 v[132:135], v[204:207], v[56:59], v[132:135]
ds_read_b64_tr_b16 v[204:205], v247 offset:6144
ds_read_b64_tr_b16 v[206:207], v247 offset:7168
s_setprio 0
v_exp_f32 v160, v160
s_add_u32 m0, s76, 0
s_addk_i32 s96, 8192
buffer_load_dwordx4 v240, s[12:15], s96 offen lds
s_addk_i32 m0, 32
s_nop 0
buffer_load_dwordx4 v240, s[12:15], s96 offen offset:1024 lds
s_addk_i32 m0, 8416
s_addk_i32 s96, 8192
buffer_load_dwordx4 v240, s[12:15], s96 offen lds
s_addk_i32 m0, 32
s_nop 0
buffer_load_dwordx4 v240, s[12:15], s96 offen offset:1024 lds
s_add_u32 m0, s88, 151552
s_mov_b32 s82, 1376384
buffer_load_dwordx4 v241, s[28:31], s82 offen lds
s_addk_i32 m0, 1024
s_addk_i32 s82, 14336
buffer_load_dwordx4 v241, s[28:31], s82 offen lds
s_add_u32 m0, s77, 118272
s_addk_i32 s97, 8192
buffer_load_dwordx4 v240, s[16:19], s97 offen lds
s_addk_i32 m0, 32
s_nop 0
buffer_load_dwordx4 v240, s[16:19], s97 offen offset:1024 lds
s_addk_i32 m0, 8416
s_addk_i32 s97, 8192
buffer_load_dwordx4 v240, s[16:19], s97 offen lds
s_addk_i32 m0, 32
s_nop 0
buffer_load_dwordx4 v240, s[16:19], s97 offen offset:1024 lds
s_add_u32 s83, s89, 851968
buffer_load_dword v244, v243, s[44:47], s83 offen
s_waitcnt vmcnt(15)
s_waitcnt lgkmcnt(0)
s_barrier
s_setprio 2
v_mfma_f32_16x16x32_bf16 v[112:115], v[176:179], v[64:67], v[112:115]
v_exp_f32 v161, v161
v_mfma_f32_16x16x32_bf16 v[120:123], v[176:179], v[68:71], v[120:123]
ds_read_b64_tr_b16 v[176:177], v246 offset:8192
ds_read_b64_tr_b16 v[178:179], v246 offset:9216
v_mfma_f32_16x16x32_bf16 v[136:139], v[180:183], v[68:71], v[136:139]
v_exp_f32_e64 v162, v162
v_mfma_f32_16x16x32_bf16 v[128:131], v[180:183], v[64:67], v[128:131]
ds_read_b64_tr_b16 v[180:181], v247 offset:8192
ds_read_b64_tr_b16 v[182:183], v247 offset:9216
v_mfma_f32_16x16x32_bf16 v[116:119], v[184:187], v[64:67], v[116:119]
v_exp_f32_e64 v163, v163
v_mfma_f32_16x16x32_bf16 v[124:127], v[184:187], v[68:71], v[124:127]
ds_read_b64_tr_b16 v[184:185], v246 offset:10240
ds_read_b64_tr_b16 v[186:187], v246 offset:11264
v_mfma_f32_16x16x32_bf16 v[140:143], v[188:191], v[68:71], v[140:143]
v_exp_f32_e64 v168, v168
v_mfma_f32_16x16x32_bf16 v[132:135], v[188:191], v[64:67], v[132:135]
ds_read_b64_tr_b16 v[188:189], v247 offset:10240
ds_read_b64_tr_b16 v[190:191], v247 offset:11264
v_mfma_f32_16x16x32_bf16 v[112:115], v[192:195], v[72:75], v[112:115]
v_exp_f32_e64 v169, v169
v_mfma_f32_16x16x32_bf16 v[120:123], v[192:195], v[76:79], v[120:123]
ds_read_b64_tr_b16 v[192:193], v246 offset:12288
ds_read_b64_tr_b16 v[194:195], v246 offset:13312
v_mfma_f32_16x16x32_bf16 v[136:139], v[196:199], v[76:79], v[136:139]
v_exp_f32_e64 v170, v170
v_mfma_f32_16x16x32_bf16 v[128:131], v[196:199], v[72:75], v[128:131]
ds_read_b64_tr_b16 v[196:197], v247 offset:12288
ds_read_b64_tr_b16 v[198:199], v247 offset:13312
v_mfma_f32_16x16x32_bf16 v[116:119], v[200:203], v[72:75], v[116:119]
v_exp_f32_e64 v171, v171
v_mfma_f32_16x16x32_bf16 v[124:127], v[200:203], v[76:79], v[124:127]
ds_read_b64_tr_b16 v[200:201], v246 offset:14336
ds_read_b64_tr_b16 v[202:203], v246 offset:15360
v_mfma_f32_16x16x32_bf16 v[140:143], v[204:207], v[76:79], v[140:143]
v_add_f32 v160, 1.0, v160
v_add_f32 v161, 1.0, v161
v_mfma_f32_16x16x32_bf16 v[132:135], v[204:207], v[72:75], v[132:135]
ds_read_b64_tr_b16 v[204:205], v247 offset:14336
ds_read_b64_tr_b16 v[206:207], v247 offset:15360
s_setprio 0
s_add_u32 m0, s76, 16896
s_addk_i32 s96, 8192
buffer_load_dwordx4 v240, s[12:15], s96 offen lds
s_addk_i32 m0, 32
s_nop 0
buffer_load_dwordx4 v240, s[12:15], s96 offen offset:1024 lds
s_addk_i32 m0, 8416
s_addk_i32 s96, 8192
buffer_load_dwordx4 v240, s[12:15], s96 offen lds
s_addk_i32 m0, 32
s_nop 0
buffer_load_dwordx4 v240, s[12:15], s96 offen offset:1024 lds
s_cmp_lg_u32 s99, 0
s_cselect_b32 s30, 0, s30
s_add_u32 m0, s88, 135168
s_mov_b32 s82, 192
buffer_load_dwordx4 v241, s[28:31], s82 offen lds
s_addk_i32 m0, 1024
s_addk_i32 s82, 14336
buffer_load_dwordx4 v241, s[28:31], s82 offen lds
s_add_u32 m0, s77, 67584
s_addk_i32 s97, 8192
buffer_load_dwordx4 v240, s[16:19], s97 offen lds
s_addk_i32 m0, 32
s_nop 0
buffer_load_dwordx4 v240, s[16:19], s97 offen offset:1024 lds
s_addk_i32 m0, 8416
s_addk_i32 s97, 8192
buffer_load_dwordx4 v240, s[16:19], s97 offen lds
s_addk_i32 m0, 32
s_nop 0
buffer_load_dwordx4 v240, s[16:19], s97 offen offset:1024 lds
s_waitcnt vmcnt(15)
s_waitcnt lgkmcnt(0)
s_barrier
s_setprio 2
v_mfma_f32_16x16x32_bf16 v[112:115], v[176:179], v[80:83], v[112:115]
v_add_f32 v162, 1.0, v162
v_add_f32_e64 v163, 1.0, v163
v_mfma_f32_16x16x32_bf16 v[120:123], v[176:179], v[84:87], v[120:123]
ds_read_b64_tr_b16 v[176:177], v246 offset:16384
ds_read_b64_tr_b16 v[178:179], v246 offset:17408
v_mfma_f32_16x16x32_bf16 v[136:139], v[180:183], v[84:87], v[136:139]
v_add_f32 v168, 1.0, v168
v_add_f32 v169, 1.0, v169
v_mfma_f32_16x16x32_bf16 v[128:131], v[180:183], v[80:83], v[128:131]
ds_read_b64_tr_b16 v[180:181], v247 offset:16384
ds_read_b64_tr_b16 v[182:183], v247 offset:17408
v_mfma_f32_16x16x32_bf16 v[116:119], v[184:187], v[80:83], v[116:119]
v_add_f32 v170, 1.0, v170
v_add_f32 v171, 1.0, v171
v_mfma_f32_16x16x32_bf16 v[124:127], v[184:187], v[84:87], v[124:127]
ds_read_b64_tr_b16 v[184:185], v246 offset:18432
ds_read_b64_tr_b16 v[186:187], v246 offset:19456
v_mfma_f32_16x16x32_bf16 v[140:143], v[188:191], v[84:87], v[140:143]
v_rcp_f32_e64 v160, v160
v_mfma_f32_16x16x32_bf16 v[132:135], v[188:191], v[80:83], v[132:135]
ds_read_b64_tr_b16 v[188:189], v247 offset:18432
ds_read_b64_tr_b16 v[190:191], v247 offset:19456
v_mfma_f32_16x16x32_bf16 v[112:115], v[192:195], v[88:91], v[112:115]
v_rcp_f32_e64 v161, v161
v_mfma_f32_16x16x32_bf16 v[120:123], v[192:195], v[92:95], v[120:123]
ds_read_b64_tr_b16 v[192:193], v246 offset:20480
ds_read_b64_tr_b16 v[194:195], v246 offset:21504
v_mfma_f32_16x16x32_bf16 v[136:139], v[196:199], v[92:95], v[136:139]
v_rcp_f32_e64 v162, v162
v_mfma_f32_16x16x32_bf16 v[128:131], v[196:199], v[88:91], v[128:131]
ds_read_b64_tr_b16 v[196:197], v247 offset:20480
ds_read_b64_tr_b16 v[198:199], v247 offset:21504
v_mfma_f32_16x16x32_bf16 v[116:119], v[200:203], v[88:91], v[116:119]
v_rcp_f32_e64 v163, v163
v_mfma_f32_16x16x32_bf16 v[124:127], v[200:203], v[92:95], v[124:127]
ds_read_b64_tr_b16 v[200:201], v246 offset:22528
ds_read_b64_tr_b16 v[202:203], v246 offset:23552
v_mfma_f32_16x16x32_bf16 v[140:143], v[204:207], v[92:95], v[140:143]
v_rcp_f32_e64 v168, v168
v_mfma_f32_16x16x32_bf16 v[132:135], v[204:207], v[88:91], v[132:135]
ds_read_b64_tr_b16 v[204:205], v247 offset:22528
ds_read_b64_tr_b16 v[206:207], v247 offset:23552
s_setprio 0
v_rcp_f32 v169, v169
s_add_u32 m0, s76, 33792
s_addk_i32 s96, 8192
buffer_load_dwordx4 v240, s[12:15], s96 offen lds
s_addk_i32 m0, 32
s_nop 0
buffer_load_dwordx4 v240, s[12:15], s96 offen offset:1024 lds
s_addk_i32 m0, 8416
s_addk_i32 s96, 8192
buffer_load_dwordx4 v240, s[12:15], s96 offen lds
s_addk_i32 m0, 32
s_nop 0
buffer_load_dwordx4 v240, s[12:15], s96 offen offset:1024 lds
s_add_u32 m0, s88, 143360
s_mov_b32 s82, 229568
buffer_load_dwordx4 v241, s[28:31], s82 offen lds
s_addk_i32 m0, 1024
s_addk_i32 s82, 14336
buffer_load_dwordx4 v241, s[28:31], s82 offen lds
s_add_u32 m0, s77, 84480
s_addk_i32 s97, 8192
buffer_load_dwordx4 v240, s[16:19], s97 offen lds
s_addk_i32 m0, 32
s_nop 0
buffer_load_dwordx4 v240, s[16:19], s97 offen offset:1024 lds
s_addk_i32 m0, 8416
s_addk_i32 s97, 8192
buffer_load_dwordx4 v240, s[16:19], s97 offen lds
s_addk_i32 m0, 32
s_nop 0
buffer_load_dwordx4 v240, s[16:19], s97 offen offset:1024 lds
s_add_u32 s83, s89, 917504
buffer_load_dword v244, v243, s[44:47], s83 offen
s_waitcnt vmcnt(15)
s_waitcnt lgkmcnt(0)
s_barrier
s_setprio 2
v_mfma_f32_16x16x32_bf16 v[112:115], v[176:179], v[96:99], v[112:115]
v_rcp_f32_e64 v170, v170
v_mfma_f32_16x16x32_bf16 v[120:123], v[176:179], v[100:103], v[120:123]
ds_read_b64_tr_b16 v[176:177], v246 offset:0
ds_read_b64_tr_b16 v[178:179], v246 offset:1024
v_mfma_f32_16x16x32_bf16 v[136:139], v[180:183], v[100:103], v[136:139]
v_rcp_f32_e64 v171, v171
v_mfma_f32_16x16x32_bf16 v[128:131], v[180:183], v[96:99], v[128:131]
ds_read_b64_tr_b16 v[180:181], v247 offset:0
ds_read_b64_tr_b16 v[182:183], v247 offset:1024
v_mfma_f32_16x16x32_bf16 v[116:119], v[184:187], v[96:99], v[116:119]
v_mul_f32 v160, v160, v164
v_mul_f32 v161, v161, v165
v_mfma_f32_16x16x32_bf16 v[124:127], v[184:187], v[100:103], v[124:127]
ds_read_b64_tr_b16 v[184:185], v246 offset:2048
ds_read_b64_tr_b16 v[186:187], v246 offset:3072
v_mfma_f32_16x16x32_bf16 v[140:143], v[188:191], v[100:103], v[140:143]
v_mul_f32 v162, v162, v166
v_mul_f32 v163, v163, v167
v_mfma_f32_16x16x32_bf16 v[132:135], v[188:191], v[96:99], v[132:135]
ds_read_b64_tr_b16 v[188:189], v247 offset:2048
ds_read_b64_tr_b16 v[190:191], v247 offset:3072
v_mfma_f32_16x16x32_bf16 v[112:115], v[192:195], v[104:107], v[112:115]
v_mul_f32 v168, v168, v172
v_mul_f32 v169, v169, v173
v_mfma_f32_16x16x32_bf16 v[120:123], v[192:195], v[108:111], v[120:123]
ds_read_b64_tr_b16 v[192:193], v246 offset:4096
ds_read_b64_tr_b16 v[194:195], v246 offset:5120
v_mfma_f32_16x16x32_bf16 v[136:139], v[196:199], v[108:111], v[136:139]
v_mul_f32 v170, v170, v174
v_mul_f32 v171, v171, v175
v_mfma_f32_16x16x32_bf16 v[128:131], v[196:199], v[104:107], v[128:131]
ds_read_b64_tr_b16 v[196:197], v247 offset:4096
ds_read_b64_tr_b16 v[198:199], v247 offset:5120
v_mfma_f32_16x16x32_bf16 v[116:119], v[200:203], v[104:107], v[116:119]
v_cvt_pk_bf16_f32 v218, v160, v161
v_cvt_pk_bf16_f32 v219, v162, v163
v_mfma_f32_16x16x32_bf16 v[124:127], v[200:203], v[108:111], v[124:127]
ds_read_b64_tr_b16 v[200:201], v246 offset:6144
ds_read_b64_tr_b16 v[202:203], v246 offset:7168
v_mfma_f32_16x16x32_bf16 v[140:143], v[204:207], v[108:111], v[140:143]
v_cvt_pk_bf16_f32 v222, v168, v169
v_cvt_pk_bf16_f32 v223, v170, v171
v_mfma_f32_16x16x32_bf16 v[132:135], v[204:207], v[104:107], v[132:135]
ds_read_b64_tr_b16 v[204:205], v247 offset:6144
ds_read_b64_tr_b16 v[206:207], v247 offset:7168
s_setprio 0
s_add_u32 m0, s76, 50688
s_addk_i32 s96, 8192
buffer_load_dwordx4 v240, s[12:15], s96 offen lds
s_addk_i32 m0, 32
s_nop 0
buffer_load_dwordx4 v240, s[12:15], s96 offen offset:1024 lds
s_addk_i32 m0, 8416
s_addk_i32 s96, 8192
buffer_load_dwordx4 v240, s[12:15], s96 offen lds
s_addk_i32 m0, 32
s_nop 0
buffer_load_dwordx4 v240, s[12:15], s96 offen offset:1024 lds
s_add_u32 m0, s88, 151552
s_mov_b32 s82, 458944
buffer_load_dwordx4 v241, s[28:31], s82 offen lds
s_addk_i32 m0, 1024
s_addk_i32 s82, 14336
buffer_load_dwordx4 v241, s[28:31], s82 offen lds
s_add_u32 m0, s77, 101376
s_addk_i32 s97, 8192
buffer_load_dwordx4 v240, s[16:19], s97 offen lds
s_addk_i32 m0, 32
s_nop 0
buffer_load_dwordx4 v240, s[16:19], s97 offen offset:1024 lds
s_addk_i32 m0, 8416
s_addk_i32 s97, 8192
buffer_load_dwordx4 v240, s[16:19], s97 offen lds
s_addk_i32 m0, 32
s_nop 0
buffer_load_dwordx4 v240, s[16:19], s97 offen offset:1024 lds
s_waitcnt vmcnt(15)
s_waitcnt lgkmcnt(0)
s_barrier
s_cmp_lg_u32 s99, 0
s_cbranch_scc0 L_bg21
v_mul_f32 v112, s73, v112
v_mul_f32 v113, s73, v113
v_mul_f32 v114, s73, v114
v_mul_f32 v115, s73, v115
v_mul_f32 v120, s73, v120
v_mul_f32 v121, s73, v121
v_mul_f32 v122, s73, v122
v_mul_f32 v123, s73, v123
v_exp_f32 v112, v112
v_exp_f32 v113, v113
v_exp_f32 v114, v114
v_exp_f32 v115, v115
v_exp_f32_e64 v120, v120
s_branch L_be21
L_bg21:
s_setprio 2
v_mfma_f32_16x16x32_bf16 v[144:147], v[176:179], v[0:3], 0
v_mul_f32 v112, s73, v112
v_mul_f32 v113, s73, v113
v_mfma_f32_16x16x32_bf16 v[152:155], v[176:179], v[4:7], 0
ds_read_b64_tr_b16 v[176:177], v246 offset:8192
ds_read_b64_tr_b16 v[178:179], v246 offset:9216
v_mfma_f32_16x16x32_bf16 v[168:171], v[180:183], v[4:7], 0
v_mul_f32 v114, s73, v114
v_mul_f32 v115, s73, v115
v_mfma_f32_16x16x32_bf16 v[160:163], v[180:183], v[0:3], 0
ds_read_b64_tr_b16 v[180:181], v247 offset:8192
ds_read_b64_tr_b16 v[182:183], v247 offset:9216
v_mfma_f32_16x16x32_bf16 v[148:151], v[184:187], v[0:3], 0
v_mul_f32 v120, s73, v120
v_mul_f32 v121, s73, v121
v_mfma_f32_16x16x32_bf16 v[156:159], v[184:187], v[4:7], 0
ds_read_b64_tr_b16 v[184:185], v246 offset:10240
ds_read_b64_tr_b16 v[186:187], v246 offset:11264
v_mfma_f32_16x16x32_bf16 v[172:175], v[188:191], v[4:7], 0
v_mul_f32 v122, s73, v122
v_mul_f32 v123, s73, v123
v_mfma_f32_16x16x32_bf16 v[164:167], v[188:191], v[0:3], 0
ds_read_b64_tr_b16 v[188:189], v247 offset:10240
ds_read_b64_tr_b16 v[190:191], v247 offset:11264
v_mfma_f32_16x16x32_bf16 v[144:147], v[192:195], v[8:11], v[144:147]
v_exp_f32_e64 v112, v112
v_mfma_f32_16x16x32_bf16 v[152:155], v[192:195], v[12:15], v[152:155]
ds_read_b64_tr_b16 v[192:193], v246 offset:12288
ds_read_b64_tr_b16 v[194:195], v246 offset:13312
v_mfma_f32_16x16x32_bf16 v[168:171], v[196:199], v[12:15], v[168:171]
v_exp_f32_e64 v113, v113
v_mfma_f32_16x16x32_bf16 v[160:163], v[196:199], v[8:11], v[160:163]
ds_read_b64_tr_b16 v[196:197], v247 offset:12288
ds_read_b64_tr_b16 v[198:199], v247 offset:13312
v_mfma_f32_16x16x32_bf16 v[148:151], v[200:203], v[8:11], v[148:151]
v_exp_f32_e64 v114, v114
v_mfma_f32_16x16x32_bf16 v[156:159], v[200:203], v[12:15], v[156:159]
ds_read_b64_tr_b16 v[200:201], v246 offset:14336
ds_read_b64_tr_b16 v[202:203], v246 offset:15360
v_mfma_f32_16x16x32_bf16 v[172:175], v[204:207], v[12:15], v[172:175]
v_exp_f32_e64 v115, v115
v_mfma_f32_16x16x32_bf16 v[164:167], v[204:207], v[8:11], v[164:167]
ds_read_b64_tr_b16 v[204:205], v247 offset:14336
ds_read_b64_tr_b16 v[206:207], v247 offset:15360
s_setprio 0
v_exp_f32 v120, v120
L_be21:
s_add_u32 m0, s76, 0
s_addk_i32 s96, 8192
buffer_load_dwordx4 v240, s[12:15], s96 offen lds
s_addk_i32 m0, 32
s_nop 0
buffer_load_dwordx4 v240, s[12:15], s96 offen offset:1024 lds
s_addk_i32 m0, 8416
s_addk_i32 s96, 8192
buffer_load_dwordx4 v240, s[12:15], s96 offen lds
s_addk_i32 m0, 32
s_nop 0
buffer_load_dwordx4 v240, s[12:15], s96 offen offset:1024 lds
s_add_u32 m0, s88, 135168
s_mov_b32 s82, 688320
buffer_load_dwordx4 v241, s[28:31], s82 offen lds
s_addk_i32 m0, 1024
s_addk_i32 s82, 14336
buffer_load_dwordx4 v241, s[28:31], s82 offen lds
s_add_u32 m0, s77, 118272
s_addk_i32 s97, 8192
buffer_load_dwordx4 v240, s[16:19], s97 offen lds
s_addk_i32 m0, 32
s_nop 0
buffer_load_dwordx4 v240, s[16:19], s97 offen offset:1024 lds
s_addk_i32 m0, 8416
s_addk_i32 s97, 8192
buffer_load_dwordx4 v240, s[16:19], s97 offen lds
s_addk_i32 m0, 32
s_nop 0
buffer_load_dwordx4 v240, s[16:19], s97 offen offset:1024 lds
s_add_u32 s83, s89, 983040
buffer_load_dword v244, v243, s[44:47], s83 offen
s_waitcnt vmcnt(15)
s_waitcnt lgkmcnt(0)
s_barrier
s_cmp_lg_u32 s99, 0
s_cbranch_scc0 L_bg22
v_exp_f32 v121, v121
v_exp_f32 v122, v122
v_exp_f32 v123, v123
v_add_f32 v112, 1.0, v112
v_add_f32 v113, 1.0, v113
v_add_f32 v114, 1.0, v114
v_add_f32 v115, 1.0, v115
v_add_f32 v120, 1.0, v120
v_add_f32 v121, 1.0, v121
v_add_f32 v122, 1.0, v122
v_add_f32 v123, 1.0, v123
v_rcp_f32 v112, v112
v_rcp_f32_e64 v113, v113
s_branch L_be22
L_bg22:
s_setprio 2
v_mfma_f32_16x16x32_bf16 v[144:147], v[176:179], v[16:19], v[144:147]
v_exp_f32_e64 v121, v121
v_mfma_f32_16x16x32_bf16 v[152:155], v[176:179], v[20:23], v[152:155]
ds_read_b64_tr_b16 v[176:177], v246 offset:16384
ds_read_b64_tr_b16 v[178:179], v246 offset:17408
v_mfma_f32_16x16x32_bf16 v[168:171], v[180:183], v[20:23], v[168:171]
v_exp_f32_e64 v122, v122
v_mfma_f32_16x16x32_bf16 v[160:163], v[180:183], v[16:19], v[160:163]
ds_read_b64_tr_b16 v[180:181], v247 offset:16384
ds_read_b64_tr_b16 v[182:183], v247 offset:17408
v_mfma_f32_16x16x32_bf16 v[148:151], v[184:187], v[16:19], v[148:151]
v_exp_f32_e64 v123, v123
v_mfma_f32_16x16x32_bf16 v[156:159], v[184:187], v[20:23], v[156:159]
ds_read_b64_tr_b16 v[184:185], v246 offset:18432
ds_read_b64_tr_b16 v[186:187], v246 offset:19456
v_mfma_f32_16x16x32_bf16 v[172:175], v[188:191], v[20:23], v[172:175]
v_add_f32 v112, 1.0, v112
v_add_f32 v113, 1.0, v113
v_mfma_f32_16x16x32_bf16 v[164:167], v[188:191], v[16:19], v[164:167]
ds_read_b64_tr_b16 v[188:189], v247 offset:18432
ds_read_b64_tr_b16 v[190:191], v247 offset:19456
v_mfma_f32_16x16x32_bf16 v[144:147], v[192:195], v[24:27], v[144:147]
v_add_f32 v114, 1.0, v114
v_add_f32 v115, 1.0, v115
v_mfma_f32_16x16x32_bf16 v[152:155], v[192:195], v[28:31], v[152:155]
ds_read_b64_tr_b16 v[192:193], v246 offset:20480
ds_read_b64_tr_b16 v[194:195], v246 offset:21504
v_mfma_f32_16x16x32_bf16 v[168:171], v[196:199], v[28:31], v[168:171]
v_add_f32 v120, 1.0, v120
v_add_f32 v121, 1.0, v121
v_mfma_f32_16x16x32_bf16 v[160:163], v[196:199], v[24:27], v[160:163]
ds_read_b64_tr_b16 v[196:197], v247 offset:20480
ds_read_b64_tr_b16 v[198:199], v247 offset:21504
v_mfma_f32_16x16x32_bf16 v[148:151], v[200:203], v[24:27], v[148:151]
v_add_f32 v122, 1.0, v122
v_add_f32 v123, 1.0, v123
v_mfma_f32_16x16x32_bf16 v[156:159], v[200:203], v[28:31], v[156:159]
ds_read_b64_tr_b16 v[200:201], v246 offset:22528
ds_read_b64_tr_b16 v[202:203], v246 offset:23552
v_mfma_f32_16x16x32_bf16 v[172:175], v[204:207], v[28:31], v[172:175]
v_rcp_f32_e64 v112, v112
v_mfma_f32_16x16x32_bf16 v[164:167], v[204:207], v[24:27], v[164:167]
ds_read_b64_tr_b16 v[204:205], v247 offset:22528
ds_read_b64_tr_b16 v[206:207], v247 offset:23552
s_setprio 0
v_rcp_f32 v113, v113
L_be22:
s_add_u32 m0, s76, 16896
s_addk_i32 s96, 8192
buffer_load_dwordx4 v240, s[12:15], s96 offen lds
s_addk_i32 m0, 32
s_nop 0
buffer_load_dwordx4 v240, s[12:15], s96 offen offset:1024 lds
s_addk_i32 m0, 8416
s_addk_i32 s96, 8192
buffer_load_dwordx4 v240, s[12:15], s96 offen lds
s_addk_i32 m0, 32
s_nop 0
buffer_load_dwordx4 v240, s[12:15], s96 offen offset:1024 lds
s_add_u32 m0, s88, 143360
s_mov_b32 s82, 917696
buffer_load_dwordx4 v241, s[28:31], s82 offen lds
s_addk_i32 m0, 1024
s_addk_i32 s82, 14336
buffer_load_dwordx4 v241, s[28:31], s82 offen lds
s_add_u32 m0, s77, 67584
s_addk_i32 s97, 8192
buffer_load_dwordx4 v240, s[16:19], s97 offen lds
s_addk_i32 m0, 32
s_nop 0
buffer_load_dwordx4 v240, s[16:19], s97 offen offset:1024 lds
s_addk_i32 m0, 8416
s_addk_i32 s97, 8192
buffer_load_dwordx4 v240, s[16:19], s97 offen lds
s_addk_i32 m0, 32
s_nop 0
buffer_load_dwordx4 v240, s[16:19], s97 offen offset:1024 lds
s_waitcnt vmcnt(15)
s_waitcnt lgkmcnt(0)
s_barrier
s_cmp_lg_u32 s99, 0
s_cbranch_scc0 L_bg23
v_rcp_f32 v114, v114
v_rcp_f32 v115, v115
v_rcp_f32 v120, v120
v_rcp_f32 v121, v121
v_rcp_f32 v122, v122
v_rcp_f32 v123, v123
v_mul_f32 v112, v112, v116
v_mul_f32 v113, v113, v117
v_mul_f32 v114, v114, v118
v_mul_f32_e64 v115, v115, v119
s_branch L_be23
L_bg23:
s_setprio 2
v_mfma_f32_16x16x32_bf16 v[144:147], v[176:179], v[32:35], v[144:147]
v_rcp_f32_e64 v114, v114
v_mfma_f32_16x16x32_bf16 v[152:155], v[176:179], v[36:39], v[152:155]
ds_read_b64_tr_b16 v[176:177], v246 offset:0
ds_read_b64_tr_b16 v[178:179], v246 offset:1024
v_mfma_f32_16x16x32_bf16 v[168:171], v[180:183], v[36:39], v[168:171]
v_rcp_f32_e64 v115, v115
v_mfma_f32_16x16x32_bf16 v[160:163], v[180:183], v[32:35], v[160:163]
ds_read_b64_tr_b16 v[180:181], v247 offset:0
ds_read_b64_tr_b16 v[182:183], v247 offset:1024
v_mfma_f32_16x16x32_bf16 v[148:151], v[184:187], v[32:35], v[148:151]
v_rcp_f32_e64 v120, v120
v_mfma_f32_16x16x32_bf16 v[156:159], v[184:187], v[36:39], v[156:159]
ds_read_b64_tr_b16 v[184:185], v246 offset:2048
ds_read_b64_tr_b16 v[186:187], v246 offset:3072
v_mfma_f32_16x16x32_bf16 v[172:175], v[188:191], v[36:39], v[172:175]
v_rcp_f32_e64 v121, v121
v_mfma_f32_16x16x32_bf16 v[164:167], v[188:191], v[32:35], v[164:167]
ds_read_b64_tr_b16 v[188:189], v247 offset:2048
ds_read_b64_tr_b16 v[190:191], v247 offset:3072
v_mfma_f32_16x16x32_bf16 v[144:147], v[192:195], v[40:43], v[144:147]
v_rcp_f32_e64 v122, v122
v_mfma_f32_16x16x32_bf16 v[152:155], v[192:195], v[44:47], v[152:155]
ds_read_b64_tr_b16 v[192:193], v246 offset:4096
ds_read_b64_tr_b16 v[194:195], v246 offset:5120
v_mfma_f32_16x16x32_bf16 v[168:171], v[196:199], v[44:47], v[168:171]
v_rcp_f32_e64 v123, v123
v_mfma_f32_16x16x32_bf16 v[160:163], v[196:199], v[40:43], v[160:163]
ds_read_b64_tr_b16 v[196:197], v247 offset:4096
ds_read_b64_tr_b16 v[198:199], v247 offset:5120
v_mfma_f32_16x16x32_bf16 v[148:151], v[200:203], v[40:43], v[148:151]
v_mul_f32 v112, v112, v116
v_mul_f32 v113, v113, v117
v_mfma_f32_16x16x32_bf16 v[156:159], v[200:203], v[44:47], v[156:159]
ds_read_b64_tr_b16 v[200:201], v246 offset:6144
ds_read_b64_tr_b16 v[202:203], v246 offset:7168
v_mfma_f32_16x16x32_bf16 v[172:175], v[204:207], v[44:47], v[172:175]
v_mul_f32 v114, v114, v118
v_mul_f32 v115, v115, v119
v_mfma_f32_16x16x32_bf16 v[164:167], v[204:207], v[40:43], v[164:167]
ds_read_b64_tr_b16 v[204:205], v247 offset:6144
ds_read_b64_tr_b16 v[206:207], v247 offset:7168
s_setprio 0
L_be23:
s_add_u32 m0, s76, 33792
s_addk_i32 s96, 8192
buffer_load_dwordx4 v240, s[12:15], s96 offen lds
s_addk_i32 m0, 32
s_nop 0
buffer_load_dwordx4 v240, s[12:15], s96 offen offset:1024 lds
s_addk_i32 m0, 8416
s_addk_i32 s96, 8192
buffer_load_dwordx4 v240, s[12:15], s96 offen lds
s_addk_i32 m0, 32
s_nop 0
buffer_load_dwordx4 v240, s[12:15], s96 offen offset:1024 lds
s_add_u32 m0, s88, 151552
s_mov_b32 s82, 1147072
buffer_load_dwordx4 v241, s[28:31], s82 offen lds
s_addk_i32 m0, 1024
s_addk_i32 s82, 14336
buffer_load_dwordx4 v241, s[28:31], s82 offen lds
s_add_u32 m0, s77, 84480
s_addk_i32 s97, 8192
buffer_load_dwordx4 v240, s[16:19], s97 offen lds
s_addk_i32 m0, 32
s_nop 0
buffer_load_dwordx4 v240, s[16:19], s97 offen offset:1024 lds
s_addk_i32 m0, 8416
s_addk_i32 s97, 8192
buffer_load_dwordx4 v240, s[16:19], s97 offen lds
s_addk_i32 m0, 32
s_nop 0
buffer_load_dwordx4 v240, s[16:19], s97 offen offset:1024 lds
s_waitcnt vmcnt(14)
s_waitcnt lgkmcnt(0)
s_barrier
s_cmp_lg_u32 s99, 0
s_cbranch_scc0 L_bg24
v_mul_f32 v120, v120, v124
v_mul_f32 v121, v121, v125
v_mul_f32 v122, v122, v126
v_mul_f32 v123, v123, v127
v_cvt_pk_bf16_f32 v224, v112, v113
v_cvt_pk_bf16_f32 v225, v114, v115
v_cvt_pk_bf16_f32 v228, v120, v121
v_cvt_pk_bf16_f32 v229, v122, v123
v_mul_f32 v128, s73, v128
v_mul_f32 v129, s73, v129
v_mul_f32 v130, s73, v130
v_mul_f32 v131, s73, v131
v_mul_f32 v136, s73, v136
v_mul_f32 v137, s73, v137
v_mul_f32 v138, s73, v138
v_mul_f32 v139, s73, v139
v_exp_f32_e64 v128, v128
s_branch L_be24
L_bg24:
s_setprio 2
v_mfma_f32_16x16x32_bf16 v[144:147], v[176:179], v[48:51], v[144:147]
v_mul_f32 v120, v120, v124
v_mul_f32 v121, v121, v125
v_mfma_f32_16x16x32_bf16 v[152:155], v[176:179], v[52:55], v[152:155]
ds_read_b64_tr_b16 v[176:177], v246 offset:8192
ds_read_b64_tr_b16 v[178:179], v246 offset:9216
v_mfma_f32_16x16x32_bf16 v[168:171], v[180:183], v[52:55], v[168:171]
v_mul_f32 v122, v122, v126
v_mul_f32 v123, v123, v127
v_mfma_f32_16x16x32_bf16 v[160:163], v[180:183], v[48:51], v[160:163]
ds_read_b64_tr_b16 v[180:181], v247 offset:8192
ds_read_b64_tr_b16 v[182:183], v247 offset:9216
v_mfma_f32_16x16x32_bf16 v[148:151], v[184:187], v[48:51], v[148:151]
v_cvt_pk_bf16_f32 v224, v112, v113
v_cvt_pk_bf16_f32 v225, v114, v115
v_mfma_f32_16x16x32_bf16 v[156:159], v[184:187], v[52:55], v[156:159]
ds_read_b64_tr_b16 v[184:185], v246 offset:10240
ds_read_b64_tr_b16 v[186:187], v246 offset:11264
v_mfma_f32_16x16x32_bf16 v[172:175], v[188:191], v[52:55], v[172:175]
v_cvt_pk_bf16_f32 v228, v120, v121
v_cvt_pk_bf16_f32 v229, v122, v123
v_mfma_f32_16x16x32_bf16 v[164:167], v[188:191], v[48:51], v[164:167]
ds_read_b64_tr_b16 v[188:189], v247 offset:10240
ds_read_b64_tr_b16 v[190:191], v247 offset:11264
v_mfma_f32_16x16x32_bf16 v[144:147], v[192:195], v[56:59], v[144:147]
v_mul_f32 v128, s73, v128
v_mul_f32 v129, s73, v129
v_mfma_f32_16x16x32_bf16 v[152:155], v[192:195], v[60:63], v[152:155]
ds_read_b64_tr_b16 v[192:193], v246 offset:12288
ds_read_b64_tr_b16 v[194:195], v246 offset:13312
v_mfma_f32_16x16x32_bf16 v[168:171], v[196:199], v[60:63], v[168:171]
v_mul_f32 v130, s73, v130
v_mul_f32 v131, s73, v131
v_mfma_f32_16x16x32_bf16 v[160:163], v[196:199], v[56:59], v[160:163]
ds_read_b64_tr_b16 v[196:197], v247 offset:12288
ds_read_b64_tr_b16 v[198:199], v247 offset:13312
v_mfma_f32_16x16x32_bf16 v[148:151], v[200:203], v[56:59], v[148:151]
v_mul_f32 v136, s73, v136
v_mul_f32 v137, s73, v137
v_mfma_f32_16x16x32_bf16 v[156:159], v[200:203], v[60:63], v[156:159]
ds_read_b64_tr_b16 v[200:201], v246 offset:14336
ds_read_b64_tr_b16 v[202:203], v246 offset:15360
v_mfma_f32_16x16x32_bf16 v[172:175], v[204:207], v[60:63], v[172:175]
v_mul_f32 v138, s73, v138
v_mul_f32 v139, s73, v139
v_mfma_f32_16x16x32_bf16 v[164:167], v[204:207], v[56:59], v[164:167]
ds_read_b64_tr_b16 v[204:205], v247 offset:14336
ds_read_b64_tr_b16 v[206:207], v247 offset:15360
s_setprio 0
v_exp_f32 v128, v128
L_be24:
s_add_u32 m0, s76, 50688
s_addk_i32 s96, 8192
buffer_load_dwordx4 v240, s[12:15], s96 offen lds
s_addk_i32 m0, 32
s_nop 0
buffer_load_dwordx4 v240, s[12:15], s96 offen offset:1024 lds
s_addk_i32 m0, 8416
s_addk_i32 s96, 8192
buffer_load_dwordx4 v240, s[12:15], s96 offen lds
s_addk_i32 m0, 32
s_nop 0
buffer_load_dwordx4 v240, s[12:15], s96 offen offset:1024 lds
s_add_u32 m0, s88, 135168
s_mov_b32 s82, 1376448
buffer_load_dwordx4 v241, s[28:31], s82 offen lds
s_addk_i32 m0, 1024
s_addk_i32 s82, 14336
buffer_load_dwordx4 v241, s[28:31], s82 offen lds
s_add_u32 m0, s77, 101376
s_addk_i32 s97, 8192
buffer_load_dwordx4 v240, s[16:19], s97 offen lds
s_addk_i32 m0, 32
s_nop 0
buffer_load_dwordx4 v240, s[16:19], s97 offen offset:1024 lds
s_addk_i32 m0, 8416
s_addk_i32 s97, 8192
buffer_load_dwordx4 v240, s[16:19], s97 offen lds
s_addk_i32 m0, 32
s_nop 0
buffer_load_dwordx4 v240, s[16:19], s97 offen offset:1024 lds
s_mul_i32 s83, s91, 14336
s_add_u32 s83, s83, s88
s_add_u32 s83, s83, 0
s_lshl_b32 s83, s83, 0
buffer_load_dword v244, v243, s[24:27], s83 offen
s_waitcnt vmcnt(15)
s_waitcnt lgkmcnt(0)
s_barrier
s_cmp_lg_u32 s99, 0
s_cbranch_scc0 L_bg25
v_exp_f32 v129, v129
v_exp_f32 v130, v130
v_exp_f32 v131, v131
v_exp_f32 v136, v136
v_exp_f32 v137, v137
v_exp_f32 v138, v138
v_exp_f32 v139, v139
v_add_f32 v128, 1.0, v128
v_add_f32_e64 v129, 1.0, v129
s_branch L_be25
L_bg25:
s_setprio 2
v_mfma_f32_16x16x32_bf16 v[144:147], v[176:179], v[64:67], v[144:147]
v_exp_f32_e64 v129, v129
v_mfma_f32_16x16x32_bf16 v[152:155], v[176:179], v[68:71], v[152:155]
ds_read_b64_tr_b16 v[176:177], v246 offset:16384
ds_read_b64_tr_b16 v[178:179], v246 offset:17408
v_mfma_f32_16x16x32_bf16 v[168:171], v[180:183], v[68:71], v[168:171]
v_exp_f32_e64 v130, v130
v_mfma_f32_16x16x32_bf16 v[160:163], v[180:183], v[64:67], v[160:163]
ds_read_b64_tr_b16 v[180:181], v247 offset:16384
ds_read_b64_tr_b16 v[182:183], v247 offset:17408
v_mfma_f32_16x16x32_bf16 v[148:151], v[184:187], v[64:67], v[148:151]
v_exp_f32_e64 v131, v131
v_mfma_f32_16x16x32_bf16 v[156:159], v[184:187], v[68:71], v[156:159]
ds_read_b64_tr_b16 v[184:185], v246 offset:18432
ds_read_b64_tr_b16 v[186:187], v246 offset:19456
v_mfma_f32_16x16x32_bf16 v[172:175], v[188:191], v[68:71], v[172:175]
v_exp_f32_e64 v136, v136
v_mfma_f32_16x16x32_bf16 v[164:167], v[188:191], v[64:67], v[164:167]
ds_read_b64_tr_b16 v[188:189], v247 offset:18432
ds_read_b64_tr_b16 v[190:191], v247 offset:19456
v_mfma_f32_16x16x32_bf16 v[144:147], v[192:195], v[72:75], v[144:147]
v_exp_f32_e64 v137, v137
v_mfma_f32_16x16x32_bf16 v[152:155], v[192:195], v[76:79], v[152:155]
ds_read_b64_tr_b16 v[192:193], v246 offset:20480
ds_read_b64_tr_b16 v[194:195], v246 offset:21504
v_mfma_f32_16x16x32_bf16 v[168:171], v[196:199], v[76:79], v[168:171]
v_exp_f32_e64 v138, v138
v_mfma_f32_16x16x32_bf16 v[160:163], v[196:199], v[72:75], v[160:163]
ds_read_b64_tr_b16 v[196:197], v247 offset:20480
ds_read_b64_tr_b16 v[198:199], v247 offset:21504
v_mfma_f32_16x16x32_bf16 v[148:151], v[200:203], v[72:75], v[148:151]
v_exp_f32_e64 v139, v139
v_mfma_f32_16x16x32_bf16 v[156:159], v[200:203], v[76:79], v[156:159]
ds_read_b64_tr_b16 v[200:201], v246 offset:22528
ds_read_b64_tr_b16 v[202:203], v246 offset:23552
v_mfma_f32_16x16x32_bf16 v[172:175], v[204:207], v[76:79], v[172:175]
v_add_f32 v128, 1.0, v128
v_add_f32 v129, 1.0, v129
v_mfma_f32_16x16x32_bf16 v[164:167], v[204:207], v[72:75], v[164:167]
ds_read_b64_tr_b16 v[204:205], v247 offset:22528
ds_read_b64_tr_b16 v[206:207], v247 offset:23552
s_setprio 0
L_be25:
s_add_u32 m0, s76, 0
s_addk_i32 s96, 8192
buffer_load_dwordx4 v240, s[12:15], s96 offen lds
s_addk_i32 m0, 32
s_nop 0
buffer_load_dwordx4 v240, s[12:15], s96 offen offset:1024 lds
s_addk_i32 m0, 8416
s_addk_i32 s96, 8192
buffer_load_dwordx4 v240, s[12:15], s96 offen lds
s_addk_i32 m0, 32
s_nop 0
buffer_load_dwordx4 v240, s[12:15], s96 offen offset:1024 lds
s_add_u32 m0, s77, 118272
s_addk_i32 s97, 8192
buffer_load_dwordx4 v240, s[16:19], s97 offen lds
s_addk_i32 m0, 32
s_nop 0
buffer_load_dwordx4 v240, s[16:19], s97 offen offset:1024 lds
s_addk_i32 m0, 8416
s_addk_i32 s97, 8192
buffer_load_dwordx4 v240, s[16:19], s97 offen lds
s_addk_i32 m0, 32
s_nop 0
buffer_load_dwordx4 v240, s[16:19], s97 offen offset:1024 lds
s_waitcnt vmcnt(13)
s_waitcnt lgkmcnt(0)
s_barrier
s_cmp_lg_u32 s99, 0
s_cbranch_scc0 L_bg26
v_add_f32 v130, 1.0, v130
v_add_f32 v131, 1.0, v131
v_add_f32 v136, 1.0, v136
v_add_f32 v137, 1.0, v137
v_add_f32 v138, 1.0, v138
v_add_f32 v139, 1.0, v139
v_rcp_f32 v128, v128
v_rcp_f32 v129, v129
v_rcp_f32 v130, v130
v_rcp_f32 v131, v131
v_rcp_f32 v136, v136
v_rcp_f32_e64 v137, v137
s_branch L_be26
L_bg26:
s_setprio 2
v_mfma_f32_16x16x32_bf16 v[144:147], v[176:179], v[80:83], v[144:147]
v_add_f32 v130, 1.0, v130
v_add_f32 v131, 1.0, v131
v_mfma_f32_16x16x32_bf16 v[152:155], v[176:179], v[84:87], v[152:155]
ds_read_b64_tr_b16 v[176:177], v246 offset:0
ds_read_b64_tr_b16 v[178:179], v246 offset:1024
v_mfma_f32_16x16x32_bf16 v[168:171], v[180:183], v[84:87], v[168:171]
v_add_f32 v136, 1.0, v136
v_add_f32 v137, 1.0, v137
v_mfma_f32_16x16x32_bf16 v[160:163], v[180:183], v[80:83], v[160:163]
ds_read_b64_tr_b16 v[180:181], v247 offset:0
ds_read_b64_tr_b16 v[182:183], v247 offset:1024
v_mfma_f32_16x16x32_bf16 v[148:151], v[184:187], v[80:83], v[148:151]
v_add_f32 v138, 1.0, v138
v_add_f32 v139, 1.0, v139
v_mfma_f32_16x16x32_bf16 v[156:159], v[184:187], v[84:87], v[156:159]
ds_read_b64_tr_b16 v[184:185], v246 offset:2048
ds_read_b64_tr_b16 v[186:187], v246 offset:3072
v_mfma_f32_16x16x32_bf16 v[172:175], v[188:191], v[84:87], v[172:175]
v_rcp_f32_e64 v128, v128
v_mfma_f32_16x16x32_bf16 v[164:167], v[188:191], v[80:83], v[164:167]
ds_read_b64_tr_b16 v[188:189], v247 offset:2048
ds_read_b64_tr_b16 v[190:191], v247 offset:3072
v_mfma_f32_16x16x32_bf16 v[144:147], v[192:195], v[88:91], v[144:147]
v_rcp_f32_e64 v129, v129
v_mfma_f32_16x16x32_bf16 v[152:155], v[192:195], v[92:95], v[152:155]
ds_read_b64_tr_b16 v[192:193], v246 offset:4096
ds_read_b64_tr_b16 v[194:195], v246 offset:5120
v_mfma_f32_16x16x32_bf16 v[168:171], v[196:199], v[92:95], v[168:171]
v_rcp_f32_e64 v130, v130
v_mfma_f32_16x16x32_bf16 v[160:163], v[196:199], v[88:91], v[160:163]
ds_read_b64_tr_b16 v[196:197], v247 offset:4096
ds_read_b64_tr_b16 v[198:199], v247 offset:5120
v_mfma_f32_16x16x32_bf16 v[148:151], v[200:203], v[88:91], v[148:151]
v_rcp_f32_e64 v131, v131
v_mfma_f32_16x16x32_bf16 v[156:159], v[200:203], v[92:95], v[156:159]
ds_read_b64_tr_b16 v[200:201], v246 offset:6144
ds_read_b64_tr_b16 v[202:203], v246 offset:7168
v_mfma_f32_16x16x32_bf16 v[172:175], v[204:207], v[92:95], v[172:175]
v_rcp_f32_e64 v136, v136
v_mfma_f32_16x16x32_bf16 v[164:167], v[204:207], v[88:91], v[164:167]
ds_read_b64_tr_b16 v[204:205], v247 offset:6144
ds_read_b64_tr_b16 v[206:207], v247 offset:7168
s_setprio 0
v_rcp_f32 v137, v137
L_be26:
s_add_u32 m0, s76, 16896
s_addk_i32 s96, 8192
buffer_load_dwordx4 v240, s[12:15], s96 offen lds
s_addk_i32 m0, 32
s_nop 0
buffer_load_dwordx4 v240, s[12:15], s96 offen offset:1024 lds
s_addk_i32 m0, 8416
s_addk_i32 s96, 8192
buffer_load_dwordx4 v240, s[12:15], s96 offen lds
s_addk_i32 m0, 32
s_nop 0
buffer_load_dwordx4 v240, s[12:15], s96 offen offset:1024 lds
s_add_u32 m0, s77, 67584
s_addk_i32 s97, 8192
buffer_load_dwordx4 v240, s[16:19], s97 offen lds
s_addk_i32 m0, 32
s_nop 0
buffer_load_dwordx4 v240, s[16:19], s97 offen offset:1024 lds
s_addk_i32 m0, 8416
s_addk_i32 s97, 8192
buffer_load_dwordx4 v240, s[16:19], s97 offen lds
s_addk_i32 m0, 32
s_nop 0
buffer_load_dwordx4 v240, s[16:19], s97 offen offset:1024 lds
s_mul_i32 s83, s91, 14336
s_add_u32 s83, s83, s88
s_add_u32 s83, s83, 8192
s_lshl_b32 s83, s83, 0
buffer_load_dword v244, v243, s[24:27], s83 offen
s_waitcnt vmcnt(13)
s_waitcnt lgkmcnt(0)
s_barrier
s_cmp_lg_u32 s99, 0
s_cbranch_scc0 L_bg27
v_rcp_f32 v138, v138
v_rcp_f32 v139, v139
v_mul_f32 v128, v128, v132
v_mul_f32 v129, v129, v133
v_mul_f32 v130, v130, v134
v_mul_f32 v131, v131, v135
v_mul_f32 v136, v136, v140
v_mul_f32 v137, v137, v141
v_mul_f32 v138, v138, v142
v_mul_f32_e64 v139, v139, v143
v_cvt_pk_bf16_f32 v226, v128, v129
v_cvt_pk_bf16_f32 v227, v130, v131
v_cvt_pk_bf16_f32 v230, v136, v137
v_cvt_pk_bf16_f32 v231, v138, v139
s_branch L_be27
L_bg27:
s_setprio 2
v_mfma_f32_16x16x32_bf16 v[144:147], v[176:179], v[96:99], v[144:147]
v_rcp_f32_e64 v138, v138
v_mfma_f32_16x16x32_bf16 v[152:155], v[176:179], v[100:103], v[152:155]
v_mfma_f32_16x16x32_bf16 v[168:171], v[180:183], v[100:103], v[168:171]
v_rcp_f32_e64 v139, v139
v_mfma_f32_16x16x32_bf16 v[160:163], v[180:183], v[96:99], v[160:163]
v_mfma_f32_16x16x32_bf16 v[148:151], v[184:187], v[96:99], v[148:151]
v_mul_f32 v128, v128, v132
v_mul_f32 v129, v129, v133
v_mfma_f32_16x16x32_bf16 v[156:159], v[184:187], v[100:103], v[156:159]
v_mfma_f32_16x16x32_bf16 v[172:175], v[188:191], v[100:103], v[172:175]
v_mul_f32 v130, v130, v134
v_mul_f32 v131, v131, v135
v_mfma_f32_16x16x32_bf16 v[164:167], v[188:191], v[96:99], v[164:167]
v_mfma_f32_16x16x32_bf16 v[144:147], v[192:195], v[104:107], v[144:147]
v_mul_f32 v136, v136, v140
v_mul_f32 v137, v137, v141
v_mfma_f32_16x16x32_bf16 v[152:155], v[192:195], v[108:111], v[152:155]
v_mfma_f32_16x16x32_bf16 v[168:171], v[196:199], v[108:111], v[168:171]
v_mul_f32 v138, v138, v142
v_mul_f32 v139, v139, v143
v_mfma_f32_16x16x32_bf16 v[160:163], v[196:199], v[104:107], v[160:163]
v_mfma_f32_16x16x32_bf16 v[148:151], v[200:203], v[104:107], v[148:151]
v_cvt_pk_bf16_f32 v226, v128, v129
v_cvt_pk_bf16_f32 v227, v130, v131
v_mfma_f32_16x16x32_bf16 v[156:159], v[200:203], v[108:111], v[156:159]
v_mfma_f32_16x16x32_bf16 v[172:175], v[204:207], v[108:111], v[172:175]
v_cvt_pk_bf16_f32 v230, v136, v137
v_cvt_pk_bf16_f32 v231, v138, v139
v_mfma_f32_16x16x32_bf16 v[164:167], v[204:207], v[104:107], v[164:167]
s_setprio 0
L_be27:
s_add_u32 m0, s76, 33792
s_addk_i32 s96, 8192
buffer_load_dwordx4 v240, s[12:15], s96 offen lds
s_addk_i32 m0, 32
s_nop 0
buffer_load_dwordx4 v240, s[12:15], s96 offen offset:1024 lds
s_addk_i32 m0, 8416
s_addk_i32 s96, 8192
buffer_load_dwordx4 v240, s[12:15], s96 offen lds
s_addk_i32 m0, 32
s_nop 0
buffer_load_dwordx4 v240, s[12:15], s96 offen offset:1024 lds
s_add_u32 m0, s88, 143360
s_add_u32 s82, s87, 0
buffer_load_dwordx4 v242, s[36:39], s82 offen lds
s_addk_i32 m0, 1024
s_addk_i32 s82, 14336
buffer_load_dwordx4 v242, s[36:39], s82 offen lds
s_add_u32 m0, s77, 84480
s_addk_i32 s97, 8192
buffer_load_dwordx4 v240, s[16:19], s97 offen lds
s_addk_i32 m0, 32
s_nop 0
buffer_load_dwordx4 v240, s[16:19], s97 offen offset:1024 lds
s_addk_i32 m0, 8416
s_addk_i32 s97, 8192
buffer_load_dwordx4 v240, s[16:19], s97 offen lds
s_addk_i32 m0, 32
s_nop 0
buffer_load_dwordx4 v240, s[16:19], s97 offen offset:1024 lds
s_waitcnt vmcnt(15)
s_waitcnt lgkmcnt(0)
s_barrier
s_add_u32 m0, s76, 50688
s_addk_i32 s96, 8192
buffer_load_dwordx4 v240, s[12:15], s96 offen lds
s_addk_i32 m0, 32
s_nop 0
buffer_load_dwordx4 v240, s[12:15], s96 offen offset:1024 lds
s_addk_i32 m0, 8416
s_addk_i32 s96, 8192
buffer_load_dwordx4 v240, s[12:15], s96 offen lds
s_addk_i32 m0, 32
s_nop 0
buffer_load_dwordx4 v240, s[12:15], s96 offen offset:1024 lds
s_add_u32 m0, s88, 151552
s_add_u32 s82, s87, 64
buffer_load_dwordx4 v242, s[36:39], s82 offen lds
s_addk_i32 m0, 1024
s_addk_i32 s82, 14336
buffer_load_dwordx4 v242, s[36:39], s82 offen lds
s_add_u32 m0, s77, 101376
s_addk_i32 s97, 8192
buffer_load_dwordx4 v240, s[16:19], s97 offen lds
s_addk_i32 m0, 32
s_nop 0
buffer_load_dwordx4 v240, s[16:19], s97 offen offset:1024 lds
s_addk_i32 m0, 8416
s_addk_i32 s97, 8192
buffer_load_dwordx4 v240, s[16:19], s97 offen lds
s_addk_i32 m0, 32
s_nop 0
buffer_load_dwordx4 v240, s[16:19], s97 offen offset:1024 lds
s_cmp_lg_u32 s99, 0
s_cbranch_scc1 L_as31
v_mul_f32 v144, s73, v144
v_mul_f32 v145, s73, v145
v_mul_f32 v146, s73, v146
v_mul_f32 v147, s73, v147
v_mul_f32 v152, s73, v152
v_mul_f32 v153, s73, v153
v_mul_f32 v154, s73, v154
v_mul_f32 v155, s73, v155
v_exp_f32 v144, v144
v_exp_f32 v145, v145
v_exp_f32 v146, v146
v_exp_f32 v147, v147
v_exp_f32 v152, v152
v_exp_f32 v153, v153
v_exp_f32 v154, v154
v_exp_f32 v155, v155
v_add_f32 v144, 1.0, v144
v_add_f32 v145, 1.0, v145
v_add_f32 v146, 1.0, v146
v_add_f32 v147, 1.0, v147
v_add_f32 v152, 1.0, v152
v_add_f32 v153, 1.0, v153
v_add_f32 v154, 1.0, v154
v_add_f32 v155, 1.0, v155
v_rcp_f32 v144, v144
v_rcp_f32 v145, v145
v_rcp_f32 v146, v146
v_rcp_f32 v147, v147
v_rcp_f32 v152, v152
v_rcp_f32 v153, v153
v_rcp_f32 v154, v154
v_rcp_f32 v155, v155
v_mul_f32 v144, v144, v148
v_mul_f32 v145, v145, v149
v_mul_f32 v146, v146, v150
v_mul_f32 v147, v147, v151
v_mul_f32 v152, v152, v156
v_mul_f32 v153, v153, v157
v_mul_f32 v154, v154, v158
v_mul_f32 v155, v155, v159
v_cvt_pk_bf16_f32 v232, v144, v145
v_cvt_pk_bf16_f32 v233, v146, v147
v_cvt_pk_bf16_f32 v236, v152, v153
v_cvt_pk_bf16_f32 v237, v154, v155
L_as31:
s_waitcnt vmcnt(14)
s_waitcnt lgkmcnt(0)
s_barrier
s_add_u32 m0, s76, 0
s_addk_i32 s96, 8192
buffer_load_dwordx4 v240, s[12:15], s96 offen lds
s_addk_i32 m0, 32
s_nop 0
buffer_load_dwordx4 v240, s[12:15], s96 offen offset:1024 lds
s_addk_i32 m0, 8416
s_addk_i32 s96, 8192
buffer_load_dwordx4 v240, s[12:15], s96 offen lds
s_addk_i32 m0, 32
s_nop 0
buffer_load_dwordx4 v240, s[12:15], s96 offen offset:1024 lds
s_add_u32 m0, s88, 135168
s_add_u32 s82, s87, 128
buffer_load_dwordx4 v242, s[36:39], s82 offen lds
s_addk_i32 m0, 1024
s_addk_i32 s82, 14336
buffer_load_dwordx4 v242, s[36:39], s82 offen lds
s_add_u32 m0, s77, 118272
s_addk_i32 s97, 8192
buffer_load_dwordx4 v240, s[16:19], s97 offen lds
s_addk_i32 m0, 32
s_nop 0
buffer_load_dwordx4 v240, s[16:19], s97 offen offset:1024 lds
s_addk_i32 m0, 8416
s_addk_i32 s97, 8192
buffer_load_dwordx4 v240, s[16:19], s97 offen lds
s_addk_i32 m0, 32
s_nop 0
buffer_load_dwordx4 v240, s[16:19], s97 offen offset:1024 lds
s_cmp_lg_u32 s99, 0
s_cbranch_scc1 L_as32
v_mul_f32 v160, s73, v160
v_mul_f32 v161, s73, v161
v_mul_f32 v162, s73, v162
v_mul_f32 v163, s73, v163
v_mul_f32 v168, s73, v168
v_mul_f32 v169, s73, v169
v_mul_f32 v170, s73, v170
v_mul_f32 v171, s73, v171
v_exp_f32 v160, v160
v_exp_f32 v161, v161
v_exp_f32 v162, v162
v_exp_f32 v163, v163
v_exp_f32 v168, v168
v_exp_f32 v169, v169
v_exp_f32 v170, v170
v_exp_f32 v171, v171
v_add_f32 v160, 1.0, v160
v_add_f32 v161, 1.0, v161
v_add_f32 v162, 1.0, v162
v_add_f32 v163, 1.0, v163
v_add_f32 v168, 1.0, v168
v_add_f32 v169, 1.0, v169
v_add_f32 v170, 1.0, v170
v_add_f32 v171, 1.0, v171
v_rcp_f32 v160, v160
v_rcp_f32 v161, v161
v_rcp_f32 v162, v162
v_rcp_f32 v163, v163
v_rcp_f32 v168, v168
v_rcp_f32 v169, v169
v_rcp_f32 v170, v170
v_rcp_f32 v171, v171
v_mul_f32 v160, v160, v164
v_mul_f32 v161, v161, v165
v_mul_f32 v162, v162, v166
v_mul_f32 v163, v163, v167
v_mul_f32 v168, v168, v172
v_mul_f32 v169, v169, v173
v_mul_f32 v170, v170, v174
v_mul_f32 v171, v171, v175
v_cvt_pk_bf16_f32 v234, v160, v161
v_cvt_pk_bf16_f32 v235, v162, v163
v_cvt_pk_bf16_f32 v238, v168, v169
v_cvt_pk_bf16_f32 v239, v170, v171
L_as32:
ds_read_b64_tr_b16 v[176:177], v246 offset:8192
ds_read_b64_tr_b16 v[178:179], v246 offset:9216
ds_read_b64_tr_b16 v[180:181], v247 offset:8192
ds_read_b64_tr_b16 v[182:183], v247 offset:9216
ds_read_b64_tr_b16 v[184:185], v246 offset:10240
ds_read_b64_tr_b16 v[186:187], v246 offset:11264
ds_read_b64_tr_b16 v[188:189], v247 offset:10240
ds_read_b64_tr_b16 v[190:191], v247 offset:11264
ds_read_b64_tr_b16 v[192:193], v246 offset:12288
ds_read_b64_tr_b16 v[194:195], v246 offset:13312
ds_read_b64_tr_b16 v[196:197], v247 offset:12288
ds_read_b64_tr_b16 v[198:199], v247 offset:13312
ds_read_b64_tr_b16 v[200:201], v246 offset:14336
ds_read_b64_tr_b16 v[202:203], v246 offset:15360
ds_read_b64_tr_b16 v[204:205], v247 offset:14336
ds_read_b64_tr_b16 v[206:207], v247 offset:15360
s_waitcnt vmcnt(14)
s_waitcnt lgkmcnt(0)
s_barrier
s_setprio 2
v_mfma_f32_16x16x32_bf16 v[48:51], v[176:179], v[208:211], 0
v_mfma_f32_16x16x32_bf16 v[56:59], v[176:179], v[212:215], 0
ds_read_b64_tr_b16 v[176:177], v246 offset:16384
ds_read_b64_tr_b16 v[178:179], v246 offset:17408
v_mfma_f32_16x16x32_bf16 v[60:63], v[180:183], v[212:215], 0
v_mfma_f32_16x16x32_bf16 v[52:55], v[180:183], v[208:211], 0
ds_read_b64_tr_b16 v[180:181], v247 offset:16384
ds_read_b64_tr_b16 v[182:183], v247 offset:17408
v_mfma_f32_16x16x32_bf16 v[48:51], v[184:187], v[216:219], v[48:51]
v_mfma_f32_16x16x32_bf16 v[56:59], v[184:187], v[220:223], v[56:59]
ds_read_b64_tr_b16 v[184:185], v246 offset:18432
ds_read_b64_tr_b16 v[186:187], v246 offset:19456
v_mfma_f32_16x16x32_bf16 v[60:63], v[188:191], v[220:223], v[60:63]
v_mfma_f32_16x16x32_bf16 v[52:55], v[188:191], v[216:219], v[52:55]
ds_read_b64_tr_b16 v[188:189], v247 offset:18432
ds_read_b64_tr_b16 v[190:191], v247 offset:19456
v_mfma_f32_16x16x32_bf16 v[48:51], v[192:195], v[224:227], v[48:51]
v_mfma_f32_16x16x32_bf16 v[56:59], v[192:195], v[228:231], v[56:59]
ds_read_b64_tr_b16 v[192:193], v246 offset:20480
ds_read_b64_tr_b16 v[194:195], v246 offset:21504
v_mfma_f32_16x16x32_bf16 v[60:63], v[196:199], v[228:231], v[60:63]
v_mfma_f32_16x16x32_bf16 v[52:55], v[196:199], v[224:227], v[52:55]
ds_read_b64_tr_b16 v[196:197], v247 offset:20480
ds_read_b64_tr_b16 v[198:199], v247 offset:21504
s_cmp_lg_u32 s99, 0
s_cbranch_scc1 L_bs28
v_mfma_f32_16x16x32_bf16 v[48:51], v[200:203], v[232:235], v[48:51]
v_mfma_f32_16x16x32_bf16 v[56:59], v[200:203], v[236:239], v[56:59]
ds_read_b64_tr_b16 v[200:201], v246 offset:22528
ds_read_b64_tr_b16 v[202:203], v246 offset:23552
v_mfma_f32_16x16x32_bf16 v[60:63], v[204:207], v[236:239], v[60:63]
v_mfma_f32_16x16x32_bf16 v[52:55], v[204:207], v[232:235], v[52:55]
ds_read_b64_tr_b16 v[204:205], v247 offset:22528
ds_read_b64_tr_b16 v[206:207], v247 offset:23552
L_bs28:
s_setprio 0
s_add_u32 m0, s76, 16896
s_addk_i32 s96, 8192
buffer_load_dwordx4 v240, s[12:15], s96 offen lds
s_addk_i32 m0, 32
s_nop 0
buffer_load_dwordx4 v240, s[12:15], s96 offen offset:1024 lds
s_addk_i32 m0, 8416
s_addk_i32 s96, 8192
buffer_load_dwordx4 v240, s[12:15], s96 offen lds
s_addk_i32 m0, 32
s_nop 0
buffer_load_dwordx4 v240, s[12:15], s96 offen offset:1024 lds
s_add_u32 m0, s88, 143360
s_add_u32 s82, s87, 192
buffer_load_dwordx4 v242, s[36:39], s82 offen lds
s_addk_i32 m0, 1024
s_addk_i32 s82, 14336
buffer_load_dwordx4 v242, s[36:39], s82 offen lds
s_add_u32 m0, s77, 67584
s_addk_i32 s97, 8192
buffer_load_dwordx4 v240, s[16:19], s97 offen lds
s_addk_i32 m0, 32
s_nop 0
buffer_load_dwordx4 v240, s[16:19], s97 offen offset:1024 lds
s_addk_i32 m0, 8416
s_addk_i32 s97, 8192
buffer_load_dwordx4 v240, s[16:19], s97 offen lds
s_addk_i32 m0, 32
s_nop 0
buffer_load_dwordx4 v240, s[16:19], s97 offen offset:1024 lds
s_waitcnt vmcnt(14)
s_waitcnt lgkmcnt(0)
s_barrier
s_setprio 2
v_mfma_f32_16x16x32_bf16 v[64:67], v[176:179], v[208:211], 0
v_cvt_pk_bf16_f32 v80, v48, v49
v_cvt_pk_bf16_f32 v81, v50, v51
v_mfma_f32_16x16x32_bf16 v[72:75], v[176:179], v[212:215], 0
ds_read_b64_tr_b16 v[176:177], v246 offset:0
ds_read_b64_tr_b16 v[178:179], v246 offset:1024
v_mfma_f32_16x16x32_bf16 v[76:79], v[180:183], v[212:215], 0
v_cvt_pk_bf16_f32 v82, v52, v53
v_cvt_pk_bf16_f32 v83, v54, v55
v_mfma_f32_16x16x32_bf16 v[68:71], v[180:183], v[208:211], 0
ds_read_b64_tr_b16 v[180:181], v247 offset:0
ds_read_b64_tr_b16 v[182:183], v247 offset:1024
v_mfma_f32_16x16x32_bf16 v[64:67], v[184:187], v[216:219], v[64:67]
v_cvt_pk_bf16_f32 v84, v56, v57
v_cvt_pk_bf16_f32 v85, v58, v59
v_mfma_f32_16x16x32_bf16 v[72:75], v[184:187], v[220:223], v[72:75]
ds_read_b64_tr_b16 v[184:185], v246 offset:2048
ds_read_b64_tr_b16 v[186:187], v246 offset:3072
v_mfma_f32_16x16x32_bf16 v[76:79], v[188:191], v[220:223], v[76:79]
v_cvt_pk_bf16_f32 v86, v60, v61
v_cvt_pk_bf16_f32 v87, v62, v63
v_mfma_f32_16x16x32_bf16 v[68:71], v[188:191], v[216:219], v[68:71]
ds_read_b64_tr_b16 v[188:189], v247 offset:2048
ds_read_b64_tr_b16 v[190:191], v247 offset:3072
v_mfma_f32_16x16x32_bf16 v[64:67], v[192:195], v[224:227], v[64:67]
s_nop 0
v_mfma_f32_16x16x32_bf16 v[72:75], v[192:195], v[228:231], v[72:75]
ds_read_b64_tr_b16 v[192:193], v246 offset:4096
ds_read_b64_tr_b16 v[194:195], v246 offset:5120
v_mfma_f32_16x16x32_bf16 v[76:79], v[196:199], v[228:231], v[76:79]
v_mfma_f32_16x16x32_bf16 v[68:71], v[196:199], v[224:227], v[68:71]
ds_read_b64_tr_b16 v[196:197], v247 offset:4096
ds_read_b64_tr_b16 v[198:199], v247 offset:5120
s_cmp_lg_u32 s99, 0
s_cbranch_scc1 L_bs29
v_mfma_f32_16x16x32_bf16 v[64:67], v[200:203], v[232:235], v[64:67]
v_mfma_f32_16x16x32_bf16 v[72:75], v[200:203], v[236:239], v[72:75]
ds_read_b64_tr_b16 v[200:201], v246 offset:6144
ds_read_b64_tr_b16 v[202:203], v246 offset:7168
v_mfma_f32_16x16x32_bf16 v[76:79], v[204:207], v[236:239], v[76:79]
v_mfma_f32_16x16x32_bf16 v[68:71], v[204:207], v[232:235], v[68:71]
ds_read_b64_tr_b16 v[204:205], v247 offset:6144
ds_read_b64_tr_b16 v[206:207], v247 offset:7168
L_bs29:
s_setprio 0
s_add_u32 m0, s76, 33792
s_addk_i32 s96, 8192
buffer_load_dwordx4 v240, s[12:15], s96 offen lds
s_addk_i32 m0, 32
s_nop 0
buffer_load_dwordx4 v240, s[12:15], s96 offen offset:1024 lds
s_addk_i32 m0, 8416
s_addk_i32 s96, 8192
buffer_load_dwordx4 v240, s[12:15], s96 offen lds
s_addk_i32 m0, 32
s_nop 0
buffer_load_dwordx4 v240, s[12:15], s96 offen offset:1024 lds
s_add_u32 m0, s88, 151552
s_add_u32 s82, s87, 256
buffer_load_dwordx4 v242, s[36:39], s82 offen lds
s_addk_i32 m0, 1024
s_addk_i32 s82, 14336
buffer_load_dwordx4 v242, s[36:39], s82 offen lds
s_add_u32 m0, s77, 84480
s_addk_i32 s97, 8192
buffer_load_dwordx4 v240, s[16:19], s97 offen lds
s_addk_i32 m0, 32
s_nop 0
buffer_load_dwordx4 v240, s[16:19], s97 offen offset:1024 lds
s_addk_i32 m0, 8416
s_addk_i32 s97, 8192
buffer_load_dwordx4 v240, s[16:19], s97 offen lds
s_addk_i32 m0, 32
s_nop 0
buffer_load_dwordx4 v240, s[16:19], s97 offen offset:1024 lds
s_mov_b32 s83, 0
buffer_store_dwordx4 v[80:83], v249, s[40:43], s83 offen sc1
s_addk_i32 s83, 16384
buffer_store_dwordx4 v[84:87], v249, s[40:43], s83 offen sc1
s_waitcnt vmcnt(16)
s_waitcnt lgkmcnt(0)
s_barrier
s_setprio 2
v_mfma_f32_16x16x32_bf16 v[48:51], v[176:179], v[208:211], 0
v_cvt_pk_bf16_f32 v88, v64, v65
v_cvt_pk_bf16_f32 v89, v66, v67
v_mfma_f32_16x16x32_bf16 v[56:59], v[176:179], v[212:215], 0
ds_read_b64_tr_b16 v[176:177], v246 offset:8192
ds_read_b64_tr_b16 v[178:179], v246 offset:9216
v_mfma_f32_16x16x32_bf16 v[60:63], v[180:183], v[212:215], 0
v_cvt_pk_bf16_f32 v90, v68, v69
v_cvt_pk_bf16_f32 v91, v70, v71
v_mfma_f32_16x16x32_bf16 v[52:55], v[180:183], v[208:211], 0
ds_read_b64_tr_b16 v[180:181], v247 offset:8192
ds_read_b64_tr_b16 v[182:183], v247 offset:9216
v_mfma_f32_16x16x32_bf16 v[48:51], v[184:187], v[216:219], v[48:51]
v_cvt_pk_bf16_f32 v92, v72, v73
v_cvt_pk_bf16_f32 v93, v74, v75
v_mfma_f32_16x16x32_bf16 v[56:59], v[184:187], v[220:223], v[56:59]
ds_read_b64_tr_b16 v[184:185], v246 offset:10240
ds_read_b64_tr_b16 v[186:187], v246 offset:11264
v_mfma_f32_16x16x32_bf16 v[60:63], v[188:191], v[220:223], v[60:63]
v_cvt_pk_bf16_f32 v94, v76, v77
v_cvt_pk_bf16_f32 v95, v78, v79
v_mfma_f32_16x16x32_bf16 v[52:55], v[188:191], v[216:219], v[52:55]
ds_read_b64_tr_b16 v[188:189], v247 offset:10240
ds_read_b64_tr_b16 v[190:191], v247 offset:11264
v_mfma_f32_16x16x32_bf16 v[48:51], v[192:195], v[224:227], v[48:51]
s_nop 0
v_mfma_f32_16x16x32_bf16 v[56:59], v[192:195], v[228:231], v[56:59]
ds_read_b64_tr_b16 v[192:193], v246 offset:12288
ds_read_b64_tr_b16 v[194:195], v246 offset:13312
v_mfma_f32_16x16x32_bf16 v[60:63], v[196:199], v[228:231], v[60:63]
v_mfma_f32_16x16x32_bf16 v[52:55], v[196:199], v[224:227], v[52:55]
ds_read_b64_tr_b16 v[196:197], v247 offset:12288
ds_read_b64_tr_b16 v[198:199], v247 offset:13312
s_cmp_lg_u32 s99, 0
s_cbranch_scc1 L_bs30
v_mfma_f32_16x16x32_bf16 v[48:51], v[200:203], v[232:235], v[48:51]
v_mfma_f32_16x16x32_bf16 v[56:59], v[200:203], v[236:239], v[56:59]
ds_read_b64_tr_b16 v[200:201], v246 offset:14336
ds_read_b64_tr_b16 v[202:203], v246 offset:15360
v_mfma_f32_16x16x32_bf16 v[60:63], v[204:207], v[236:239], v[60:63]
v_mfma_f32_16x16x32_bf16 v[52:55], v[204:207], v[232:235], v[52:55]
ds_read_b64_tr_b16 v[204:205], v247 offset:14336
ds_read_b64_tr_b16 v[206:207], v247 offset:15360
L_bs30:
s_setprio 0
s_lshr_b32 s7, s3, 2
s_mul_i32 s83, s4, 1835008
s_lshl_b32 s82, s3, 14
s_add_u32 s83, s83, s82
s_lshl_b32 s82, s6, 18
s_add_u32 s83, s83, s82
s_add_u32 s20, s70, s83
s_addc_u32 s21, s71, 0
s_cmp_eq_u32 s6, 3
s_cselect_b32 s22, 0, 1048576
s_add_u32 s22, s22, 33816576
s_mov_b32 s28, s66
s_mov_b32 s29, s67
s_mov_b32 s30, 1835008
s_lshl_b32 s82, s4, 2
s_add_u32 s7, s7, s82
s_lshl_b32 s82, s7, 10
s_add_u32 s82, s82, 67108864
s_add_u32 s32, s70, s82
s_addc_u32 s33, s71, 0
s_mov_b32 s34, 0x10400
s_mov_b32 s84, 0x10000
s_lshl_b32 s7, s7, 1
s_and_b32 s82, s3, 1
s_add_u32 s7, s7, s82
s_mul_i32 s86, s7, 14336
s_lshl_b32 s82, s6, 7
s_add_u32 s86, s86, s82
s_bfe_u32 s82, s3, 0x10001
s_lshl_b32 s82, s82, 6
s_add_u32 s86, s86, s82
s_lshl_b32 s7, s4, 4
v_mov_b32_e64 v252, s7
s_add_u32 m0, s76, 50688
s_addk_i32 s96, 8192
buffer_load_dwordx4 v240, s[12:15], s96 offen lds
s_addk_i32 m0, 32
s_nop 0
buffer_load_dwordx4 v240, s[12:15], s96 offen offset:1024 lds
s_addk_i32 m0, 8416
s_addk_i32 s96, 8192
buffer_load_dwordx4 v240, s[12:15], s96 offen lds
s_addk_i32 m0, 32
s_nop 0
buffer_load_dwordx4 v240, s[12:15], s96 offen offset:1024 lds
s_add_u32 m0, s88, 135168
s_add_u32 s82, s87, 320
buffer_load_dwordx4 v242, s[36:39], s82 offen lds
s_addk_i32 m0, 1024
s_addk_i32 s82, 14336
buffer_load_dwordx4 v242, s[36:39], s82 offen lds
s_add_u32 m0, s77, 101376
s_addk_i32 s97, 8192
buffer_load_dwordx4 v240, s[16:19], s97 offen lds
s_addk_i32 m0, 32
s_nop 0
buffer_load_dwordx4 v240, s[16:19], s97 offen offset:1024 lds
s_addk_i32 m0, 8416
s_addk_i32 s97, 8192
buffer_load_dwordx4 v240, s[16:19], s97 offen lds
s_addk_i32 m0, 32
s_nop 0
buffer_load_dwordx4 v240, s[16:19], s97 offen offset:1024 lds
s_mov_b32 s83, 32768
buffer_store_dwordx4 v[88:91], v249, s[40:43], s83 offen sc1
s_addk_i32 s83, 16384
buffer_store_dwordx4 v[92:95], v249, s[40:43], s83 offen sc1
s_waitcnt vmcnt(18)
s_waitcnt lgkmcnt(0)
s_barrier
global_load_dword v253, v252, s[68:69] sc1
s_setprio 2
v_mfma_f32_16x16x32_bf16 v[64:67], v[176:179], v[208:211], 0
v_cvt_pk_bf16_f32 v80, v48, v49
v_cvt_pk_bf16_f32 v81, v50, v51
v_mfma_f32_16x16x32_bf16 v[72:75], v[176:179], v[212:215], 0
ds_read_b64_tr_b16 v[176:177], v246 offset:16384
ds_read_b64_tr_b16 v[178:179], v246 offset:17408
v_mfma_f32_16x16x32_bf16 v[76:79], v[180:183], v[212:215], 0
v_cvt_pk_bf16_f32 v82, v52, v53
v_cvt_pk_bf16_f32 v83, v54, v55
v_mfma_f32_16x16x32_bf16 v[68:71], v[180:183], v[208:211], 0
ds_read_b64_tr_b16 v[180:181], v247 offset:16384
ds_read_b64_tr_b16 v[182:183], v247 offset:17408
v_mfma_f32_16x16x32_bf16 v[64:67], v[184:187], v[216:219], v[64:67]
v_cvt_pk_bf16_f32 v84, v56, v57
v_cvt_pk_bf16_f32 v85, v58, v59
v_mfma_f32_16x16x32_bf16 v[72:75], v[184:187], v[220:223], v[72:75]
ds_read_b64_tr_b16 v[184:185], v246 offset:18432
ds_read_b64_tr_b16 v[186:187], v246 offset:19456
v_mfma_f32_16x16x32_bf16 v[76:79], v[188:191], v[220:223], v[76:79]
v_cvt_pk_bf16_f32 v86, v60, v61
v_cvt_pk_bf16_f32 v87, v62, v63
v_mfma_f32_16x16x32_bf16 v[68:71], v[188:191], v[216:219], v[68:71]
ds_read_b64_tr_b16 v[188:189], v247 offset:18432
ds_read_b64_tr_b16 v[190:191], v247 offset:19456
v_mfma_f32_16x16x32_bf16 v[64:67], v[192:195], v[224:227], v[64:67]
s_nop 0
v_mfma_f32_16x16x32_bf16 v[72:75], v[192:195], v[228:231], v[72:75]
ds_read_b64_tr_b16 v[192:193], v246 offset:20480
ds_read_b64_tr_b16 v[194:195], v246 offset:21504
v_mfma_f32_16x16x32_bf16 v[76:79], v[196:199], v[228:231], v[76:79]
v_mfma_f32_16x16x32_bf16 v[68:71], v[196:199], v[224:227], v[68:71]
ds_read_b64_tr_b16 v[196:197], v247 offset:20480
ds_read_b64_tr_b16 v[198:199], v247 offset:21504
s_cmp_lg_u32 s99, 0
s_cbranch_scc1 L_bs31
v_mfma_f32_16x16x32_bf16 v[64:67], v[200:203], v[232:235], v[64:67]
v_mfma_f32_16x16x32_bf16 v[72:75], v[200:203], v[236:239], v[72:75]
ds_read_b64_tr_b16 v[200:201], v246 offset:22528
ds_read_b64_tr_b16 v[202:203], v246 offset:23552
v_mfma_f32_16x16x32_bf16 v[76:79], v[204:207], v[236:239], v[76:79]
v_mfma_f32_16x16x32_bf16 v[68:71], v[204:207], v[232:235], v[68:71]
ds_read_b64_tr_b16 v[204:205], v247 offset:22528
ds_read_b64_tr_b16 v[206:207], v247 offset:23552
L_bs31:
s_setprio 0
s_add_u32 m0, s76, 0
s_addk_i32 s96, 8192
buffer_load_dwordx4 v240, s[12:15], s96 offen lds
s_addk_i32 m0, 32
s_nop 0
buffer_load_dwordx4 v240, s[12:15], s96 offen offset:1024 lds
s_addk_i32 m0, 8416
s_addk_i32 s96, 8192
buffer_load_dwordx4 v240, s[12:15], s96 offen lds
s_addk_i32 m0, 32
s_nop 0
buffer_load_dwordx4 v240, s[12:15], s96 offen offset:1024 lds
s_add_u32 m0, s88, 143360
s_add_u32 s82, s87, 384
buffer_load_dwordx4 v242, s[36:39], s82 offen lds
s_addk_i32 m0, 1024
s_addk_i32 s82, 14336
buffer_load_dwordx4 v242, s[36:39], s82 offen lds
s_add_u32 m0, s77, 118272
s_addk_i32 s97, 8192
buffer_load_dwordx4 v240, s[16:19], s97 offen lds
s_addk_i32 m0, 32
s_nop 0
buffer_load_dwordx4 v240, s[16:19], s97 offen offset:1024 lds
s_addk_i32 m0, 8416
s_addk_i32 s97, 8192
buffer_load_dwordx4 v240, s[16:19], s97 offen lds
s_addk_i32 m0, 32
s_nop 0
buffer_load_dwordx4 v240, s[16:19], s97 offen offset:1024 lds
s_mov_b32 s83, 262144
buffer_store_dwordx4 v[80:83], v249, s[40:43], s83 offen sc1
s_addk_i32 s83, 16384
buffer_store_dwordx4 v[84:87], v249, s[40:43], s83 offen sc1
s_waitcnt vmcnt(12)
v_cmp_le_u32_e64 vcc, 16, v253
s_cmp_eq_u64 vcc, -1
s_cbranch_scc1 L_pa_ok
s_mov_b32 s7, 400000
L_pa_lp:
s_sleep 8
global_load_dword v253, v252, s[68:69] sc1
s_waitcnt vmcnt(0)
v_cmp_le_u32 vcc, 16, v253
s_cmp_eq_u64 vcc, -1
s_cbranch_scc1 L_pa_ok
s_sub_u32 s7, s7, 1
s_cbranch_scc0 L_pa_lp
L_pa_ok:
v_and_b32 v252, 15, v255
v_lshlrev_b32 v252, 2, v252
s_waitcnt lgkmcnt(0)
s_barrier
s_setprio 2
v_mfma_f32_16x16x32_bf16 v[48:51], v[176:179], v[208:211], 0
v_cvt_pk_bf16_f32 v88, v64, v65
v_cvt_pk_bf16_f32 v89, v66, v67
v_mfma_f32_16x16x32_bf16 v[56:59], v[176:179], v[212:215], 0
ds_read_b64_tr_b16 v[176:177], v246 offset:0
ds_read_b64_tr_b16 v[178:179], v246 offset:1024
v_mfma_f32_16x16x32_bf16 v[60:63], v[180:183], v[212:215], 0
v_cvt_pk_bf16_f32 v90, v68, v69
v_cvt_pk_bf16_f32 v91, v70, v71
v_mfma_f32_16x16x32_bf16 v[52:55], v[180:183], v[208:211], 0
ds_read_b64_tr_b16 v[180:181], v247 offset:0
ds_read_b64_tr_b16 v[182:183], v247 offset:1024
v_mfma_f32_16x16x32_bf16 v[48:51], v[184:187], v[216:219], v[48:51]
v_cvt_pk_bf16_f32 v92, v72, v73
v_cvt_pk_bf16_f32 v93, v74, v75
v_mfma_f32_16x16x32_bf16 v[56:59], v[184:187], v[220:223], v[56:59]
ds_read_b64_tr_b16 v[184:185], v246 offset:2048
ds_read_b64_tr_b16 v[186:187], v246 offset:3072
v_mfma_f32_16x16x32_bf16 v[60:63], v[188:191], v[220:223], v[60:63]
v_cvt_pk_bf16_f32 v94, v76, v77
v_cvt_pk_bf16_f32 v95, v78, v79
v_mfma_f32_16x16x32_bf16 v[52:55], v[188:191], v[216:219], v[52:55]
ds_read_b64_tr_b16 v[188:189], v247 offset:2048
ds_read_b64_tr_b16 v[190:191], v247 offset:3072
v_mfma_f32_16x16x32_bf16 v[48:51], v[192:195], v[224:227], v[48:51]
v_mfma_f32_16x16x32_bf16 v[56:59], v[192:195], v[228:231], v[56:59]
ds_read_b64_tr_b16 v[192:193], v246 offset:4096
ds_read_b64_tr_b16 v[194:195], v246 offset:5120
v_mfma_f32_16x16x32_bf16 v[60:63], v[196:199], v[228:231], v[60:63]
v_mfma_f32_16x16x32_bf16 v[52:55], v[196:199], v[224:227], v[52:55]
ds_read_b64_tr_b16 v[196:197], v247 offset:4096
ds_read_b64_tr_b16 v[198:199], v247 offset:5120
s_cmp_lg_u32 s99, 0
s_cbranch_scc1 L_bs32
v_mfma_f32_16x16x32_bf16 v[48:51], v[200:203], v[232:235], v[48:51]
v_mfma_f32_16x16x32_bf16 v[56:59], v[200:203], v[236:239], v[56:59]
ds_read_b64_tr_b16 v[200:201], v246 offset:6144
ds_read_b64_tr_b16 v[202:203], v246 offset:7168
v_mfma_f32_16x16x32_bf16 v[60:63], v[204:207], v[236:239], v[60:63]
v_mfma_f32_16x16x32_bf16 v[52:55], v[204:207], v[232:235], v[52:55]
ds_read_b64_tr_b16 v[204:205], v247 offset:6144
ds_read_b64_tr_b16 v[206:207], v247 offset:7168
L_bs32:
s_setprio 0
s_add_u32 m0, s76, 16896
s_addk_i32 s96, 8192
buffer_load_dwordx4 v240, s[12:15], s96 offen lds
s_addk_i32 m0, 32
s_nop 0
buffer_load_dwordx4 v240, s[12:15], s96 offen offset:1024 lds
s_addk_i32 m0, 8416
s_addk_i32 s96, 8192
buffer_load_dwordx4 v240, s[12:15], s96 offen lds
s_addk_i32 m0, 32
s_nop 0
buffer_load_dwordx4 v240, s[12:15], s96 offen offset:1024 lds
s_add_u32 m0, s88, 151552
s_add_u32 s82, s87, 448
buffer_load_dwordx4 v242, s[36:39], s82 offen lds
s_addk_i32 m0, 1024
s_addk_i32 s82, 14336
buffer_load_dwordx4 v242, s[36:39], s82 offen lds
s_add_u32 m0, s77, 67584
s_addk_i32 s97, 8192
buffer_load_dwordx4 v240, s[16:19], s97 offen lds
s_addk_i32 m0, 32
s_nop 0
buffer_load_dwordx4 v240, s[16:19], s97 offen offset:1024 lds
s_addk_i32 m0, 8416
s_addk_i32 s97, 8192
buffer_load_dwordx4 v240, s[16:19], s97 offen lds
s_addk_i32 m0, 32
s_nop 0
buffer_load_dwordx4 v240, s[16:19], s97 offen offset:1024 lds
s_mov_b32 s83, 294912
buffer_store_dwordx4 v[88:91], v249, s[40:43], s83 offen sc1
s_addk_i32 s83, 16384
buffer_store_dwordx4 v[92:95], v249, s[40:43], s83 offen sc1
s_waitcnt vmcnt(18)
s_waitcnt lgkmcnt(0)
s_barrier
s_setprio 2
v_mfma_f32_16x16x32_bf16 v[64:67], v[176:179], v[208:211], 0
v_cvt_pk_bf16_f32 v80, v48, v49
v_cvt_pk_bf16_f32 v81, v50, v51
v_mfma_f32_16x16x32_bf16 v[72:75], v[176:179], v[212:215], 0
ds_read_b64_tr_b16 v[176:177], v246 offset:8192
ds_read_b64_tr_b16 v[178:179], v246 offset:9216
v_mfma_f32_16x16x32_bf16 v[76:79], v[180:183], v[212:215], 0
v_cvt_pk_bf16_f32 v82, v52, v53
v_cvt_pk_bf16_f32 v83, v54, v55
v_mfma_f32_16x16x32_bf16 v[68:71], v[180:183], v[208:211], 0
ds_read_b64_tr_b16 v[180:181], v247 offset:8192
ds_read_b64_tr_b16 v[182:183], v247 offset:9216
v_mfma_f32_16x16x32_bf16 v[64:67], v[184:187], v[216:219], v[64:67]
v_cvt_pk_bf16_f32 v84, v56, v57
v_cvt_pk_bf16_f32 v85, v58, v59
v_mfma_f32_16x16x32_bf16 v[72:75], v[184:187], v[220:223], v[72:75]
ds_read_b64_tr_b16 v[184:185], v246 offset:10240
ds_read_b64_tr_b16 v[186:187], v246 offset:11264
v_mfma_f32_16x16x32_bf16 v[76:79], v[188:191], v[220:223], v[76:79]
v_cvt_pk_bf16_f32 v86, v60, v61
v_cvt_pk_bf16_f32 v87, v62, v63
v_mfma_f32_16x16x32_bf16 v[68:71], v[188:191], v[216:219], v[68:71]
ds_read_b64_tr_b16 v[188:189], v247 offset:10240
ds_read_b64_tr_b16 v[190:191], v247 offset:11264
v_mfma_f32_16x16x32_bf16 v[64:67], v[192:195], v[224:227], v[64:67]
v_mfma_f32_16x16x32_bf16 v[72:75], v[192:195], v[228:231], v[72:75]
ds_read_b64_tr_b16 v[192:193], v246 offset:12288
ds_read_b64_tr_b16 v[194:195], v246 offset:13312
v_mfma_f32_16x16x32_bf16 v[76:79], v[196:199], v[228:231], v[76:79]
v_mfma_f32_16x16x32_bf16 v[68:71], v[196:199], v[224:227], v[68:71]
ds_read_b64_tr_b16 v[196:197], v247 offset:12288
ds_read_b64_tr_b16 v[198:199], v247 offset:13312
s_cmp_lg_u32 s99, 0
s_cbranch_scc1 L_bs33
v_mfma_f32_16x16x32_bf16 v[64:67], v[200:203], v[232:235], v[64:67]
v_mfma_f32_16x16x32_bf16 v[72:75], v[200:203], v[236:239], v[72:75]
ds_read_b64_tr_b16 v[200:201], v246 offset:14336
ds_read_b64_tr_b16 v[202:203], v246 offset:15360
v_mfma_f32_16x16x32_bf16 v[76:79], v[204:207], v[236:239], v[76:79]
v_mfma_f32_16x16x32_bf16 v[68:71], v[204:207], v[232:235], v[68:71]
ds_read_b64_tr_b16 v[204:205], v247 offset:14336
ds_read_b64_tr_b16 v[206:207], v247 offset:15360
L_bs33:
s_setprio 0
s_add_u32 m0, s76, 33792
s_addk_i32 s96, 8192
buffer_load_dwordx4 v240, s[12:15], s96 offen lds
s_addk_i32 m0, 32
s_nop 0
buffer_load_dwordx4 v240, s[12:15], s96 offen offset:1024 lds
s_addk_i32 m0, 8416
s_addk_i32 s96, 8192
buffer_load_dwordx4 v240, s[12:15], s96 offen lds
s_addk_i32 m0, 32
s_nop 0
buffer_load_dwordx4 v240, s[12:15], s96 offen offset:1024 lds
s_add_u32 m0, s88, 135168
s_add_u32 s82, s87, 512
buffer_load_dwordx4 v242, s[36:39], s82 offen lds
s_addk_i32 m0, 1024
s_addk_i32 s82, 14336
buffer_load_dwordx4 v242, s[36:39], s82 offen lds
s_add_u32 m0, s77, 84480
s_addk_i32 s97, 8192
buffer_load_dwordx4 v240, s[16:19], s97 offen lds
s_addk_i32 m0, 32
s_nop 0
buffer_load_dwordx4 v240, s[16:19], s97 offen offset:1024 lds
s_addk_i32 m0, 8416
s_addk_i32 s97, 8192
buffer_load_dwordx4 v240, s[16:19], s97 offen lds
s_addk_i32 m0, 32
s_nop 0
buffer_load_dwordx4 v240, s[16:19], s97 offen offset:1024 lds
s_mov_b32 s83, 524288
buffer_store_dwordx4 v[80:83], v249, s[40:43], s83 offen sc1
s_addk_i32 s83, 16384
buffer_store_dwordx4 v[84:87], v249, s[40:43], s83 offen sc1
s_waitcnt vmcnt(18)
s_waitcnt lgkmcnt(0)
s_barrier
s_setprio 2
v_mfma_f32_16x16x32_bf16 v[48:51], v[176:179], v[208:211], 0
v_cvt_pk_bf16_f32 v88, v64, v65
v_cvt_pk_bf16_f32 v89, v66, v67
v_mfma_f32_16x16x32_bf16 v[56:59], v[176:179], v[212:215], 0
ds_read_b64_tr_b16 v[176:177], v246 offset:16384
ds_read_b64_tr_b16 v[178:179], v246 offset:17408
v_mfma_f32_16x16x32_bf16 v[60:63], v[180:183], v[212:215], 0
v_cvt_pk_bf16_f32 v90, v68, v69
v_cvt_pk_bf16_f32 v91, v70, v71
v_mfma_f32_16x16x32_bf16 v[52:55], v[180:183], v[208:211], 0
ds_read_b64_tr_b16 v[180:181], v247 offset:16384
ds_read_b64_tr_b16 v[182:183], v247 offset:17408
v_mfma_f32_16x16x32_bf16 v[48:51], v[184:187], v[216:219], v[48:51]
v_cvt_pk_bf16_f32 v92, v72, v73
v_cvt_pk_bf16_f32 v93, v74, v75
v_mfma_f32_16x16x32_bf16 v[56:59], v[184:187], v[220:223], v[56:59]
ds_read_b64_tr_b16 v[184:185], v246 offset:18432
ds_read_b64_tr_b16 v[186:187], v246 offset:19456
v_mfma_f32_16x16x32_bf16 v[60:63], v[188:191], v[220:223], v[60:63]
v_cvt_pk_bf16_f32 v94, v76, v77
v_cvt_pk_bf16_f32 v95, v78, v79
v_mfma_f32_16x16x32_bf16 v[52:55], v[188:191], v[216:219], v[52:55]
ds_read_b64_tr_b16 v[188:189], v247 offset:18432
ds_read_b64_tr_b16 v[190:191], v247 offset:19456
v_mfma_f32_16x16x32_bf16 v[48:51], v[192:195], v[224:227], v[48:51]
v_mfma_f32_16x16x32_bf16 v[56:59], v[192:195], v[228:231], v[56:59]
ds_read_b64_tr_b16 v[192:193], v246 offset:20480
ds_read_b64_tr_b16 v[194:195], v246 offset:21504
v_mfma_f32_16x16x32_bf16 v[60:63], v[196:199], v[228:231], v[60:63]
v_mfma_f32_16x16x32_bf16 v[52:55], v[196:199], v[224:227], v[52:55]
ds_read_b64_tr_b16 v[196:197], v247 offset:20480
ds_read_b64_tr_b16 v[198:199], v247 offset:21504
s_cmp_lg_u32 s99, 0
s_cbranch_scc1 L_bs34
v_mfma_f32_16x16x32_bf16 v[48:51], v[200:203], v[232:235], v[48:51]
v_mfma_f32_16x16x32_bf16 v[56:59], v[200:203], v[236:239], v[56:59]
ds_read_b64_tr_b16 v[200:201], v246 offset:22528
ds_read_b64_tr_b16 v[202:203], v246 offset:23552
v_mfma_f32_16x16x32_bf16 v[60:63], v[204:207], v[236:239], v[60:63]
v_mfma_f32_16x16x32_bf16 v[52:55], v[204:207], v[232:235], v[52:55]
ds_read_b64_tr_b16 v[204:205], v247 offset:22528
ds_read_b64_tr_b16 v[206:207], v247 offset:23552
L_bs34:
s_setprio 0
s_add_u32 m0, s76, 50688
s_addk_i32 s96, 8192
buffer_load_dwordx4 v240, s[12:15], s96 offen lds
s_addk_i32 m0, 32
s_nop 0
buffer_load_dwordx4 v240, s[12:15], s96 offen offset:1024 lds
s_addk_i32 m0, 8416
s_addk_i32 s96, 8192
buffer_load_dwordx4 v240, s[12:15], s96 offen lds
s_addk_i32 m0, 32
s_nop 0
buffer_load_dwordx4 v240, s[12:15], s96 offen offset:1024 lds
s_add_u32 m0, s88, 143360
s_add_u32 s82, s87, 576
buffer_load_dwordx4 v242, s[36:39], s82 offen lds
s_addk_i32 m0, 1024
s_addk_i32 s82, 14336
buffer_load_dwordx4 v242, s[36:39], s82 offen lds
s_add_u32 m0, s77, 101376
s_addk_i32 s97, 8192
buffer_load_dwordx4 v240, s[16:19], s97 offen lds
s_addk_i32 m0, 32
s_nop 0
buffer_load_dwordx4 v240, s[16:19], s97 offen offset:1024 lds
s_addk_i32 m0, 8416
s_addk_i32 s97, 8192
buffer_load_dwordx4 v240, s[16:19], s97 offen lds
s_addk_i32 m0, 32
s_nop 0
buffer_load_dwordx4 v240, s[16:19], s97 offen offset:1024 lds
s_mov_b32 s83, 557056
buffer_store_dwordx4 v[88:91], v249, s[40:43], s83 offen sc1
s_addk_i32 s83, 16384
buffer_store_dwordx4 v[92:95], v249, s[40:43], s83 offen sc1
s_waitcnt vmcnt(18)
s_waitcnt lgkmcnt(0)
s_barrier
s_setprio 2
v_mfma_f32_16x16x32_bf16 v[64:67], v[176:179], v[208:211], 0
v_cvt_pk_bf16_f32 v80, v48, v49
v_cvt_pk_bf16_f32 v81, v50, v51
v_mfma_f32_16x16x32_bf16 v[72:75], v[176:179], v[212:215], 0
ds_read_b64_tr_b16 v[176:177], v246 offset:0
ds_read_b64_tr_b16 v[178:179], v246 offset:1024
v_mfma_f32_16x16x32_bf16 v[76:79], v[180:183], v[212:215], 0
v_cvt_pk_bf16_f32 v82, v52, v53
v_cvt_pk_bf16_f32 v83, v54, v55
v_mfma_f32_16x16x32_bf16 v[68:71], v[180:183], v[208:211], 0
ds_read_b64_tr_b16 v[180:181], v247 offset:0
ds_read_b64_tr_b16 v[182:183], v247 offset:1024
v_mfma_f32_16x16x32_bf16 v[64:67], v[184:187], v[216:219], v[64:67]
v_cvt_pk_bf16_f32 v84, v56, v57
v_cvt_pk_bf16_f32 v85, v58, v59
v_mfma_f32_16x16x32_bf16 v[72:75], v[184:187], v[220:223], v[72:75]
ds_read_b64_tr_b16 v[184:185], v246 offset:2048
ds_read_b64_tr_b16 v[186:187], v246 offset:3072
v_mfma_f32_16x16x32_bf16 v[76:79], v[188:191], v[220:223], v[76:79]
v_cvt_pk_bf16_f32 v86, v60, v61
v_cvt_pk_bf16_f32 v87, v62, v63
v_mfma_f32_16x16x32_bf16 v[68:71], v[188:191], v[216:219], v[68:71]
ds_read_b64_tr_b16 v[188:189], v247 offset:2048
ds_read_b64_tr_b16 v[190:191], v247 offset:3072
v_mfma_f32_16x16x32_bf16 v[64:67], v[192:195], v[224:227], v[64:67]
v_mfma_f32_16x16x32_bf16 v[72:75], v[192:195], v[228:231], v[72:75]
ds_read_b64_tr_b16 v[192:193], v246 offset:4096
ds_read_b64_tr_b16 v[194:195], v246 offset:5120
v_mfma_f32_16x16x32_bf16 v[76:79], v[196:199], v[228:231], v[76:79]
v_mfma_f32_16x16x32_bf16 v[68:71], v[196:199], v[224:227], v[68:71]
ds_read_b64_tr_b16 v[196:197], v247 offset:4096
ds_read_b64_tr_b16 v[198:199], v247 offset:5120
s_cmp_lg_u32 s99, 0
s_cbranch_scc1 L_bs35
v_mfma_f32_16x16x32_bf16 v[64:67], v[200:203], v[232:235], v[64:67]
v_mfma_f32_16x16x32_bf16 v[72:75], v[200:203], v[236:239], v[72:75]
ds_read_b64_tr_b16 v[200:201], v246 offset:6144
ds_read_b64_tr_b16 v[202:203], v246 offset:7168
v_mfma_f32_16x16x32_bf16 v[76:79], v[204:207], v[236:239], v[76:79]
v_mfma_f32_16x16x32_bf16 v[68:71], v[204:207], v[232:235], v[68:71]
ds_read_b64_tr_b16 v[204:205], v247 offset:6144
ds_read_b64_tr_b16 v[206:207], v247 offset:7168
L_bs35:
s_setprio 0
s_add_u32 m0, s76, 0
s_addk_i32 s96, 8192
buffer_load_dwordx4 v240, s[12:15], s96 offen lds
s_addk_i32 m0, 32
s_nop 0
buffer_load_dwordx4 v240, s[12:15], s96 offen offset:1024 lds
s_addk_i32 m0, 8416
s_addk_i32 s96, 8192
buffer_load_dwordx4 v240, s[12:15], s96 offen lds
s_addk_i32 m0, 32
s_nop 0
buffer_load_dwordx4 v240, s[12:15], s96 offen offset:1024 lds
s_add_u32 m0, s88, 151552
s_add_u32 s82, s87, 640
buffer_load_dwordx4 v242, s[36:39], s82 offen lds
s_addk_i32 m0, 1024
s_addk_i32 s82, 14336
buffer_load_dwordx4 v242, s[36:39], s82 offen lds
s_add_u32 m0, s77, 118272
s_addk_i32 s97, 8192
buffer_load_dwordx4 v240, s[16:19], s97 offen lds
s_addk_i32 m0, 32
s_nop 0
buffer_load_dwordx4 v240, s[16:19], s97 offen offset:1024 lds
s_addk_i32 m0, 8416
s_addk_i32 s97, 8192
buffer_load_dwordx4 v240, s[16:19], s97 offen lds
s_addk_i32 m0, 32
s_nop 0
buffer_load_dwordx4 v240, s[16:19], s97 offen offset:1024 lds
s_mov_b32 s83, 786432
buffer_store_dwordx4 v[80:83], v249, s[40:43], s83 offen sc1
s_addk_i32 s83, 16384
buffer_store_dwordx4 v[84:87], v249, s[40:43], s83 offen sc1
s_waitcnt vmcnt(18)
s_waitcnt lgkmcnt(0)
s_barrier
s_setprio 2
v_mfma_f32_16x16x32_bf16 v[48:51], v[176:179], v[208:211], 0
v_cvt_pk_bf16_f32 v88, v64, v65
v_cvt_pk_bf16_f32 v89, v66, v67
v_mfma_f32_16x16x32_bf16 v[56:59], v[176:179], v[212:215], 0
ds_read_b64_tr_b16 v[176:177], v246 offset:8192
ds_read_b64_tr_b16 v[178:179], v246 offset:9216
v_mfma_f32_16x16x32_bf16 v[60:63], v[180:183], v[212:215], 0
v_cvt_pk_bf16_f32 v90, v68, v69
v_cvt_pk_bf16_f32 v91, v70, v71
v_mfma_f32_16x16x32_bf16 v[52:55], v[180:183], v[208:211], 0
ds_read_b64_tr_b16 v[180:181], v247 offset:8192
ds_read_b64_tr_b16 v[182:183], v247 offset:9216
v_mfma_f32_16x16x32_bf16 v[48:51], v[184:187], v[216:219], v[48:51]
v_cvt_pk_bf16_f32 v92, v72, v73
v_cvt_pk_bf16_f32 v93, v74, v75
v_mfma_f32_16x16x32_bf16 v[56:59], v[184:187], v[220:223], v[56:59]
ds_read_b64_tr_b16 v[184:185], v246 offset:10240
ds_read_b64_tr_b16 v[186:187], v246 offset:11264
v_mfma_f32_16x16x32_bf16 v[60:63], v[188:191], v[220:223], v[60:63]
v_cvt_pk_bf16_f32 v94, v76, v77
v_cvt_pk_bf16_f32 v95, v78, v79
v_mfma_f32_16x16x32_bf16 v[52:55], v[188:191], v[216:219], v[52:55]
ds_read_b64_tr_b16 v[188:189], v247 offset:10240
ds_read_b64_tr_b16 v[190:191], v247 offset:11264
v_mfma_f32_16x16x32_bf16 v[48:51], v[192:195], v[224:227], v[48:51]
s_nop 0
v_mfma_f32_16x16x32_bf16 v[56:59], v[192:195], v[228:231], v[56:59]
ds_read_b64_tr_b16 v[192:193], v246 offset:12288
ds_read_b64_tr_b16 v[194:195], v246 offset:13312
v_mfma_f32_16x16x32_bf16 v[60:63], v[196:199], v[228:231], v[60:63]
v_mfma_f32_16x16x32_bf16 v[52:55], v[196:199], v[224:227], v[52:55]
ds_read_b64_tr_b16 v[196:197], v247 offset:12288
ds_read_b64_tr_b16 v[198:199], v247 offset:13312
s_cmp_lg_u32 s99, 0
s_cbranch_scc1 L_bs36
v_mfma_f32_16x16x32_bf16 v[48:51], v[200:203], v[232:235], v[48:51]
v_mfma_f32_16x16x32_bf16 v[56:59], v[200:203], v[236:239], v[56:59]
ds_read_b64_tr_b16 v[200:201], v246 offset:14336
ds_read_b64_tr_b16 v[202:203], v246 offset:15360
v_mfma_f32_16x16x32_bf16 v[60:63], v[204:207], v[236:239], v[60:63]
v_mfma_f32_16x16x32_bf16 v[52:55], v[204:207], v[232:235], v[52:55]
ds_read_b64_tr_b16 v[204:205], v247 offset:14336
ds_read_b64_tr_b16 v[206:207], v247 offset:15360
L_bs36:
s_setprio 0
s_add_u32 m0, s76, 16896
s_addk_i32 s96, 8192
buffer_load_dwordx4 v240, s[12:15], s96 offen lds
s_addk_i32 m0, 32
s_nop 0
buffer_load_dwordx4 v240, s[12:15], s96 offen offset:1024 lds
s_addk_i32 m0, 8416
s_addk_i32 s96, 8192
buffer_load_dwordx4 v240, s[12:15], s96 offen lds
s_addk_i32 m0, 32
s_nop 0
buffer_load_dwordx4 v240, s[12:15], s96 offen offset:1024 lds
s_add_u32 m0, s88, 135168
s_add_u32 s82, s87, 704
buffer_load_dwordx4 v242, s[36:39], s82 offen lds
s_addk_i32 m0, 1024
s_addk_i32 s82, 14336
buffer_load_dwordx4 v242, s[36:39], s82 offen lds
s_add_u32 m0, s77, 67584
s_addk_i32 s97, 8192
buffer_load_dwordx4 v240, s[16:19], s97 offen lds
s_addk_i32 m0, 32
s_nop 0
buffer_load_dwordx4 v240, s[16:19], s97 offen offset:1024 lds
s_addk_i32 m0, 8416
s_addk_i32 s97, 8192
buffer_load_dwordx4 v240, s[16:19], s97 offen lds
s_addk_i32 m0, 32
s_nop 0
buffer_load_dwordx4 v240, s[16:19], s97 offen offset:1024 lds
s_mov_b32 s83, 819200
buffer_store_dwordx4 v[88:91], v249, s[40:43], s83 offen sc1
s_addk_i32 s83, 16384
buffer_store_dwordx4 v[92:95], v249, s[40:43], s83 offen sc1
s_waitcnt vmcnt(18)
s_waitcnt lgkmcnt(0)
s_barrier
s_setprio 2
v_mfma_f32_16x16x32_bf16 v[64:67], v[176:179], v[208:211], 0
v_cvt_pk_bf16_f32 v80, v48, v49
v_cvt_pk_bf16_f32 v81, v50, v51
v_mfma_f32_16x16x32_bf16 v[72:75], v[176:179], v[212:215], 0
ds_read_b64_tr_b16 v[176:177], v246 offset:16384
ds_read_b64_tr_b16 v[178:179], v246 offset:17408
v_mfma_f32_16x16x32_bf16 v[76:79], v[180:183], v[212:215], 0
v_cvt_pk_bf16_f32 v82, v52, v53
v_cvt_pk_bf16_f32 v83, v54, v55
v_mfma_f32_16x16x32_bf16 v[68:71], v[180:183], v[208:211], 0
ds_read_b64_tr_b16 v[180:181], v247 offset:16384
ds_read_b64_tr_b16 v[182:183], v247 offset:17408
v_mfma_f32_16x16x32_bf16 v[64:67], v[184:187], v[216:219], v[64:67]
v_cvt_pk_bf16_f32 v84, v56, v57
v_cvt_pk_bf16_f32 v85, v58, v59
v_mfma_f32_16x16x32_bf16 v[72:75], v[184:187], v[220:223], v[72:75]
ds_read_b64_tr_b16 v[184:185], v246 offset:18432
ds_read_b64_tr_b16 v[186:187], v246 offset:19456
v_mfma_f32_16x16x32_bf16 v[76:79], v[188:191], v[220:223], v[76:79]
v_cvt_pk_bf16_f32 v86, v60, v61
v_cvt_pk_bf16_f32 v87, v62, v63
v_mfma_f32_16x16x32_bf16 v[68:71], v[188:191], v[216:219], v[68:71]
ds_read_b64_tr_b16 v[188:189], v247 offset:18432
ds_read_b64_tr_b16 v[190:191], v247 offset:19456
v_mfma_f32_16x16x32_bf16 v[64:67], v[192:195], v[224:227], v[64:67]
v_mfma_f32_16x16x32_bf16 v[72:75], v[192:195], v[228:231], v[72:75]
ds_read_b64_tr_b16 v[192:193], v246 offset:20480
ds_read_b64_tr_b16 v[194:195], v246 offset:21504
v_mfma_f32_16x16x32_bf16 v[76:79], v[196:199], v[228:231], v[76:79]
v_mfma_f32_16x16x32_bf16 v[68:71], v[196:199], v[224:227], v[68:71]
ds_read_b64_tr_b16 v[196:197], v247 offset:20480
ds_read_b64_tr_b16 v[198:199], v247 offset:21504
s_cmp_lg_u32 s99, 0
s_cbranch_scc1 L_bs37
v_mfma_f32_16x16x32_bf16 v[64:67], v[200:203], v[232:235], v[64:67]
v_mfma_f32_16x16x32_bf16 v[72:75], v[200:203], v[236:239], v[72:75]
ds_read_b64_tr_b16 v[200:201], v246 offset:22528
ds_read_b64_tr_b16 v[202:203], v246 offset:23552
v_mfma_f32_16x16x32_bf16 v[76:79], v[204:207], v[236:239], v[76:79]
v_mfma_f32_16x16x32_bf16 v[68:71], v[204:207], v[232:235], v[68:71]
ds_read_b64_tr_b16 v[204:205], v247 offset:22528
ds_read_b64_tr_b16 v[206:207], v247 offset:23552
L_bs37:
s_setprio 0
s_add_u32 m0, s76, 33792
s_addk_i32 s96, 8192
buffer_load_dwordx4 v240, s[12:15], s96 offen lds
s_addk_i32 m0, 32
s_nop 0
buffer_load_dwordx4 v240, s[12:15], s96 offen offset:1024 lds
s_addk_i32 m0, 8416
s_addk_i32 s96, 8192
buffer_load_dwordx4 v240, s[12:15], s96 offen lds
s_addk_i32 m0, 32
s_nop 0
buffer_load_dwordx4 v240, s[12:15], s96 offen offset:1024 lds
s_add_u32 m0, s88, 143360
s_add_u32 s82, s87, 768
buffer_load_dwordx4 v242, s[36:39], s82 offen lds
s_addk_i32 m0, 1024
s_addk_i32 s82, 14336
buffer_load_dwordx4 v242, s[36:39], s82 offen lds
s_add_u32 m0, s77, 84480
s_addk_i32 s97, 8192
buffer_load_dwordx4 v240, s[16:19], s97 offen lds
s_addk_i32 m0, 32
s_nop 0
buffer_load_dwordx4 v240, s[16:19], s97 offen offset:1024 lds
s_addk_i32 m0, 8416
s_addk_i32 s97, 8192
buffer_load_dwordx4 v240, s[16:19], s97 offen lds
s_addk_i32 m0, 32
s_nop 0
buffer_load_dwordx4 v240, s[16:19], s97 offen offset:1024 lds
s_mov_b32 s83, 1048576
buffer_store_dwordx4 v[80:83], v249, s[40:43], s83 offen sc1
s_addk_i32 s83, 16384
buffer_store_dwordx4 v[84:87], v249, s[40:43], s83 offen sc1
s_waitcnt vmcnt(18)
s_waitcnt lgkmcnt(0)
s_barrier
s_setprio 2
v_mfma_f32_16x16x32_bf16 v[48:51], v[176:179], v[208:211], 0
v_cvt_pk_bf16_f32 v88, v64, v65
v_cvt_pk_bf16_f32 v89, v66, v67
v_mfma_f32_16x16x32_bf16 v[56:59], v[176:179], v[212:215], 0
ds_read_b64_tr_b16 v[176:177], v246 offset:0
ds_read_b64_tr_b16 v[178:179], v246 offset:1024
v_mfma_f32_16x16x32_bf16 v[60:63], v[180:183], v[212:215], 0
v_cvt_pk_bf16_f32 v90, v68, v69
v_cvt_pk_bf16_f32 v91, v70, v71
v_mfma_f32_16x16x32_bf16 v[52:55], v[180:183], v[208:211], 0
ds_read_b64_tr_b16 v[180:181], v247 offset:0
ds_read_b64_tr_b16 v[182:183], v247 offset:1024
v_mfma_f32_16x16x32_bf16 v[48:51], v[184:187], v[216:219], v[48:51]
v_cvt_pk_bf16_f32 v92, v72, v73
v_cvt_pk_bf16_f32 v93, v74, v75
v_mfma_f32_16x16x32_bf16 v[56:59], v[184:187], v[220:223], v[56:59]
ds_read_b64_tr_b16 v[184:185], v246 offset:2048
ds_read_b64_tr_b16 v[186:187], v246 offset:3072
v_mfma_f32_16x16x32_bf16 v[60:63], v[188:191], v[220:223], v[60:63]
v_cvt_pk_bf16_f32 v94, v76, v77
v_cvt_pk_bf16_f32 v95, v78, v79
v_mfma_f32_16x16x32_bf16 v[52:55], v[188:191], v[216:219], v[52:55]
ds_read_b64_tr_b16 v[188:189], v247 offset:2048
ds_read_b64_tr_b16 v[190:191], v247 offset:3072
v_mfma_f32_16x16x32_bf16 v[48:51], v[192:195], v[224:227], v[48:51]
v_mfma_f32_16x16x32_bf16 v[56:59], v[192:195], v[228:231], v[56:59]
ds_read_b64_tr_b16 v[192:193], v246 offset:4096
ds_read_b64_tr_b16 v[194:195], v246 offset:5120
v_mfma_f32_16x16x32_bf16 v[60:63], v[196:199], v[228:231], v[60:63]
v_mfma_f32_16x16x32_bf16 v[52:55], v[196:199], v[224:227], v[52:55]
ds_read_b64_tr_b16 v[196:197], v247 offset:4096
ds_read_b64_tr_b16 v[198:199], v247 offset:5120
s_cmp_lg_u32 s99, 0
s_cbranch_scc1 L_bs38
v_mfma_f32_16x16x32_bf16 v[48:51], v[200:203], v[232:235], v[48:51]
v_mfma_f32_16x16x32_bf16 v[56:59], v[200:203], v[236:239], v[56:59]
ds_read_b64_tr_b16 v[200:201], v246 offset:6144
ds_read_b64_tr_b16 v[202:203], v246 offset:7168
v_mfma_f32_16x16x32_bf16 v[60:63], v[204:207], v[236:239], v[60:63]
v_mfma_f32_16x16x32_bf16 v[52:55], v[204:207], v[232:235], v[52:55]
ds_read_b64_tr_b16 v[204:205], v247 offset:6144
ds_read_b64_tr_b16 v[206:207], v247 offset:7168
L_bs38:
s_setprio 0
s_add_u32 m0, s76, 50688
s_addk_i32 s96, 8192
buffer_load_dwordx4 v240, s[12:15], s96 offen lds
s_addk_i32 m0, 32
s_nop 0
buffer_load_dwordx4 v240, s[12:15], s96 offen offset:1024 lds
s_addk_i32 m0, 8416
s_addk_i32 s96, 8192
buffer_load_dwordx4 v240, s[12:15], s96 offen lds
s_addk_i32 m0, 32
s_nop 0
buffer_load_dwordx4 v240, s[12:15], s96 offen offset:1024 lds
s_add_u32 m0, s88, 151552
s_add_u32 s82, s87, 832
buffer_load_dwordx4 v242, s[36:39], s82 offen lds
s_addk_i32 m0, 1024
s_addk_i32 s82, 14336
buffer_load_dwordx4 v242, s[36:39], s82 offen lds
s_add_u32 m0, s77, 101376
s_addk_i32 s97, 8192
buffer_load_dwordx4 v240, s[16:19], s97 offen lds
s_addk_i32 m0, 32
s_nop 0
buffer_load_dwordx4 v240, s[16:19], s97 offen offset:1024 lds
s_addk_i32 m0, 8416
s_addk_i32 s97, 8192
buffer_load_dwordx4 v240, s[16:19], s97 offen lds
s_addk_i32 m0, 32
s_nop 0
buffer_load_dwordx4 v240, s[16:19], s97 offen offset:1024 lds
s_mov_b32 s83, 1081344
buffer_store_dwordx4 v[88:91], v249, s[40:43], s83 offen sc1
s_addk_i32 s83, 16384
buffer_store_dwordx4 v[92:95], v249, s[40:43], s83 offen sc1
v_mov_b32 v96, 0
v_mov_b32 v97, 1
s_waitcnt vmcnt(24)
s_mov_b64 exec, 1
global_store_dword v96, v97, s[100:101] offset:0 sc1
s_mov_b64 exec, -1
s_waitcnt vmcnt(19)
s_waitcnt lgkmcnt(0)
s_barrier
s_setprio 2
v_mfma_f32_16x16x32_bf16 v[64:67], v[176:179], v[208:211], 0
v_cvt_pk_bf16_f32 v80, v48, v49
v_cvt_pk_bf16_f32 v81, v50, v51
v_mfma_f32_16x16x32_bf16 v[72:75], v[176:179], v[212:215], 0
ds_read_b64_tr_b16 v[176:177], v246 offset:8192
ds_read_b64_tr_b16 v[178:179], v246 offset:9216
v_mfma_f32_16x16x32_bf16 v[76:79], v[180:183], v[212:215], 0
v_cvt_pk_bf16_f32 v82, v52, v53
v_cvt_pk_bf16_f32 v83, v54, v55
v_mfma_f32_16x16x32_bf16 v[68:71], v[180:183], v[208:211], 0
ds_read_b64_tr_b16 v[180:181], v247 offset:8192
ds_read_b64_tr_b16 v[182:183], v247 offset:9216
v_mfma_f32_16x16x32_bf16 v[64:67], v[184:187], v[216:219], v[64:67]
v_cvt_pk_bf16_f32 v84, v56, v57
v_cvt_pk_bf16_f32 v85, v58, v59
v_mfma_f32_16x16x32_bf16 v[72:75], v[184:187], v[220:223], v[72:75]
ds_read_b64_tr_b16 v[184:185], v246 offset:10240
ds_read_b64_tr_b16 v[186:187], v246 offset:11264
v_mfma_f32_16x16x32_bf16 v[76:79], v[188:191], v[220:223], v[76:79]
v_cvt_pk_bf16_f32 v86, v60, v61
v_cvt_pk_bf16_f32 v87, v62, v63
v_mfma_f32_16x16x32_bf16 v[68:71], v[188:191], v[216:219], v[68:71]
ds_read_b64_tr_b16 v[188:189], v247 offset:10240
ds_read_b64_tr_b16 v[190:191], v247 offset:11264
v_mfma_f32_16x16x32_bf16 v[64:67], v[192:195], v[224:227], v[64:67]
s_nop 0
v_mfma_f32_16x16x32_bf16 v[72:75], v[192:195], v[228:231], v[72:75]
ds_read_b64_tr_b16 v[192:193], v246 offset:12288
ds_read_b64_tr_b16 v[194:195], v246 offset:13312
v_mfma_f32_16x16x32_bf16 v[76:79], v[196:199], v[228:231], v[76:79]
v_mfma_f32_16x16x32_bf16 v[68:71], v[196:199], v[224:227], v[68:71]
ds_read_b64_tr_b16 v[196:197], v247 offset:12288
ds_read_b64_tr_b16 v[198:199], v247 offset:13312
s_cmp_lg_u32 s99, 0
s_cbranch_scc1 L_bs39
v_mfma_f32_16x16x32_bf16 v[64:67], v[200:203], v[232:235], v[64:67]
v_mfma_f32_16x16x32_bf16 v[72:75], v[200:203], v[236:239], v[72:75]
ds_read_b64_tr_b16 v[200:201], v246 offset:14336
ds_read_b64_tr_b16 v[202:203], v246 offset:15360
v_mfma_f32_16x16x32_bf16 v[76:79], v[204:207], v[236:239], v[76:79]
v_mfma_f32_16x16x32_bf16 v[68:71], v[204:207], v[232:235], v[68:71]
ds_read_b64_tr_b16 v[204:205], v247 offset:14336
ds_read_b64_tr_b16 v[206:207], v247 offset:15360
L_bs39:
s_setprio 0
s_add_u32 m0, s76, 0
s_addk_i32 s96, 8192
buffer_load_dwordx4 v240, s[12:15], s96 offen lds
s_addk_i32 m0, 32
s_nop 0
buffer_load_dwordx4 v240, s[12:15], s96 offen offset:1024 lds
s_addk_i32 m0, 8416
s_addk_i32 s96, 8192
buffer_load_dwordx4 v240, s[12:15], s96 offen lds
s_addk_i32 m0, 32
s_nop 0
buffer_load_dwordx4 v240, s[12:15], s96 offen offset:1024 lds
s_add_u32 m0, s77, 118272
s_addk_i32 s97, 8192
buffer_load_dwordx4 v240, s[16:19], s97 offen lds
s_addk_i32 m0, 32
s_nop 0
buffer_load_dwordx4 v240, s[16:19], s97 offen offset:1024 lds
s_addk_i32 m0, 8416
s_addk_i32 s97, 8192
buffer_load_dwordx4 v240, s[16:19], s97 offen lds
s_addk_i32 m0, 32
s_nop 0
buffer_load_dwordx4 v240, s[16:19], s97 offen offset:1024 lds
s_mov_b32 s83, 1310720
buffer_store_dwordx4 v[80:83], v249, s[40:43], s83 offen sc1
s_addk_i32 s83, 16384
buffer_store_dwordx4 v[84:87], v249, s[40:43], s83 offen sc1
s_waitcnt vmcnt(17)
s_waitcnt lgkmcnt(0)
s_barrier
buffer_load_dword v253, v252, s[32:35], s84 offen offset:0 sc1
s_setprio 2
v_mfma_f32_16x16x32_bf16 v[48:51], v[176:179], v[208:211], 0
v_cvt_pk_bf16_f32 v88, v64, v65
v_cvt_pk_bf16_f32 v89, v66, v67
v_mfma_f32_16x16x32_bf16 v[56:59], v[176:179], v[212:215], 0
ds_read_b64_tr_b16 v[176:177], v246 offset:16384
ds_read_b64_tr_b16 v[178:179], v246 offset:17408
v_mfma_f32_16x16x32_bf16 v[60:63], v[180:183], v[212:215], 0
v_cvt_pk_bf16_f32 v90, v68, v69
v_cvt_pk_bf16_f32 v91, v70, v71
v_mfma_f32_16x16x32_bf16 v[52:55], v[180:183], v[208:211], 0
ds_read_b64_tr_b16 v[180:181], v247 offset:16384
ds_read_b64_tr_b16 v[182:183], v247 offset:17408
v_mfma_f32_16x16x32_bf16 v[48:51], v[184:187], v[216:219], v[48:51]
v_cvt_pk_bf16_f32 v92, v72, v73
v_cvt_pk_bf16_f32 v93, v74, v75
v_mfma_f32_16x16x32_bf16 v[56:59], v[184:187], v[220:223], v[56:59]
ds_read_b64_tr_b16 v[184:185], v246 offset:18432
ds_read_b64_tr_b16 v[186:187], v246 offset:19456
v_mfma_f32_16x16x32_bf16 v[60:63], v[188:191], v[220:223], v[60:63]
v_cvt_pk_bf16_f32 v94, v76, v77
v_cvt_pk_bf16_f32 v95, v78, v79
v_mfma_f32_16x16x32_bf16 v[52:55], v[188:191], v[216:219], v[52:55]
ds_read_b64_tr_b16 v[188:189], v247 offset:18432
ds_read_b64_tr_b16 v[190:191], v247 offset:19456
v_mfma_f32_16x16x32_bf16 v[48:51], v[192:195], v[224:227], v[48:51]
s_nop 0
v_mfma_f32_16x16x32_bf16 v[56:59], v[192:195], v[228:231], v[56:59]
ds_read_b64_tr_b16 v[192:193], v246 offset:20480
ds_read_b64_tr_b16 v[194:195], v246 offset:21504
v_mfma_f32_16x16x32_bf16 v[60:63], v[196:199], v[228:231], v[60:63]
v_mfma_f32_16x16x32_bf16 v[52:55], v[196:199], v[224:227], v[52:55]
ds_read_b64_tr_b16 v[196:197], v247 offset:20480
ds_read_b64_tr_b16 v[198:199], v247 offset:21504
s_cmp_lg_u32 s99, 0
s_cbranch_scc1 L_bs40
v_mfma_f32_16x16x32_bf16 v[48:51], v[200:203], v[232:235], v[48:51]
v_mfma_f32_16x16x32_bf16 v[56:59], v[200:203], v[236:239], v[56:59]
ds_read_b64_tr_b16 v[200:201], v246 offset:22528
ds_read_b64_tr_b16 v[202:203], v246 offset:23552
v_mfma_f32_16x16x32_bf16 v[60:63], v[204:207], v[236:239], v[60:63]
v_mfma_f32_16x16x32_bf16 v[52:55], v[204:207], v[232:235], v[52:55]
ds_read_b64_tr_b16 v[204:205], v247 offset:22528
ds_read_b64_tr_b16 v[206:207], v247 offset:23552
L_bs40:
s_setprio 0
s_add_u32 m0, s76, 16896
s_addk_i32 s96, 8192
buffer_load_dwordx4 v240, s[12:15], s96 offen lds
s_addk_i32 m0, 32
s_nop 0
buffer_load_dwordx4 v240, s[12:15], s96 offen offset:1024 lds
s_addk_i32 m0, 8416
s_addk_i32 s96, 8192
buffer_load_dwordx4 v240, s[12:15], s96 offen lds
s_addk_i32 m0, 32
s_nop 0
buffer_load_dwordx4 v240, s[12:15], s96 offen offset:1024 lds
s_add_u32 m0, s77, 67584
s_addk_i32 s97, 8192
buffer_load_dwordx4 v240, s[16:19], s97 offen lds
s_addk_i32 m0, 32
s_nop 0
buffer_load_dwordx4 v240, s[16:19], s97 offen offset:1024 lds
s_addk_i32 m0, 8416
s_addk_i32 s97, 8192
buffer_load_dwordx4 v240, s[16:19], s97 offen lds
s_addk_i32 m0, 32
s_nop 0
buffer_load_dwordx4 v240, s[16:19], s97 offen offset:1024 lds
s_mov_b32 s83, 1343488
buffer_store_dwordx4 v[88:91], v249, s[40:43], s83 offen sc1
s_addk_i32 s83, 16384
buffer_store_dwordx4 v[92:95], v249, s[40:43], s83 offen sc1
s_waitcnt vmcnt(10)
v_cmp_le_u32 vcc, 1, v253
s_cmp_eq_u64 vcc, -1
s_cbranch_scc1 L_pg0_ok
s_mov_b32 s7, 400000
L_pg0_lp:
s_sleep 8
buffer_load_dword v253, v252, s[32:35], s84 offen offset:0 sc1
s_waitcnt vmcnt(0)
v_cmp_le_u32 vcc, 1, v253
s_cmp_eq_u64 vcc, -1
s_cbranch_scc1 L_pg0_ok
s_sub_u32 s7, s7, 1
s_cbranch_scc0 L_pg0_lp
L_pg0_ok:
s_waitcnt lgkmcnt(0)
s_barrier
s_setprio 2
v_mfma_f32_16x16x32_bf16 v[64:67], v[176:179], v[208:211], 0
v_cvt_pk_bf16_f32 v80, v48, v49
v_cvt_pk_bf16_f32 v81, v50, v51
v_mfma_f32_16x16x32_bf16 v[72:75], v[176:179], v[212:215], 0
v_mfma_f32_16x16x32_bf16 v[76:79], v[180:183], v[212:215], 0
v_cvt_pk_bf16_f32 v82, v52, v53
v_cvt_pk_bf16_f32 v83, v54, v55
v_mfma_f32_16x16x32_bf16 v[68:71], v[180:183], v[208:211], 0
v_mfma_f32_16x16x32_bf16 v[64:67], v[184:187], v[216:219], v[64:67]
v_cvt_pk_bf16_f32 v84, v56, v57
v_cvt_pk_bf16_f32 v85, v58, v59
v_mfma_f32_16x16x32_bf16 v[72:75], v[184:187], v[220:223], v[72:75]
v_mfma_f32_16x16x32_bf16 v[76:79], v[188:191], v[220:223], v[76:79]
v_cvt_pk_bf16_f32 v86, v60, v61
v_cvt_pk_bf16_f32 v87, v62, v63
v_mfma_f32_16x16x32_bf16 v[68:71], v[188:191], v[216:219], v[68:71]
v_mfma_f32_16x16x32_bf16 v[64:67], v[192:195], v[224:227], v[64:67]
v_mfma_f32_16x16x32_bf16 v[72:75], v[192:195], v[228:231], v[72:75]
v_mfma_f32_16x16x32_bf16 v[76:79], v[196:199], v[228:231], v[76:79]
v_mfma_f32_16x16x32_bf16 v[68:71], v[196:199], v[224:227], v[68:71]
s_cmp_lg_u32 s99, 0
s_cbranch_scc1 L_bs41
v_mfma_f32_16x16x32_bf16 v[64:67], v[200:203], v[232:235], v[64:67]
v_mfma_f32_16x16x32_bf16 v[72:75], v[200:203], v[236:239], v[72:75]
v_mfma_f32_16x16x32_bf16 v[76:79], v[204:207], v[236:239], v[76:79]
v_mfma_f32_16x16x32_bf16 v[68:71], v[204:207], v[232:235], v[68:71]
L_bs41:
s_setprio 0
s_add_u32 m0, s76, 33792
s_addk_i32 s96, 8192
buffer_load_dwordx4 v240, s[12:15], s96 offen lds
s_addk_i32 m0, 32
s_nop 0
buffer_load_dwordx4 v240, s[12:15], s96 offen offset:1024 lds
s_addk_i32 m0, 8416
s_addk_i32 s96, 8192
buffer_load_dwordx4 v240, s[12:15], s96 offen lds
s_addk_i32 m0, 32
s_nop 0
buffer_load_dwordx4 v240, s[12:15], s96 offen offset:1024 lds
s_add_u32 m0, s77, 84480
s_addk_i32 s97, 8192
buffer_load_dwordx4 v240, s[16:19], s97 offen lds
s_addk_i32 m0, 32
s_nop 0
buffer_load_dwordx4 v240, s[16:19], s97 offen offset:1024 lds
s_addk_i32 m0, 8416
s_addk_i32 s97, 8192
buffer_load_dwordx4 v240, s[16:19], s97 offen lds
s_addk_i32 m0, 32
s_nop 0
buffer_load_dwordx4 v240, s[16:19], s97 offen offset:1024 lds
s_mov_b32 s83, 1572864
buffer_store_dwordx4 v[80:83], v249, s[40:43], s83 offen sc1
s_addk_i32 s83, 16384
buffer_store_dwordx4 v[84:87], v249, s[40:43], s83 offen sc1
s_mov_b32 s83, 33554432
buffer_load_dwordx4 v[112:115], v249, s[20:23], s83 offen sc1
s_mov_b32 s83, 33555456
buffer_load_dwordx4 v[116:119], v249, s[20:23], s83 offen sc1
s_waitcnt vmcnt(18)
s_barrier
v_cvt_pk_bf16_f32 v88, v64, v65
v_cvt_pk_bf16_f32 v89, v66, v67
v_cvt_pk_bf16_f32 v90, v68, v69
v_cvt_pk_bf16_f32 v91, v70, v71
v_cvt_pk_bf16_f32 v92, v72, v73
v_cvt_pk_bf16_f32 v93, v74, v75
v_cvt_pk_bf16_f32 v94, v76, v77
v_cvt_pk_bf16_f32 v95, v78, v79
s_add_u32 m0, s76, 50688
s_addk_i32 s96, 8192
buffer_load_dwordx4 v240, s[12:15], s96 offen lds
s_addk_i32 m0, 32
s_nop 0
buffer_load_dwordx4 v240, s[12:15], s96 offen offset:1024 lds
s_addk_i32 m0, 8416
s_addk_i32 s96, 8192
buffer_load_dwordx4 v240, s[12:15], s96 offen lds
s_addk_i32 m0, 32
s_nop 0
buffer_load_dwordx4 v240, s[12:15], s96 offen offset:1024 lds
s_add_u32 m0, s77, 101376
s_addk_i32 s97, 8192
buffer_load_dwordx4 v240, s[16:19], s97 offen lds
s_addk_i32 m0, 32
s_nop 0
buffer_load_dwordx4 v240, s[16:19], s97 offen offset:1024 lds
s_addk_i32 m0, 8416
s_addk_i32 s97, 8192
buffer_load_dwordx4 v240, s[16:19], s97 offen lds
s_addk_i32 m0, 32
s_nop 0
buffer_load_dwordx4 v240, s[16:19], s97 offen offset:1024 lds
s_mov_b32 s83, 1605632
buffer_store_dwordx4 v[88:91], v249, s[40:43], s83 offen sc1
s_addk_i32 s83, 16384
buffer_store_dwordx4 v[92:95], v249, s[40:43], s83 offen sc1
s_mov_b32 s83, 33556480
buffer_load_dwordx4 v[120:123], v249, s[20:23], s83 offen sc1
s_mov_b32 s83, 33557504
buffer_load_dwordx4 v[124:127], v249, s[20:23], s83 offen sc1
s_waitcnt vmcnt(20)
s_barrier
s_add_u32 m0, s76, 0
s_addk_i32 s96, 8192
buffer_load_dwordx4 v240, s[12:15], s96 offen lds
s_addk_i32 m0, 32
s_nop 0
buffer_load_dwordx4 v240, s[12:15], s96 offen offset:1024 lds
s_addk_i32 m0, 8416
s_addk_i32 s96, 8192
buffer_load_dwordx4 v240, s[12:15], s96 offen lds
s_addk_i32 m0, 32
s_nop 0
buffer_load_dwordx4 v240, s[12:15], s96 offen offset:1024 lds
v_and_b32 v176, 15, v255
v_lshrrev_b32_e64 v177, 4, v255
v_mul_u32_u24 v251, 896, v176
v_lshl_add_u32 v251, v177, 4, v251
v_lshrrev_b32 v178, 3, v255
v_lshlrev_b32 v179, 1, v177
v_and_b32 v180, 7, v255
v_xor_b32 v179, v179, v180
v_mul_u32_u24 v248, 896, v178
v_lshl_add_u32 v248, v179, 4, v248
v_bfe_u32 v178, v176, 2, 1
v_lshlrev_b32 v178, 3, v178
v_lshrrev_b32 v179, 3, v176
v_lshl_add_u32 v178, v179, 1, v178
v_bfe_u32 v179, v176, 1, 1
v_add_u32 v178, v178, v179
v_lshlrev_b32 v179, 2, v177
v_sub_u32 v178, v178, v179
v_and_b32 v179, 1, v176
v_lshlrev_b32_e64 v179, 4, v179
v_mov_b32 v180, 0x3f80
v_lshlrev_b32 v179, v179, v180
v_cmp_eq_u32 vcc, 0, v178
s_nop 1
v_cndmask_b32 v192, 0, v179, vcc
v_cmp_eq_u32 vcc, 1, v178
s_nop 1
v_cndmask_b32 v193, 0, v179, vcc
v_cmp_eq_u32 vcc, 2, v178
s_nop 1
v_cndmask_b32 v194, 0, v179, vcc
v_cmp_eq_u32 vcc, 3, v178
s_nop 1
v_cndmask_b32 v195, 0, v179, vcc
v_cmp_eq_u32 vcc, -4, v178
s_nop 1
v_cndmask_b32 v196, 0, v179, vcc
v_cmp_eq_u32 vcc, -3, v178
s_nop 1
v_cndmask_b32 v197, 0, v179, vcc
v_cmp_eq_u32 vcc, -2, v178
s_nop 1
v_cndmask_b32 v198, 0, v179, vcc
v_cmp_eq_u32 vcc, -1, v178
s_nop 1
v_cndmask_b32_e64 v199, 0, v179, vcc
s_add_u32 m0, s77, 118272
s_addk_i32 s97, 8192
buffer_load_dwordx4 v240, s[16:19], s97 offen lds
s_addk_i32 m0, 32
s_nop 0
buffer_load_dwordx4 v240, s[16:19], s97 offen offset:1024 lds
s_addk_i32 m0, 8416
s_addk_i32 s97, 8192
buffer_load_dwordx4 v240, s[16:19], s97 offen lds
s_addk_i32 m0, 32
s_nop 0
buffer_load_dwordx4 v240, s[16:19], s97 offen offset:1024 lds
s_mov_b32 s83, 33558528
buffer_load_dwordx4 v[128:131], v249, s[20:23], s83 offen sc1
s_mov_b32 s83, 33559552
buffer_load_dwordx4 v[132:135], v249, s[20:23], s83 offen sc1
s_waitcnt vmcnt(18)
s_barrier
s_add_u32 m0, s76, 16896
s_addk_i32 s96, 8192
buffer_load_dwordx4 v240, s[12:15], s96 offen lds
s_addk_i32 m0, 32
s_nop 0
buffer_load_dwordx4 v240, s[12:15], s96 offen offset:1024 lds
s_addk_i32 m0, 8416
s_addk_i32 s96, 8192
buffer_load_dwordx4 v240, s[12:15], s96 offen lds
s_addk_i32 m0, 32
s_nop 0
buffer_load_dwordx4 v240, s[12:15], s96 offen offset:1024 lds
s_add_u32 m0, s77, 67584
s_addk_i32 s97, 8192
buffer_load_dwordx4 v240, s[16:19], s97 offen lds
s_addk_i32 m0, 32
s_nop 0
buffer_load_dwordx4 v240, s[16:19], s97 offen offset:1024 lds
s_addk_i32 m0, 8416
s_addk_i32 s97, 8192
buffer_load_dwordx4 v240, s[16:19], s97 offen lds
s_addk_i32 m0, 32
s_nop 0
buffer_load_dwordx4 v240, s[16:19], s97 offen offset:1024 lds
s_mov_b32 s83, 33560576
buffer_load_dwordx4 v[136:139], v249, s[20:23], s83 offen sc1
s_mov_b32 s83, 33561600
buffer_load_dwordx4 v[140:143], v249, s[20:23], s83 offen sc1
s_waitcnt vmcnt(16)
s_barrier
s_add_u32 m0, s76, 33792
s_addk_i32 s96, 8192
buffer_load_dwordx4 v240, s[12:15], s96 offen lds
s_addk_i32 m0, 32
s_nop 0
buffer_load_dwordx4 v240, s[12:15], s96 offen offset:1024 lds
s_addk_i32 m0, 8416
s_addk_i32 s96, 8192
buffer_load_dwordx4 v240, s[12:15], s96 offen lds
s_addk_i32 m0, 32
s_nop 0
buffer_load_dwordx4 v240, s[12:15], s96 offen offset:1024 lds
s_add_u32 m0, s77, 84480
s_addk_i32 s97, 8192
buffer_load_dwordx4 v240, s[16:19], s97 offen lds
s_addk_i32 m0, 32
s_nop 0
buffer_load_dwordx4 v240, s[16:19], s97 offen offset:1024 lds
s_addk_i32 m0, 8416
s_addk_i32 s97, 8192
buffer_load_dwordx4 v240, s[16:19], s97 offen lds
s_addk_i32 m0, 32
s_nop 0
buffer_load_dwordx4 v240, s[16:19], s97 offen offset:1024 lds
buffer_load_dwordx4 v[216:219], v251, s[8:11], s86 offen offset:0
buffer_load_dwordx4 v[220:223], v251, s[8:11], s86 offen offset:512
s_mov_b32 s83, 33562624
buffer_load_dwordx4 v[144:147], v249, s[20:23], s83 offen sc1
s_mov_b32 s83, 33563648
buffer_load_dwordx4 v[148:151], v249, s[20:23], s83 offen sc1
s_waitcnt vmcnt(18)
s_barrier
s_add_u32 m0, s76, 50688
s_addk_i32 s96, 8192
buffer_load_dwordx4 v240, s[12:15], s96 offen lds
s_addk_i32 m0, 32
s_nop 0
buffer_load_dwordx4 v240, s[12:15], s96 offen offset:1024 lds
s_addk_i32 m0, 8416
s_addk_i32 s96, 8192
buffer_load_dwordx4 v240, s[12:15], s96 offen lds
s_addk_i32 m0, 32
s_nop 0
buffer_load_dwordx4 v240, s[12:15], s96 offen offset:1024 lds
s_add_u32 m0, s77, 101376
s_addk_i32 s97, 8192
buffer_load_dwordx4 v240, s[16:19], s97 offen lds
s_addk_i32 m0, 32
s_nop 0
buffer_load_dwordx4 v240, s[16:19], s97 offen offset:1024 lds
s_addk_i32 m0, 8416
s_addk_i32 s97, 8192
buffer_load_dwordx4 v240, s[16:19], s97 offen lds
s_addk_i32 m0, 32
s_nop 0
buffer_load_dwordx4 v240, s[16:19], s97 offen offset:1024 lds
s_mov_b32 s83, 33564672
buffer_load_dwordx4 v[152:155], v249, s[20:23], s83 offen sc1
s_mov_b32 s83, 33565696
buffer_load_dwordx4 v[156:159], v249, s[20:23], s83 offen sc1
s_waitcnt vmcnt(18)
s_barrier
s_add_u32 m0, s76, 0
s_addk_i32 s96, 8192
buffer_load_dwordx4 v240, s[12:15], s96 offen lds
s_addk_i32 m0, 32
s_nop 0
buffer_load_dwordx4 v240, s[12:15], s96 offen offset:1024 lds
s_addk_i32 m0, 8416
s_addk_i32 s96, 8192
buffer_load_dwordx4 v240, s[12:15], s96 offen lds
s_addk_i32 m0, 32
s_nop 0
buffer_load_dwordx4 v240, s[12:15], s96 offen offset:1024 lds
s_add_u32 m0, s77, 118272
s_addk_i32 s97, 8192
buffer_load_dwordx4 v240, s[16:19], s97 offen lds
s_addk_i32 m0, 32
s_nop 0
buffer_load_dwordx4 v240, s[16:19], s97 offen offset:1024 lds
s_addk_i32 m0, 8416
s_addk_i32 s97, 8192
buffer_load_dwordx4 v240, s[16:19], s97 offen lds
s_addk_i32 m0, 32
s_nop 0
buffer_load_dwordx4 v240, s[16:19], s97 offen offset:1024 lds
v_mov_b32_e64 v96, 0
v_mov_b32 v97, 1
s_mov_b64 exec, 1
global_store_dword v96, v97, s[100:101] offset:128 sc1
s_mov_b64 exec, -1
s_mov_b32 s83, 33566720
buffer_load_dwordx4 v[160:163], v249, s[20:23], s83 offen sc1
s_mov_b32 s83, 33567744
buffer_load_dwordx4 v[164:167], v249, s[20:23], s83 offen sc1
s_waitcnt vmcnt(17)
s_barrier
s_add_u32 m0, s76, 16896
s_addk_i32 s96, 8192
buffer_load_dwordx4 v240, s[12:15], s96 offen lds
s_addk_i32 m0, 32
s_nop 0
buffer_load_dwordx4 v240, s[12:15], s96 offen offset:1024 lds
s_addk_i32 m0, 8416
s_addk_i32 s96, 8192
buffer_load_dwordx4 v240, s[12:15], s96 offen lds
s_addk_i32 m0, 32
s_nop 0
buffer_load_dwordx4 v240, s[12:15], s96 offen offset:1024 lds
s_add_u32 m0, s77, 67584
s_addk_i32 s97, 8192
buffer_load_dwordx4 v240, s[16:19], s97 offen lds
s_addk_i32 m0, 32
s_nop 0
buffer_load_dwordx4 v240, s[16:19], s97 offen offset:1024 lds
s_addk_i32 m0, 8416
s_addk_i32 s97, 8192
buffer_load_dwordx4 v240, s[16:19], s97 offen lds
s_addk_i32 m0, 32
s_nop 0
buffer_load_dwordx4 v240, s[16:19], s97 offen offset:1024 lds
s_mov_b32 s83, 33568768
buffer_load_dwordx4 v[168:171], v249, s[20:23], s83 offen sc1
s_mov_b32 s83, 33569792
buffer_load_dwordx4 v[172:175], v249, s[20:23], s83 offen sc1
s_waitcnt vmcnt(17)
s_barrier
buffer_load_dword v253, v252, s[32:35], s84 offen offset:128 sc1
s_add_u32 m0, s76, 33792
s_addk_i32 s96, 8192
buffer_load_dwordx4 v240, s[12:15], s96 offen lds
s_addk_i32 m0, 32
s_nop 0
buffer_load_dwordx4 v240, s[12:15], s96 offen offset:1024 lds
s_addk_i32 m0, 8416
s_addk_i32 s96, 8192
buffer_load_dwordx4 v240, s[12:15], s96 offen lds
s_addk_i32 m0, 32
s_nop 0
buffer_load_dwordx4 v240, s[12:15], s96 offen offset:1024 lds
s_add_u32 m0, s77, 84480
s_addk_i32 s97, 8192
buffer_load_dwordx4 v240, s[16:19], s97 offen lds
s_addk_i32 m0, 32
s_nop 0
buffer_load_dwordx4 v240, s[16:19], s97 offen offset:1024 lds
s_addk_i32 m0, 8416
s_addk_i32 s97, 8192
buffer_load_dwordx4 v240, s[16:19], s97 offen lds
s_addk_i32 m0, 32
s_nop 0
buffer_load_dwordx4 v240, s[16:19], s97 offen offset:1024 lds
s_waitcnt vmcnt(8)
v_cmp_le_u32_e64 vcc, 1, v253
s_cmp_eq_u64 vcc, -1
s_cbranch_scc1 L_pg1_ok
s_mov_b32 s7, 400000
L_pg1_lp:
s_sleep 8
buffer_load_dword v253, v252, s[32:35], s84 offen offset:128 sc1
s_waitcnt vmcnt(0)
v_cmp_le_u32 vcc, 1, v253
s_cmp_eq_u64 vcc, -1
s_cbranch_scc1 L_pg1_ok
s_sub_u32 s7, s7, 1
s_cbranch_scc0 L_pg1_lp
L_pg1_ok:
s_barrier
s_add_u32 m0, s76, 50688
s_addk_i32 s96, 8192
buffer_load_dwordx4 v240, s[12:15], s96 offen lds
s_addk_i32 m0, 32
s_nop 0
buffer_load_dwordx4 v240, s[12:15], s96 offen offset:1024 lds
s_addk_i32 m0, 8416
s_addk_i32 s96, 8192
buffer_load_dwordx4 v240, s[12:15], s96 offen lds
s_addk_i32 m0, 32
s_nop 0
buffer_load_dwordx4 v240, s[12:15], s96 offen offset:1024 lds
s_add_u32 m0, s77, 101376
s_addk_i32 s97, 8192
buffer_load_dwordx4 v240, s[16:19], s97 offen lds
s_addk_i32 m0, 32
s_nop 0
buffer_load_dwordx4 v240, s[16:19], s97 offen offset:1024 lds
s_addk_i32 m0, 8416
s_addk_i32 s97, 8192
buffer_load_dwordx4 v240, s[16:19], s97 offen lds
s_addk_i32 m0, 32
s_nop 0
buffer_load_dwordx4 v240, s[16:19], s97 offen offset:1024 lds
s_mov_b32 s83, 34603008
buffer_load_dwordx4 v[0:3], v249, s[20:23], s83 offen sc1
s_mov_b32 s83, 34604032
buffer_load_dwordx4 v[4:7], v249, s[20:23], s83 offen sc1
s_waitcnt vmcnt(14)
s_barrier
s_add_u32 m0, s76, 0
s_addk_i32 s96, 8192
buffer_load_dwordx4 v240, s[12:15], s96 offen lds
s_addk_i32 m0, 32
s_nop 0
buffer_load_dwordx4 v240, s[12:15], s96 offen offset:1024 lds
s_addk_i32 m0, 8416
s_addk_i32 s96, 8192
buffer_load_dwordx4 v240, s[12:15], s96 offen lds
s_addk_i32 m0, 32
s_nop 0
buffer_load_dwordx4 v240, s[12:15], s96 offen offset:1024 lds
s_add_u32 m0, s77, 118272
s_addk_i32 s97, 8192
buffer_load_dwordx4 v240, s[16:19], s97 offen lds
s_addk_i32 m0, 32
s_nop 0
buffer_load_dwordx4 v240, s[16:19], s97 offen offset:1024 lds
s_addk_i32 m0, 8416
s_addk_i32 s97, 8192
buffer_load_dwordx4 v240, s[16:19], s97 offen lds
s_addk_i32 m0, 32
s_nop 0
buffer_load_dwordx4 v240, s[16:19], s97 offen offset:1024 lds
s_mov_b32 s83, 34605056
buffer_load_dwordx4 v[8:11], v249, s[20:23], s83 offen sc1
s_mov_b32 s83, 34606080
buffer_load_dwordx4 v[12:15], v249, s[20:23], s83 offen sc1
s_waitcnt vmcnt(16)
s_barrier
s_add_u32 m0, s76, 16896
s_addk_i32 s96, 8192
buffer_load_dwordx4 v240, s[12:15], s96 offen lds
s_addk_i32 m0, 32
s_nop 0
buffer_load_dwordx4 v240, s[12:15], s96 offen offset:1024 lds
s_addk_i32 m0, 8416
s_addk_i32 s96, 8192
buffer_load_dwordx4 v240, s[12:15], s96 offen lds
s_addk_i32 m0, 32
s_nop 0
buffer_load_dwordx4 v240, s[12:15], s96 offen offset:1024 lds
s_add_u32 m0, s77, 67584
s_addk_i32 s97, 8192
buffer_load_dwordx4 v240, s[16:19], s97 offen lds
s_addk_i32 m0, 32
s_nop 0
buffer_load_dwordx4 v240, s[16:19], s97 offen offset:1024 lds
s_addk_i32 m0, 8416
s_addk_i32 s97, 8192
buffer_load_dwordx4 v240, s[16:19], s97 offen lds
s_addk_i32 m0, 32
s_nop 0
buffer_load_dwordx4 v240, s[16:19], s97 offen offset:1024 lds
s_mul_i32 s83, s91, 14336
s_add_u32 s83, s83, s88
s_add_u32 s83, s83, 0
s_lshl_b32 s83, s83, 0
buffer_load_dword v244, v243, s[24:27], s83 offen
s_mov_b32 s83, 34607104
buffer_load_dwordx4 v[16:19], v249, s[20:23], s83 offen sc1
s_mov_b32 s83, 34608128
buffer_load_dwordx4 v[20:23], v249, s[20:23], s83 offen sc1
s_waitcnt vmcnt(17)
s_barrier
s_add_u32 m0, s76, 33792
s_addk_i32 s96, 8192
buffer_load_dwordx4 v240, s[12:15], s96 offen lds
s_addk_i32 m0, 32
s_nop 0
buffer_load_dwordx4 v240, s[12:15], s96 offen offset:1024 lds
s_addk_i32 m0, 8416
s_addk_i32 s96, 8192
buffer_load_dwordx4 v240, s[12:15], s96 offen lds
s_addk_i32 m0, 32
s_nop 0
buffer_load_dwordx4 v240, s[12:15], s96 offen offset:1024 lds
s_add_u32 m0, s77, 84480
s_addk_i32 s97, 8192
buffer_load_dwordx4 v240, s[16:19], s97 offen lds
s_addk_i32 m0, 32
s_nop 0
buffer_load_dwordx4 v240, s[16:19], s97 offen offset:1024 lds
s_addk_i32 m0, 8416
s_addk_i32 s97, 8192
buffer_load_dwordx4 v240, s[16:19], s97 offen lds
s_addk_i32 m0, 32
s_nop 0
buffer_load_dwordx4 v240, s[16:19], s97 offen offset:1024 lds
s_mov_b32 s83, 34609152
buffer_load_dwordx4 v[24:27], v249, s[20:23], s83 offen sc1
s_mov_b32 s83, 34610176
buffer_load_dwordx4 v[28:31], v249, s[20:23], s83 offen sc1
s_waitcnt vmcnt(17)
s_barrier
s_add_u32 m0, s76, 50688
s_addk_i32 s96, 8192
buffer_load_dwordx4 v240, s[12:15], s96 offen lds
s_addk_i32 m0, 32
s_nop 0
buffer_load_dwordx4 v240, s[12:15], s96 offen offset:1024 lds
s_addk_i32 m0, 8416
s_addk_i32 s96, 8192
buffer_load_dwordx4 v240, s[12:15], s96 offen lds
s_addk_i32 m0, 32
s_nop 0
buffer_load_dwordx4 v240, s[12:15], s96 offen offset:1024 lds
s_add_u32 m0, s77, 101376
s_addk_i32 s97, 8192
buffer_load_dwordx4 v240, s[16:19], s97 offen lds
s_addk_i32 m0, 32
s_nop 0
buffer_load_dwordx4 v240, s[16:19], s97 offen offset:1024 lds
s_addk_i32 m0, 8416
s_addk_i32 s97, 8192
buffer_load_dwordx4 v240, s[16:19], s97 offen lds
s_addk_i32 m0, 32
s_nop 0
buffer_load_dwordx4 v240, s[16:19], s97 offen offset:1024 lds
s_add_u32 m0, s78, 135168
s_add_u32 s80, s87, 0
buffer_load_dwordx4 v248, s[24:27], s80 offen lds
s_addk_i32 m0, 1024
s_addk_i32 s80, 7168
buffer_load_dwordx4 v248, s[24:27], s80 offen lds
s_addk_i32 m0, 1024
s_addk_i32 s80, 7168
buffer_load_dwordx4 v248, s[24:27], s80 offen lds
s_addk_i32 m0, 1024
s_addk_i32 s80, 7168
buffer_load_dwordx4 v248, s[24:27], s80 offen lds
s_mul_i32 s83, s91, 14336
s_add_u32 s83, s83, s88
s_add_u32 s83, s83, 8192
s_lshl_b32 s83, s83, 0
buffer_load_dword v244, v243, s[24:27], s83 offen
s_mov_b32 s83, 34611200
buffer_load_dwordx4 v[32:35], v249, s[20:23], s83 offen sc1
s_mov_b32 s83, 34612224
buffer_load_dwordx4 v[36:39], v249, s[20:23], s83 offen sc1
s_waitcnt vmcnt(21)
s_barrier
s_add_u32 m0, s77, 118272
s_addk_i32 s97, 8192
buffer_load_dwordx4 v240, s[16:19], s97 offen lds
s_addk_i32 m0, 32
s_nop 0
buffer_load_dwordx4 v240, s[16:19], s97 offen offset:1024 lds
s_addk_i32 m0, 8416
s_addk_i32 s97, 8192
buffer_load_dwordx4 v240, s[16:19], s97 offen lds
s_addk_i32 m0, 32
s_nop 0
buffer_load_dwordx4 v240, s[16:19], s97 offen offset:1024 lds
s_add_u32 m0, s78, 0
s_add_u32 s80, s87, 114688
buffer_load_dwordx4 v248, s[24:27], s80 offen lds
s_addk_i32 m0, 1024
s_addk_i32 s80, 7168
buffer_load_dwordx4 v248, s[24:27], s80 offen lds
s_addk_i32 m0, 1024
s_addk_i32 s80, 7168
buffer_load_dwordx4 v248, s[24:27], s80 offen lds
s_addk_i32 m0, 1024
s_addk_i32 s80, 7168
buffer_load_dwordx4 v248, s[24:27], s80 offen lds
s_mov_b32 s83, 34613248
buffer_load_dwordx4 v[40:43], v249, s[20:23], s83 offen sc1
s_mov_b32 s83, 34614272
buffer_load_dwordx4 v[44:47], v249, s[20:23], s83 offen sc1
s_waitcnt vmcnt(21)
s_barrier
s_add_u32 m0, s78, 16896
s_add_u32 s80, s87, 128
buffer_load_dwordx4 v248, s[24:27], s80 offen lds
s_addk_i32 m0, 1024
s_addk_i32 s80, 7168
buffer_load_dwordx4 v248, s[24:27], s80 offen lds
s_addk_i32 m0, 1024
s_addk_i32 s80, 7168
buffer_load_dwordx4 v248, s[24:27], s80 offen lds
s_addk_i32 m0, 1024
s_addk_i32 s80, 7168
buffer_load_dwordx4 v248, s[24:27], s80 offen lds
s_add_u32 m0, s78, 67584
s_add_u32 s80, s87, 114816
buffer_load_dwordx4 v248, s[24:27], s80 offen lds
s_addk_i32 m0, 1024
s_addk_i32 s80, 7168
buffer_load_dwordx4 v248, s[24:27], s80 offen lds
s_addk_i32 m0, 1024
s_addk_i32 s80, 7168
buffer_load_dwordx4 v248, s[24:27], s80 offen lds
s_addk_i32 m0, 1024
s_addk_i32 s80, 7168
buffer_load_dwordx4 v248, s[24:27], s80 offen lds
s_mov_b32 s83, 34615296
buffer_load_dwordx4 v[48:51], v249, s[20:23], s83 offen sc1
s_mov_b32 s83, 34616320
buffer_load_dwordx4 v[52:55], v249, s[20:23], s83 offen sc1
s_waitcnt vmcnt(27)
s_barrier
s_add_u32 m0, s78, 33792
s_add_u32 s80, s87, 256
buffer_load_dwordx4 v248, s[24:27], s80 offen lds
s_addk_i32 m0, 1024
s_addk_i32 s80, 7168
buffer_load_dwordx4 v248, s[24:27], s80 offen lds
s_addk_i32 m0, 1024
s_addk_i32 s80, 7168
buffer_load_dwordx4 v248, s[24:27], s80 offen lds
s_addk_i32 m0, 1024
s_addk_i32 s80, 7168
buffer_load_dwordx4 v248, s[24:27], s80 offen lds
s_add_u32 m0, s78, 84480
s_add_u32 s80, s87, 114944
buffer_load_dwordx4 v248, s[24:27], s80 offen lds
s_addk_i32 m0, 1024
s_addk_i32 s80, 7168
buffer_load_dwordx4 v248, s[24:27], s80 offen lds
s_addk_i32 m0, 1024
s_addk_i32 s80, 7168
buffer_load_dwordx4 v248, s[24:27], s80 offen lds
s_addk_i32 m0, 1024
s_addk_i32 s80, 7168
buffer_load_dwordx4 v248, s[24:27], s80 offen lds
s_mov_b32 s83, 34617344
buffer_load_dwordx4 v[56:59], v249, s[20:23], s83 offen sc1
s_mov_b32 s83, 34618368
buffer_load_dwordx4 v[60:63], v249, s[20:23], s83 offen sc1
s_waitcnt vmcnt(26)
s_barrier
s_add_u32 m0, s78, 50688
s_add_u32 s80, s87, 384
buffer_load_dwordx4 v248, s[24:27], s80 offen lds
s_addk_i32 m0, 1024
s_addk_i32 s80, 7168
buffer_load_dwordx4 v248, s[24:27], s80 offen lds
s_addk_i32 m0, 1024
s_addk_i32 s80, 7168
buffer_load_dwordx4 v248, s[24:27], s80 offen lds
s_addk_i32 m0, 1024
s_addk_i32 s80, 7168
buffer_load_dwordx4 v248, s[24:27], s80 offen lds
s_add_u32 m0, s78, 101376
s_add_u32 s80, s87, 115072
buffer_load_dwordx4 v248, s[24:27], s80 offen lds
s_addk_i32 m0, 1024
s_addk_i32 s80, 7168
buffer_load_dwordx4 v248, s[24:27], s80 offen lds
s_addk_i32 m0, 1024
s_addk_i32 s80, 7168
buffer_load_dwordx4 v248, s[24:27], s80 offen lds
s_addk_i32 m0, 1024
s_addk_i32 s80, 7168
buffer_load_dwordx4 v248, s[24:27], s80 offen lds
v_mov_b32 v176, 135136
s_waitcnt vmcnt(30)
s_barrier
ds_read_b32 v177, v176
s_add_u32 m0, s78, 118272
s_add_u32 s80, s87, 512
buffer_load_dwordx4 v248, s[24:27], s80 offen lds
s_addk_i32 m0, 1024
s_addk_i32 s80, 7168
buffer_load_dwordx4 v248, s[24:27], s80 offen lds
s_addk_i32 m0, 1024
s_addk_i32 s80, 7168
buffer_load_dwordx4 v248, s[24:27], s80 offen lds
s_addk_i32 m0, 1024
s_addk_i32 s80, 7168
buffer_load_dwordx4 v248, s[24:27], s80 offen lds
s_waitcnt lgkmcnt(0)
v_readfirstlane_b32 s7, v177
s_andn2_b32 s7, s7, s79
s_cbranch_scc1 L_again
s_waitcnt vmcnt(28)
s_barrier
s_add_u32 m0, s78, 135168
s_add_u32 s80, s87, 115200
buffer_load_dwordx4 v248, s[24:27], s80 offen lds
s_addk_i32 m0, 1024
s_addk_i32 s80, 7168
buffer_load_dwordx4 v248, s[24:27], s80 offen lds
s_addk_i32 m0, 1024
s_addk_i32 s80, 7168
buffer_load_dwordx4 v248, s[24:27], s80 offen lds
s_addk_i32 m0, 1024
s_addk_i32 s80, 7168
buffer_load_dwordx4 v248, s[24:27], s80 offen lds
s_waitcnt vmcnt(28)
s_barrier
s_add_u32 m0, s78, 0
s_add_u32 s80, s87, 640
buffer_load_dwordx4 v248, s[24:27], s80 offen lds
s_addk_i32 m0, 1024
s_addk_i32 s80, 7168
buffer_load_dwordx4 v248, s[24:27], s80 offen lds
s_addk_i32 m0, 1024
s_addk_i32 s80, 7168
buffer_load_dwordx4 v248, s[24:27], s80 offen lds
s_addk_i32 m0, 1024
s_addk_i32 s80, 7168
buffer_load_dwordx4 v248, s[24:27], s80 offen lds
s_waitcnt vmcnt(26)
s_barrier
s_add_u32 m0, s78, 16896
s_add_u32 s80, s87, 115328
buffer_load_dwordx4 v248, s[24:27], s80 offen lds
s_addk_i32 m0, 1024
s_addk_i32 s80, 7168
buffer_load_dwordx4 v248, s[24:27], s80 offen lds
s_addk_i32 m0, 1024
s_addk_i32 s80, 7168
buffer_load_dwordx4 v248, s[24:27], s80 offen lds
s_addk_i32 m0, 1024
s_addk_i32 s80, 7168
buffer_load_dwordx4 v248, s[24:27], s80 offen lds
s_waitcnt vmcnt(26)
s_barrier
s_add_u32 m0, s78, 67584
s_add_u32 s80, s87, 768
buffer_load_dwordx4 v248, s[24:27], s80 offen lds
s_addk_i32 m0, 1024
s_addk_i32 s80, 7168
buffer_load_dwordx4 v248, s[24:27], s80 offen lds
s_addk_i32 m0, 1024
s_addk_i32 s80, 7168
buffer_load_dwordx4 v248, s[24:27], s80 offen lds
s_addk_i32 m0, 1024
s_addk_i32 s80, 7168
buffer_load_dwordx4 v248, s[24:27], s80 offen lds
s_waitcnt vmcnt(16)
s_barrier
s_add_u32 m0, s78, 33792
s_add_u32 s80, s87, 115456
buffer_load_dwordx4 v248, s[24:27], s80 offen lds
s_addk_i32 m0, 1024
s_addk_i32 s80, 7168
buffer_load_dwordx4 v248, s[24:27], s80 offen lds
s_addk_i32 m0, 1024
s_addk_i32 s80, 7168
buffer_load_dwordx4 v248, s[24:27], s80 offen lds
s_addk_i32 m0, 1024
s_addk_i32 s80, 7168
buffer_load_dwordx4 v248, s[24:27], s80 offen lds
s_waitcnt vmcnt(0)
s_barrier
s_setprio 0
s_cmp_eq_u32 s6, 3
s_cbranch_scc1 L_hskip
s_lshl_b32 s7, s6, 2
s_lshr_b32 s7, 0x635, s7
s_and_b32 s7, s7, 15
s_mul_i32 s85, s7, 16896
s_lshl_b32 s90, s6, 12
s_add_u32 s90, s90, 151552
v_add_u32 v176, s85, v249
v_add_u32 v177, s90, v249
v_mov_b32_e64 v250, v249
ds_write_b128 v176, v[0:3] offset:0
ds_write_b128 v176, v[4:7] offset:1024
ds_write_b128 v176, v[8:11] offset:2048
ds_write_b128 v176, v[12:15] offset:3072
ds_write_b128 v176, v[16:19] offset:4096
ds_write_b128 v176, v[20:23] offset:5120
ds_write_b128 v176, v[24:27] offset:6144
ds_write_b128 v176, v[28:31] offset:7168
ds_write_b128 v176, v[32:35] offset:8192
ds_write_b128 v176, v[36:39] offset:9216
ds_write_b128 v176, v[40:43] offset:10240
ds_write_b128 v176, v[44:47] offset:11264
ds_write_b128 v176, v[48:51] offset:12288
ds_write_b128 v176, v[52:55] offset:13312
ds_write_b128 v176, v[56:59] offset:14336
ds_write_b128 v176, v[60:63] offset:15360
ds_write_b128 v177, v[192:195] offset:0
ds_write_b128 v177, v[196:199] offset:1024
ds_write_b128 v177, v[220:223] offset:2048
ds_write_b128 v177, v[250:253] offset:3072
L_hskip:
s_waitcnt vmcnt(0) lgkmcnt(0)
s_barrier
s_lshl_b32 s84, s6, 7
s_mov_b32 s81, 0
s_mov_b32 s75, 400000
buffer_load_dword v253, v252, s[32:35], s84 offen offset:0 sc1
s_waitcnt vmcnt(0)
v_cmp_le_u32_e64 vcc, 1, v253
s_andn2_b32 s82, vcc_lo, s81
s_or_b32 s81, s81, vcc_lo
s_bitcmp1_b32 s82, 0
s_cbranch_scc0 L_fa0_0
s_mov_b32 s83, 0
buffer_load_dwordx4 v[0:3], v249, s[20:23], s83 offen sc1
L_fa0_0:
s_bitcmp1_b32 s82, 1
s_cbranch_scc0 L_fa0_1
s_mov_b32 s83, 1024
buffer_load_dwordx4 v[4:7], v249, s[20:23], s83 offen sc1
L_fa0_1:
s_bitcmp1_b32 s82, 2
s_cbranch_scc0 L_fa0_2
s_mov_b32 s83, 2048
buffer_load_dwordx4 v[8:11], v249, s[20:23], s83 offen sc1
L_fa0_2:
s_bitcmp1_b32 s82, 3
s_cbranch_scc0 L_fa0_3
s_mov_b32 s83, 3072
buffer_load_dwordx4 v[12:15], v249, s[20:23], s83 offen sc1
L_fa0_3:
s_bitcmp1_b32 s82, 4
s_cbranch_scc0 L_fa0_4
s_mov_b32 s83, 4096
buffer_load_dwordx4 v[16:19], v249, s[20:23], s83 offen sc1
L_fa0_4:
s_bitcmp1_b32 s82, 5
s_cbranch_scc0 L_fa0_5
s_mov_b32 s83, 5120
buffer_load_dwordx4 v[20:23], v249, s[20:23], s83 offen sc1
L_fa0_5:
s_bitcmp1_b32 s82, 6
s_cbranch_scc0 L_fa0_6
s_mov_b32 s83, 6144
buffer_load_dwordx4 v[24:27], v249, s[20:23], s83 offen sc1
L_fa0_6:
s_bitcmp1_b32 s82, 7
s_cbranch_scc0 L_fa0_7
s_mov_b32 s83, 7168
buffer_load_dwordx4 v[28:31], v249, s[20:23], s83 offen sc1
L_fa0_7:
s_bitcmp1_b32 s82, 8
s_cbranch_scc0 L_fa0_8
s_mov_b32 s83, 8192
buffer_load_dwordx4 v[32:35], v249, s[20:23], s83 offen sc1
L_fa0_8:
s_bitcmp1_b32 s82, 9
s_cbranch_scc0 L_fa0_9
s_mov_b32 s83, 9216
buffer_load_dwordx4 v[36:39], v249, s[20:23], s83 offen sc1
L_fa0_9:
s_bitcmp1_b32 s82, 10
s_cbranch_scc0 L_fa0_10
s_mov_b32 s83, 10240
buffer_load_dwordx4 v[40:43], v249, s[20:23], s83 offen sc1
L_fa0_10:
s_bitcmp1_b32 s82, 11
s_cbranch_scc0 L_fa0_11
s_mov_b32 s83, 11264
buffer_load_dwordx4 v[44:47], v249, s[20:23], s83 offen sc1
L_fa0_11:
s_bitcmp1_b32 s82, 12
s_cbranch_scc0 L_fa0_12
s_mov_b32 s83, 12288
buffer_load_dwordx4 v[48:51], v249, s[20:23], s83 offen sc1
L_fa0_12:
s_bitcmp1_b32 s82, 13
s_cbranch_scc0 L_fa0_13
s_mov_b32 s83, 13312
buffer_load_dwordx4 v[52:55], v249, s[20:23], s83 offen sc1
L_fa0_13:
s_bitcmp1_b32 s82, 14
s_cbranch_scc0 L_fa0_14
s_mov_b32 s83, 14336
buffer_load_dwordx4 v[56:59], v249, s[20:23], s83 offen sc1
L_fa0_14:
s_bitcmp1_b32 s82, 15
s_cbranch_scc0 L_fa0_15
s_mov_b32 s83, 15360
buffer_load_dwordx4 v[60:63], v249, s[20:23], s83 offen sc1
L_fa0_15:
v_mfma_f32_16x16x32_bf16 v[200:203], v[192:195], v[112:115], 0
v_mfma_f32_16x16x32_bf16 v[204:207], v[196:199], v[112:115], 0
v_mfma_f32_16x16x32_bf16 v[200:203], v[192:195], v[116:119], v[200:203]
v_mfma_f32_16x16x32_bf16 v[204:207], v[196:199], v[116:119], v[204:207]
v_mfma_f32_16x16x32_bf16 v[200:203], v[192:195], v[120:123], v[200:203]
v_mfma_f32_16x16x32_bf16 v[204:207], v[196:199], v[120:123], v[204:207]
v_mfma_f32_16x16x32_bf16 v[200:203], v[192:195], v[124:127], v[200:203]
v_mfma_f32_16x16x32_bf16 v[204:207], v[196:199], v[124:127], v[204:207]
v_mfma_f32_16x16x32_bf16 v[200:203], v[192:195], v[128:131], v[200:203]
v_mfma_f32_16x16x32_bf16 v[204:207], v[196:199], v[128:131], v[204:207]
v_mfma_f32_16x16x32_bf16 v[200:203], v[192:195], v[132:135], v[200:203]
v_mfma_f32_16x16x32_bf16 v[204:207], v[196:199], v[132:135], v[204:207]
v_mfma_f32_16x16x32_bf16 v[200:203], v[192:195], v[136:139], v[200:203]
v_mfma_f32_16x16x32_bf16 v[204:207], v[196:199], v[136:139], v[204:207]
v_mfma_f32_16x16x32_bf16 v[200:203], v[192:195], v[140:143], v[200:203]
v_mfma_f32_16x16x32_bf16 v[204:207], v[196:199], v[140:143], v[204:207]
v_mfma_f32_16x16x32_bf16 v[200:203], v[192:195], v[144:147], v[200:203]
v_mfma_f32_16x16x32_bf16 v[204:207], v[196:199], v[144:147], v[204:207]
v_mfma_f32_16x16x32_bf16 v[200:203], v[192:195], v[148:151], v[200:203]
v_mfma_f32_16x16x32_bf16 v[204:207], v[196:199], v[148:151], v[204:207]
v_mfma_f32_16x16x32_bf16 v[200:203], v[192:195], v[152:155], v[200:203]
v_mfma_f32_16x16x32_bf16 v[204:207], v[196:199], v[152:155], v[204:207]
v_mfma_f32_16x16x32_bf16 v[200:203], v[192:195], v[156:159], v[200:203]
v_mfma_f32_16x16x32_bf16 v[204:207], v[196:199], v[156:159], v[204:207]
v_mfma_f32_16x16x32_bf16 v[200:203], v[192:195], v[160:163], v[200:203]
v_mfma_f32_16x16x32_bf16 v[204:207], v[196:199], v[160:163], v[204:207]
v_mfma_f32_16x16x32_bf16 v[200:203], v[192:195], v[164:167], v[200:203]
v_mfma_f32_16x16x32_bf16 v[204:207], v[196:199], v[164:167], v[204:207]
v_mfma_f32_16x16x32_bf16 v[200:203], v[192:195], v[168:171], v[200:203]
v_mfma_f32_16x16x32_bf16 v[204:207], v[196:199], v[168:171], v[204:207]
v_mfma_f32_16x16x32_bf16 v[200:203], v[192:195], v[172:175], v[200:203]
v_mfma_f32_16x16x32_bf16 v[204:207], v[196:199], v[172:175], v[204:207]
s_nop 6
v_cvt_pk_bf16_f32 v224, v200, v201
v_cvt_pk_bf16_f32 v225, v202, v203
v_cvt_pk_bf16_f32 v226, v204, v205
v_cvt_pk_bf16_f32 v227, v206, v207
v_lshlrev_b32 v200, 16, v224
v_and_b32 v201, s74, v224
v_lshlrev_b32 v202, 16, v225
v_and_b32 v203, s74, v225
v_lshlrev_b32 v204, 16, v226
v_and_b32 v205, s74, v226
v_lshlrev_b32 v206, 16, v227
v_and_b32 v207, s74, v227
v_mul_f32 v224, s73, v200
v_mul_f32 v225, s73, v201
v_mul_f32 v226, s73, v202
v_mul_f32 v227, s73, v203
v_mul_f32 v228, s73, v204
v_mul_f32 v229, s73, v205
v_mul_f32 v230, s73, v206
v_mul_f32 v231, s73, v207
v_exp_f32 v224, v224
v_exp_f32 v225, v225
v_exp_f32 v226, v226
v_exp_f32 v227, v227
v_exp_f32 v228, v228
v_exp_f32 v229, v229
v_exp_f32 v230, v230
v_exp_f32 v231, v231
v_add_f32 v224, 1.0, v224
v_add_f32 v225, 1.0, v225
v_add_f32 v226, 1.0, v226
v_add_f32 v227, 1.0, v227
v_add_f32 v228, 1.0, v228
v_add_f32 v229, 1.0, v229
v_add_f32 v230, 1.0, v230
v_add_f32 v231, 1.0, v231
v_rcp_f32 v224, v224
v_rcp_f32 v225, v225
v_rcp_f32 v226, v226
v_rcp_f32 v227, v227
v_rcp_f32 v228, v228
v_rcp_f32 v229, v229
v_rcp_f32 v230, v230
v_rcp_f32 v231, v231
v_mul_f32 v200, v200, v224
v_mul_f32 v201, v201, v225
v_mul_f32 v202, v202, v226
v_mul_f32 v203, v203, v227
v_mul_f32 v204, v204, v228
v_mul_f32 v205, v205, v229
v_mul_f32 v206, v206, v230
v_mul_f32_e64 v207, v207, v231
v_cvt_pk_bf16_f32 v224, v200, v201
v_cvt_pk_bf16_f32 v225, v202, v203
v_cvt_pk_bf16_f32 v226, v204, v205
v_cvt_pk_bf16_f32 v227, v206, v207
v_lshlrev_b32 v200, 16, v224
v_and_b32 v201, s74, v224
v_lshlrev_b32 v202, 16, v225
v_and_b32 v203, s74, v225
v_lshlrev_b32 v204, 16, v226
v_and_b32 v205, s74, v226
v_lshlrev_b32 v206, 16, v227
v_and_b32 v207, s74, v227
s_cmp_eq_u32 s81, -1
s_cbranch_scc1 L_fd0
L_fl0:
buffer_load_dword v253, v252, s[32:35], s84 offen offset:0 sc1
s_waitcnt vmcnt(0)
v_cmp_le_u32_e64 vcc, 1, v253
s_andn2_b32 s82, vcc_lo, s81
s_or_b32 s81, s81, vcc_lo
s_bitcmp1_b32 s82, 0
s_cbranch_scc0 L_fb0_0
s_mov_b32 s83, 0
buffer_load_dwordx4 v[0:3], v249, s[20:23], s83 offen sc1
L_fb0_0:
s_bitcmp1_b32 s82, 1
s_cbranch_scc0 L_fb0_1
s_mov_b32 s83, 1024
buffer_load_dwordx4 v[4:7], v249, s[20:23], s83 offen sc1
L_fb0_1:
s_bitcmp1_b32 s82, 2
s_cbranch_scc0 L_fb0_2
s_mov_b32 s83, 2048
buffer_load_dwordx4 v[8:11], v249, s[20:23], s83 offen sc1
L_fb0_2:
s_bitcmp1_b32 s82, 3
s_cbranch_scc0 L_fb0_3
s_mov_b32 s83, 3072
buffer_load_dwordx4 v[12:15], v249, s[20:23], s83 offen sc1
L_fb0_3:
s_bitcmp1_b32 s82, 4
s_cbranch_scc0 L_fb0_4
s_mov_b32 s83, 4096
buffer_load_dwordx4 v[16:19], v249, s[20:23], s83 offen sc1
L_fb0_4:
s_bitcmp1_b32 s82, 5
s_cbranch_scc0 L_fb0_5
s_mov_b32 s83, 5120
buffer_load_dwordx4 v[20:23], v249, s[20:23], s83 offen sc1
L_fb0_5:
s_bitcmp1_b32 s82, 6
s_cbranch_scc0 L_fb0_6
s_mov_b32 s83, 6144
buffer_load_dwordx4 v[24:27], v249, s[20:23], s83 offen sc1
L_fb0_6:
s_bitcmp1_b32 s82, 7
s_cbranch_scc0 L_fb0_7
s_mov_b32 s83, 7168
buffer_load_dwordx4 v[28:31], v249, s[20:23], s83 offen sc1
L_fb0_7:
s_bitcmp1_b32 s82, 8
s_cbranch_scc0 L_fb0_8
s_mov_b32 s83, 8192
buffer_load_dwordx4 v[32:35], v249, s[20:23], s83 offen sc1
L_fb0_8:
s_bitcmp1_b32 s82, 9
s_cbranch_scc0 L_fb0_9
s_mov_b32 s83, 9216
buffer_load_dwordx4 v[36:39], v249, s[20:23], s83 offen sc1
L_fb0_9:
s_bitcmp1_b32 s82, 10
s_cbranch_scc0 L_fb0_10
s_mov_b32 s83, 10240
buffer_load_dwordx4 v[40:43], v249, s[20:23], s83 offen sc1
L_fb0_10:
s_bitcmp1_b32 s82, 11
s_cbranch_scc0 L_fb0_11
s_mov_b32 s83, 11264
buffer_load_dwordx4 v[44:47], v249, s[20:23], s83 offen sc1
L_fb0_11:
s_bitcmp1_b32 s82, 12
s_cbranch_scc0 L_fb0_12
s_mov_b32 s83, 12288
buffer_load_dwordx4 v[48:51], v249, s[20:23], s83 offen sc1
L_fb0_12:
s_bitcmp1_b32 s82, 13
s_cbranch_scc0 L_fb0_13
s_mov_b32 s83, 13312
buffer_load_dwordx4 v[52:55], v249, s[20:23], s83 offen sc1
L_fb0_13:
s_bitcmp1_b32 s82, 14
s_cbranch_scc0 L_fb0_14
s_mov_b32 s83, 14336
buffer_load_dwordx4 v[56:59], v249, s[20:23], s83 offen sc1
L_fb0_14:
s_bitcmp1_b32 s82, 15
s_cbranch_scc0 L_fb0_15
s_mov_b32 s83, 15360
buffer_load_dwordx4 v[60:63], v249, s[20:23], s83 offen sc1
L_fb0_15:
s_cmp_eq_u32 s81, -1
s_cbranch_scc1 L_fd0
s_sleep 8
s_sub_u32 s75, s75, 1
s_cbranch_scc0 L_fl0
L_fd0:
v_lshlrev_b32 v232, 16, v216
v_and_b32 v233, s74, v216
v_lshlrev_b32 v234, 16, v217
v_and_b32 v235, s74, v217
v_lshlrev_b32 v236, 16, v218
v_and_b32 v237, s74, v218
v_lshlrev_b32 v238, 16, v219
v_and_b32 v239, s74, v219
s_waitcnt vmcnt(0)
v_mfma_f32_16x16x32_bf16 v[208:211], v[192:195], v[0:3], 0
v_mfma_f32_16x16x32_bf16 v[212:215], v[196:199], v[0:3], 0
v_mfma_f32_16x16x32_bf16 v[208:211], v[192:195], v[4:7], v[208:211]
v_mfma_f32_16x16x32_bf16 v[212:215], v[196:199], v[4:7], v[212:215]
v_mfma_f32_16x16x32_bf16 v[208:211], v[192:195], v[8:11], v[208:211]
v_mfma_f32_16x16x32_bf16 v[212:215], v[196:199], v[8:11], v[212:215]
v_mfma_f32_16x16x32_bf16 v[208:211], v[192:195], v[12:15], v[208:211]
v_mfma_f32_16x16x32_bf16 v[212:215], v[196:199], v[12:15], v[212:215]
v_mfma_f32_16x16x32_bf16 v[208:211], v[192:195], v[16:19], v[208:211]
v_mfma_f32_16x16x32_bf16 v[212:215], v[196:199], v[16:19], v[212:215]
v_mfma_f32_16x16x32_bf16 v[208:211], v[192:195], v[20:23], v[208:211]
v_mfma_f32_16x16x32_bf16 v[212:215], v[196:199], v[20:23], v[212:215]
v_mfma_f32_16x16x32_bf16 v[208:211], v[192:195], v[24:27], v[208:211]
v_mfma_f32_16x16x32_bf16 v[212:215], v[196:199], v[24:27], v[212:215]
v_mfma_f32_16x16x32_bf16 v[208:211], v[192:195], v[28:31], v[208:211]
v_mfma_f32_16x16x32_bf16 v[212:215], v[196:199], v[28:31], v[212:215]
v_mfma_f32_16x16x32_bf16 v[208:211], v[192:195], v[32:35], v[208:211]
v_mfma_f32_16x16x32_bf16 v[212:215], v[196:199], v[32:35], v[212:215]
v_mfma_f32_16x16x32_bf16 v[208:211], v[192:195], v[36:39], v[208:211]
v_mfma_f32_16x16x32_bf16 v[212:215], v[196:199], v[36:39], v[212:215]
v_mfma_f32_16x16x32_bf16 v[208:211], v[192:195], v[40:43], v[208:211]
v_mfma_f32_16x16x32_bf16 v[212:215], v[196:199], v[40:43], v[212:215]
v_mfma_f32_16x16x32_bf16 v[208:211], v[192:195], v[44:47], v[208:211]
v_mfma_f32_16x16x32_bf16 v[212:215], v[196:199], v[44:47], v[212:215]
v_mfma_f32_16x16x32_bf16 v[208:211], v[192:195], v[48:51], v[208:211]
v_mfma_f32_16x16x32_bf16 v[212:215], v[196:199], v[48:51], v[212:215]
v_mfma_f32_16x16x32_bf16 v[208:211], v[192:195], v[52:55], v[208:211]
v_mfma_f32_16x16x32_bf16 v[212:215], v[196:199], v[52:55], v[212:215]
v_mfma_f32_16x16x32_bf16 v[208:211], v[192:195], v[56:59], v[208:211]
v_mfma_f32_16x16x32_bf16 v[212:215], v[196:199], v[56:59], v[212:215]
v_mfma_f32_16x16x32_bf16 v[208:211], v[192:195], v[60:63], v[208:211]
v_mfma_f32_16x16x32_bf16 v[212:215], v[196:199], v[60:63], v[212:215]
s_nop 6
v_cvt_pk_bf16_f32 v224, v208, v209
v_cvt_pk_bf16_f32 v225, v210, v211
v_cvt_pk_bf16_f32 v226, v212, v213
v_cvt_pk_bf16_f32 v227, v214, v215
v_lshlrev_b32 v208, 16, v224
v_and_b32 v209, s74, v224
v_lshlrev_b32 v210, 16, v225
v_and_b32 v211, s74, v225
v_lshlrev_b32 v212, 16, v226
v_and_b32 v213, s74, v226
v_lshlrev_b32 v214, 16, v227
v_and_b32 v215, s74, v227
v_mul_f32 v208, v208, v200
v_mul_f32 v209, v209, v201
v_mul_f32 v210, v210, v202
v_mul_f32 v211, v211, v203
v_mul_f32 v212, v212, v204
v_mul_f32 v213, v213, v205
v_mul_f32 v214, v214, v206
v_mul_f32_e64 v215, v215, v207
v_cvt_pk_bf16_f32 v224, v208, v209
v_cvt_pk_bf16_f32 v225, v210, v211
v_cvt_pk_bf16_f32 v226, v212, v213
v_cvt_pk_bf16_f32 v227, v214, v215
v_lshlrev_b32 v208, 16, v224
v_and_b32 v209, s74, v224
v_lshlrev_b32 v210, 16, v225
v_and_b32 v211, s74, v225
v_lshlrev_b32 v212, 16, v226
v_and_b32 v213, s74, v226
v_lshlrev_b32 v214, 16, v227
v_and_b32 v215, s74, v227
v_add_f32 v208, v208, v232
v_add_f32 v209, v209, v233
v_add_f32 v210, v210, v234
v_add_f32 v211, v211, v235
v_add_f32 v212, v212, v236
v_add_f32 v213, v213, v237
v_add_f32 v214, v214, v238
v_add_f32 v215, v215, v239
v_cvt_pk_bf16_f32 v240, v208, v209
v_cvt_pk_bf16_f32 v241, v210, v211
v_cvt_pk_bf16_f32 v242, v212, v213
v_cvt_pk_bf16_f32 v243, v214, v215
buffer_store_dwordx4 v[240:243], v251, s[28:31], s86 offen offset:0 sc1
L_hdone:
s_endpgm
L_end:
s_endpgm
L_code_end:
.section .rodata,"a"
.p2align 6
.amdhsa_kernel recurrent_scan__mha_block_cached__glu_gated_glu__prompt_kernel
  .amdhsa_next_free_vgpr 256
  .amdhsa_next_free_sgpr 102
  .amdhsa_accum_offset 256
  .amdhsa_group_segment_fixed_size 0
  .amdhsa_kernarg_size 96
  .amdhsa_user_sgpr_count 2
  .amdhsa_user_sgpr_kernarg_segment_ptr 1
  .amdhsa_system_sgpr_workgroup_id_x 1
.end_amdhsa_kernel
```
